```python
import torch

def _softmax(x, axis=-1):
    return torch.softmax(x, dim=axis)
def _gelu(x):
    return torch.nn.functional.gelu(x, approximate="tanh")
def _silu(x):
    return torch.nn.functional.silu(x)
def _sigmoid(x):
    return torch.sigmoid(x)
def _layernorm(x, axis=-1, eps=1e-5):
    m = x.mean(dim=axis, keepdim=True)
    v = x.var(dim=axis, keepdim=True, unbiased=False)
    return (x - m) / torch.sqrt(v + eps)
def _scatter_add(tgt, idx, src, axis=0):
    return tgt.clone().index_add_(axis, idx, src)
def _segment_sum(src, seg, n):
    out = torch.zeros((n,) + src.shape[1:], dtype=src.dtype)
    return out.index_add_(0, seg, src)
def _pad(x, pw):
    flat = tuple(v for pair in reversed(pw) for v in pair)
    return torch.nn.functional.pad(x, flat)

kernel_name = 'recurrent_scan__sliding_local_dilated__glu_gated_geglu__prompt'

def setup_inputs():

    _w = (lambda a: (lambda t: t.to(torch.bfloat16) if t.is_floating_point() else t)(torch.as_tensor(a)))
    def _A_setup():
        B, S, D = 1, 2048, 640
        return {
            "x": _w((lambda *s: torch.randn(*s, dtype=torch.bfloat16) * 0.05)(B, S, D)),
            "wqkv": _w((lambda *s: torch.randn(*s, dtype=torch.bfloat16) * 0.2)(D, 3 * D)),
            "wo": _w((lambda *s: torch.randn(*s, dtype=torch.bfloat16) * 0.2)(D, D)),
        }
    _A_in = _A_setup()

    def _B_setup():
        B, S, Dm, Df = 1, 2048, 640, 1728
        return {
            "x": _w((lambda *s: torch.randn(*s, dtype=torch.bfloat16) * 0.05)(B, S, Dm)),
            "w_gate": _w((lambda *s: torch.randn(*s, dtype=torch.bfloat16) * 0.1)(Dm, Df) * (Dm ** -0.5)),
            "w_up": _w((lambda *s: torch.randn(*s, dtype=torch.bfloat16) * 0.1)(Dm, Df) * (Dm ** -0.5)),
            "w_down": _w((lambda *s: torch.randn(*s, dtype=torch.bfloat16) * 0.1)(Df, Dm) * (Df ** -0.5)),
        }
    _B_in = _B_setup()

    return {
        "A_x": _A_in["x"],
        "A_wqkv": _A_in["wqkv"],
        "A_wo": _A_in["wo"],
        "B_x": _B_in["x"],
        "B_w_gate": _B_in["w_gate"],
        "B_w_up": _B_in["w_up"],
        "B_w_down": _B_in["w_down"],
    }

def reference(A_x, A_wqkv, A_wo, B_x, B_w_gate, B_w_up, B_w_down):
    def _A_ref(x, wqkv, wo):
        B, S, D = x.shape
        H = 32; Dh = D // H
        W, dil = 8, 2
        qkv = (lambda x, *d: x.permute(*d))((x @ wqkv).reshape(B, S, 3, H, Dh), 2, 0, 3, 1, 4)
        q, k, v = qkv[0], qkv[1], qkv[2]
        scale = Dh ** -0.5
        pos = torch.arange(S)
        off = torch.arange(W) * dil
        idx = pos[:, None] - off[None, :]
        mask = idx >= 0
        idx_c = torch.where(mask, idx, 0).reshape(-1)
        kg = k[:, :, idx_c, :].reshape(B, H, S, W, Dh)
        vg = v[:, :, idx_c, :].reshape(B, H, S, W, Dh)
        logits = torch.einsum("bhsd,bhswd->bhsw", q, kg) * scale
        logits = torch.where(mask[None, None, :, :], logits, -1e9)
        attn = _softmax(logits, axis=-1)
        o = torch.einsum("bhsw,bhswd->bhsd", attn, vg)
        return (lambda x, *d: x.permute(*d))(o, 0, 2, 1, 3).reshape(B, S, D) @ wo

    def _B_ref(x, w_gate, w_up, w_down):
        g = torch.einsum("bsd,df->bsf", x, w_gate)
        u = torch.einsum("bsd,df->bsf", x, w_up)
        h = _gelu(g) * u
        return torch.einsum("bsf,fd->bsd", h, w_down)

    x = A_x
    xn = _layernorm(x, axis=-1)
    s = _A_ref(xn, A_wqkv, A_wo)
    g = _silu(_B_ref(xn, B_w_gate, B_w_up, B_w_down))
    return x + s * g
```

```asm
; @launch grid=(256,1,1) block=(512,1,1) lds=163840
.amdgcn_target "amdgcn-amd-amdhsa--gfx950"
.text
.globl recurrent_scan__sliding_local_dilated__glu_gated_geglu__prompt_kernel
.p2align 8
.type recurrent_scan__sliding_local_dilated__glu_gated_geglu__prompt_kernel,@function
recurrent_scan__sliding_local_dilated__glu_gated_geglu__prompt_kernel:
s_cmp_ge_u32 s2, 256
s_cbranch_scc1 L_end
s_load_dwordx16 s[36:51], s[0:1], 0
s_load_dwordx4 s[52:55], s[0:1], 64
s_getpc_b64 s[28:29]
L_pc:
s_mov_b32 s30, L_codeend-L_pc
s_mov_b32 s31, 0x20000
s_lshr_b32 s60, s2, 3
s_lshl_b32 s60, s60, 7
v_lshlrev_b32 v1, 12, v0
buffer_load_dword v63, v1, s[28:31], s60 offen
v_lshrrev_b32 v1, 6, v0
v_and_b32 v0, 63, v0
v_readfirstlane_b32 s56, v1
s_and_b32 s60, s2, 1
s_bfe_u32 s61, s2, 0x20001
s_lshr_b32 s62, s2, 3
s_lshl_b32 s61, s61, 1
s_cmp_ge_u32 s62, 7
s_cselect_b32 s64, 1, 0
s_cselect_b32 s63, 7, 0
s_sub_u32 s63, s62, s63
s_mul_i32 s65, s60, 7
s_add_u32 s63, s63, s65
s_add_u32 s64, s64, s61
s_sub_u32 s67, s62, 14
s_and_b32 s65, s67, 7
s_lshr_b32 s66, s67, 3
s_add_u32 s66, s66, s61
s_add_u32 s68, s61, s65
s_cmp_lt_u32 s67, 16
s_cselect_b32 s65, s65, s68
s_cselect_b32 s66, s66, 8
s_lshl_b32 s68, s60, 3
s_add_u32 s65, s65, s68
s_and_b32 s81, s56, 3
s_and_b32 s86, s56, 1
s_cmp_lt_u32 s62, 14
s_cselect_b32 s82, 1, 0
s_cselect_b32 s80, s63, s65
s_cselect_b32 s58, s64, s66
s_cselect_b32 s60, 73, 64
s_mul_i32 s57, s80, s60
s_mul_i32 s59, s58, 160
s_lshr_b32 s59, s59, 7
s_cmp_lt_u32 s56, 4
s_cbranch_scc1 L_G0
s_cmp_ge_u32 s56, 6
s_cbranch_scc1 L_SIDE
v_lshrrev_b32 v4, 3, v0
v_and_b32 v5, 7, v0
s_lshl_b32 s64, s86, 2
v_lshl_add_u32 v7, s86, 3, v4
v_add_u32 v6, s57, v7
v_mul_u32_u24 v8, 2560, v6
v_lshrrev_b32 v6, 1, v4
v_or_b32 v6, s64, v6
v_xor_b32 v6, v6, v5
v_lshl_add_u32 v8, v6, 4, v8
s_mul_i32 s84, s86, 10240
s_add_u32 s84, s84, 98304
s_mov_b32 m0, s84
s_mov_b32 s10, 2624512
s_mov_b32 s11, 0x20000
s_movk_i32 s68, 3072
s_waitcnt lgkmcnt(0)
s_sub_u32 s8, s36, 3072
s_subb_u32 s9, s37, 0
buffer_load_dwordx4 v8, s[8:11], s68 offen offset:0 lds
s_mov_b32 s69, 43008
s_cmp_eq_u32 s82, 1
s_movk_i32 s61, 3456
s_cmovk_i32 s61, 3840
s_mul_i32 s63, s58, 3
s_cmov_b32 s63, s59
s_cselect_b64 s[12:13], s[38:39], s[44:45]
s_cselect_b64 s[16:17], s[38:39], s[46:47]
buffer_load_dwordx4 v8, s[8:11], s69 offen offset:1024 lds
s_mov_b32 s70, 82944
s_lshl_b32 s63, s63, 7
v_mul_u32_u24 v2, s61, v7
v_and_or_b32 v6, v4, 2, s64
v_xor_b32 v6, v6, v5
v_lshl_add_u32 v2, v6, 4, v2
v_add_u32 v2, s63, v2
buffer_load_dwordx4 v8, s[8:11], s70 offen offset:2048 lds
s_mov_b32 s71, 122880
s_lshl_b32 s60, s61, 4
v_add_u32 v3, s60, v2
s_lshl_b32 s88, s61, 5
s_mul_i32 s83, s86, 24576
buffer_load_dwordx4 v8, s[8:11], s71 offen offset:3072 lds
s_mov_b32 s72, 166912
v_add_u32 v9, 1280, v8
s_add_u32 m0, s84, 5120
s_mul_i32 s14, s61, 640
s_add_u32 s14, s14, 3072
s_mov_b32 s18, s14
s_mov_b32 s15, 0x20000
s_mov_b32 s19, 0x20000
buffer_load_dwordx4 v9, s[8:11], s68 offen offset:0 lds
s_sub_u32 s12, s12, 3072
s_subb_u32 s13, s13, 0
s_sub_u32 s16, s16, 3072
s_subb_u32 s17, s17, 0
buffer_load_dwordx4 v9, s[8:11], s69 offen offset:1024 lds
s_cmp_eq_u32 s82, 1
s_movk_i32 s4, 3072
s_movk_i32 s5, 2048
s_cmovk_i32 s5, 2176
s_movk_i32 s6, 1152
s_cmovk_i32 s6, 2304
buffer_load_dwordx4 v9, s[8:11], s70 offen offset:2048 lds
s_cmp_eq_u32 s82, 1
s_movk_i32 s7, 128
s_cmovk_i32 s7, 1408
s_movk_i32 s42, 3328
s_cmovk_i32 s42, 5632
s_movk_i32 s43, 2304
s_cmovk_i32 s43, 4736
buffer_load_dwordx4 v9, s[8:11], s71 offen offset:3072 lds
s_add_u32 m0, s83, 0
s_nop 0
buffer_load_dwordx4 v2, s[12:15], s4 offen offset:0 lds
buffer_load_dwordx4 v2, s[16:19], s5 offen offset:1024 lds
buffer_load_dwordx4 v2, s[12:15], s6 offen offset:2048 lds
buffer_load_dwordx4 v2, s[16:19], s7 offen offset:3072 lds
s_add_u32 m0, s83, 49152
s_nop 0
buffer_load_dwordx4 v3, s[12:15], s4 offen offset:0 lds
buffer_load_dwordx4 v3, s[16:19], s5 offen offset:1024 lds
buffer_load_dwordx4 v3, s[12:15], s6 offen offset:2048 lds
buffer_load_dwordx4 v3, s[16:19], s7 offen offset:3072 lds
s_cmp_eq_u32 s82, 0
s_cbranch_scc1 L_nox
s_add_u32 m0, s84, 4096
s_nop 0
buffer_load_dwordx4 v8, s[8:11], s72 offen offset:0 lds
s_add_u32 m0, s84, 9216
s_nop 0
buffer_load_dwordx4 v9, s[8:11], s72 offen offset:0 lds
L_nox:
s_add_u32 m0, s83, 4096
s_nop 0
buffer_load_dwordx4 v2, s[12:15], s42 offen offset:0 lds
buffer_load_dwordx4 v2, s[16:19], s43 offen offset:1024 lds
s_add_u32 m0, s83, 53248
s_nop 0
buffer_load_dwordx4 v3, s[12:15], s42 offen offset:0 lds
buffer_load_dwordx4 v3, s[16:19], s43 offen offset:1024 lds
s_cmp_eq_u32 s82, 1
s_cbranch_scc1 L_LDA
s_branch L_LDB
L_SIDE:
s_and_b32 s60, s2, 1
s_lshl_b32 s60, s60, 2
s_bfe_u32 s61, s2, 0x20001
s_add_u32 s60, s60, s61
s_lshl_b32 s60, s60, 5
s_lshr_b32 s61, s2, 3
s_add_u32 s60, s60, s61
s_lshl_b32 s60, s60, 1
s_add_u32 s60, s60, s86
s_lshl_b32 s60, s60, 2
v_lshrrev_b32 v177, 4, v0
v_add_u32 v177, s60, v177
v_and_b32 v178, 15, v0
v_mul_u32_u24 v176, 1280, v177
v_lshl_add_u32 v176, v178, 4, v176
s_mov_b32 s10, 2621440
s_mov_b32 s11, 0x20000
s_waitcnt lgkmcnt(0)
s_mov_b64 s[8:9], s[36:37]
buffer_load_dwordx4 v[188:191], v176, s[8:11], 0 offen offset:0
buffer_load_dwordx4 v[192:195], v176, s[8:11], 0 offen offset:256
buffer_load_dwordx4 v[196:199], v176, s[8:11], 0 offen offset:512
buffer_load_dwordx4 v[200:203], v176, s[8:11], 0 offen offset:768
buffer_load_dwordx4 v[204:207], v176, s[8:11], 0 offen offset:1024
s_cmp_eq_u32 s82, 1
s_cbranch_scc1 L_SIDEA
s_branch L_SIDEB
L_LDB:
v_add_u32 v2, s88, v2
v_add_u32 v3, s88, v3
s_add_u32 m0, s83, 6144
s_nop 0
buffer_load_dwordx4 v2, s[12:15], s4 offen offset:0 lds
buffer_load_dwordx4 v2, s[16:19], s5 offen offset:1024 lds
buffer_load_dwordx4 v2, s[12:15], s6 offen offset:2048 lds
buffer_load_dwordx4 v2, s[16:19], s7 offen offset:3072 lds
s_add_u32 m0, s83, 55296
s_nop 0
buffer_load_dwordx4 v3, s[12:15], s4 offen offset:0 lds
buffer_load_dwordx4 v3, s[16:19], s5 offen offset:1024 lds
buffer_load_dwordx4 v3, s[12:15], s6 offen offset:2048 lds
buffer_load_dwordx4 v3, s[16:19], s7 offen offset:3072 lds
s_waitcnt vmcnt(12)
s_barrier
s_add_u32 m0, s83, 10240
s_nop 0
buffer_load_dwordx4 v2, s[12:15], s42 offen offset:0 lds
buffer_load_dwordx4 v2, s[16:19], s43 offen offset:1024 lds
s_add_u32 m0, s83, 59392
s_nop 0
buffer_load_dwordx4 v3, s[12:15], s42 offen offset:0 lds
buffer_load_dwordx4 v3, s[16:19], s43 offen offset:1024 lds
v_add_u32 v8, 128, v8
v_add_u32 v9, 128, v9
s_add_u32 m0, s84, 20480
s_nop 0
buffer_load_dwordx4 v8, s[8:11], s68 offen offset:0 lds
buffer_load_dwordx4 v8, s[8:11], s69 offen offset:1024 lds
buffer_load_dwordx4 v8, s[8:11], s70 offen offset:2048 lds
buffer_load_dwordx4 v8, s[8:11], s71 offen offset:3072 lds
s_add_u32 m0, s84, 25600
s_nop 0
buffer_load_dwordx4 v9, s[8:11], s68 offen offset:0 lds
buffer_load_dwordx4 v9, s[8:11], s69 offen offset:1024 lds
buffer_load_dwordx4 v9, s[8:11], s70 offen offset:2048 lds
buffer_load_dwordx4 v9, s[8:11], s71 offen offset:3072 lds
v_add_u32 v2, s88, v2
v_add_u32 v3, s88, v3
s_add_u32 m0, s83, 12288
s_nop 0
buffer_load_dwordx4 v2, s[12:15], s4 offen offset:0 lds
buffer_load_dwordx4 v2, s[16:19], s5 offen offset:1024 lds
buffer_load_dwordx4 v2, s[12:15], s6 offen offset:2048 lds
buffer_load_dwordx4 v2, s[16:19], s7 offen offset:3072 lds
s_add_u32 m0, s83, 61440
s_nop 0
buffer_load_dwordx4 v3, s[12:15], s4 offen offset:0 lds
buffer_load_dwordx4 v3, s[16:19], s5 offen offset:1024 lds
buffer_load_dwordx4 v3, s[12:15], s6 offen offset:2048 lds
buffer_load_dwordx4 v3, s[16:19], s7 offen offset:3072 lds
s_add_u32 m0, s83, 16384
s_nop 0
buffer_load_dwordx4 v2, s[12:15], s42 offen offset:0 lds
buffer_load_dwordx4 v2, s[16:19], s43 offen offset:1024 lds
s_waitcnt vmcnt(22)
s_barrier
s_add_u32 m0, s83, 65536
s_nop 0
buffer_load_dwordx4 v3, s[12:15], s42 offen offset:0 lds
buffer_load_dwordx4 v3, s[16:19], s43 offen offset:1024 lds
v_add_u32 v2, s88, v2
v_add_u32 v3, s88, v3
s_add_u32 m0, s83, 18432
s_nop 0
buffer_load_dwordx4 v2, s[12:15], s4 offen offset:0 lds
buffer_load_dwordx4 v2, s[16:19], s5 offen offset:1024 lds
buffer_load_dwordx4 v2, s[12:15], s6 offen offset:2048 lds
buffer_load_dwordx4 v2, s[16:19], s7 offen offset:3072 lds
s_add_u32 m0, s83, 67584
s_nop 0
buffer_load_dwordx4 v3, s[12:15], s4 offen offset:0 lds
buffer_load_dwordx4 v3, s[16:19], s5 offen offset:1024 lds
buffer_load_dwordx4 v3, s[12:15], s6 offen offset:2048 lds
buffer_load_dwordx4 v3, s[16:19], s7 offen offset:3072 lds
s_add_u32 m0, s83, 22528
s_nop 0
buffer_load_dwordx4 v2, s[12:15], s42 offen offset:0 lds
buffer_load_dwordx4 v2, s[16:19], s43 offen offset:1024 lds
s_add_u32 m0, s83, 71680
s_nop 0
buffer_load_dwordx4 v3, s[12:15], s42 offen offset:0 lds
buffer_load_dwordx4 v3, s[16:19], s43 offen offset:1024 lds
s_waitcnt vmcnt(16)
s_barrier
v_add_u32 v8, 128, v8
v_add_u32 v9, 128, v9
s_add_u32 m0, s84, 0
s_nop 0
buffer_load_dwordx4 v8, s[8:11], s68 offen offset:0 lds
buffer_load_dwordx4 v8, s[8:11], s69 offen offset:1024 lds
buffer_load_dwordx4 v8, s[8:11], s70 offen offset:2048 lds
buffer_load_dwordx4 v8, s[8:11], s71 offen offset:3072 lds
s_add_u32 m0, s84, 5120
s_nop 0
buffer_load_dwordx4 v9, s[8:11], s68 offen offset:0 lds
buffer_load_dwordx4 v9, s[8:11], s69 offen offset:1024 lds
buffer_load_dwordx4 v9, s[8:11], s70 offen offset:2048 lds
buffer_load_dwordx4 v9, s[8:11], s71 offen offset:3072 lds
v_add_u32 v2, s88, v2
v_add_u32 v3, s88, v3
s_add_u32 m0, s83, 0
s_nop 0
buffer_load_dwordx4 v2, s[12:15], s4 offen offset:0 lds
buffer_load_dwordx4 v2, s[16:19], s5 offen offset:1024 lds
buffer_load_dwordx4 v2, s[12:15], s6 offen offset:2048 lds
buffer_load_dwordx4 v2, s[16:19], s7 offen offset:3072 lds
s_add_u32 m0, s83, 49152
s_nop 0
buffer_load_dwordx4 v3, s[12:15], s4 offen offset:0 lds
buffer_load_dwordx4 v3, s[16:19], s5 offen offset:1024 lds
buffer_load_dwordx4 v3, s[12:15], s6 offen offset:2048 lds
buffer_load_dwordx4 v3, s[16:19], s7 offen offset:3072 lds
s_waitcnt vmcnt(20)
s_barrier
s_add_u32 m0, s83, 4096
s_nop 0
buffer_load_dwordx4 v2, s[12:15], s42 offen offset:0 lds
buffer_load_dwordx4 v2, s[16:19], s43 offen offset:1024 lds
s_add_u32 m0, s83, 53248
s_nop 0
buffer_load_dwordx4 v3, s[12:15], s42 offen offset:0 lds
buffer_load_dwordx4 v3, s[16:19], s43 offen offset:1024 lds
v_add_u32 v2, s88, v2
v_add_u32 v3, s88, v3
s_add_u32 m0, s83, 6144
s_nop 0
buffer_load_dwordx4 v2, s[12:15], s4 offen offset:0 lds
buffer_load_dwordx4 v2, s[16:19], s5 offen offset:1024 lds
buffer_load_dwordx4 v2, s[12:15], s6 offen offset:2048 lds
buffer_load_dwordx4 v2, s[16:19], s7 offen offset:3072 lds
s_add_u32 m0, s83, 55296
s_nop 0
buffer_load_dwordx4 v3, s[12:15], s4 offen offset:0 lds
buffer_load_dwordx4 v3, s[16:19], s5 offen offset:1024 lds
buffer_load_dwordx4 v3, s[12:15], s6 offen offset:2048 lds
buffer_load_dwordx4 v3, s[16:19], s7 offen offset:3072 lds
s_add_u32 m0, s83, 10240
s_nop 0
buffer_load_dwordx4 v2, s[12:15], s42 offen offset:0 lds
buffer_load_dwordx4 v2, s[16:19], s43 offen offset:1024 lds
s_add_u32 m0, s83, 59392
s_nop 0
buffer_load_dwordx4 v3, s[12:15], s42 offen offset:0 lds
buffer_load_dwordx4 v3, s[16:19], s43 offen offset:1024 lds
s_waitcnt vmcnt(16)
s_barrier
v_add_u32 v8, 128, v8
v_add_u32 v9, 128, v9
s_add_u32 m0, s84, 20480
s_nop 0
buffer_load_dwordx4 v8, s[8:11], s68 offen offset:0 lds
buffer_load_dwordx4 v8, s[8:11], s69 offen offset:1024 lds
buffer_load_dwordx4 v8, s[8:11], s70 offen offset:2048 lds
buffer_load_dwordx4 v8, s[8:11], s71 offen offset:3072 lds
s_add_u32 m0, s84, 25600
s_nop 0
buffer_load_dwordx4 v9, s[8:11], s68 offen offset:0 lds
buffer_load_dwordx4 v9, s[8:11], s69 offen offset:1024 lds
buffer_load_dwordx4 v9, s[8:11], s70 offen offset:2048 lds
buffer_load_dwordx4 v9, s[8:11], s71 offen offset:3072 lds
s_waitcnt vmcnt(12)
s_barrier
v_add_u32 v2, s88, v2
v_add_u32 v3, s88, v3
s_add_u32 m0, s83, 12288
s_nop 0
buffer_load_dwordx4 v2, s[12:15], s4 offen offset:0 lds
buffer_load_dwordx4 v2, s[16:19], s5 offen offset:1024 lds
buffer_load_dwordx4 v2, s[12:15], s6 offen offset:2048 lds
buffer_load_dwordx4 v2, s[16:19], s7 offen offset:3072 lds
s_add_u32 m0, s83, 61440
s_nop 0
buffer_load_dwordx4 v3, s[12:15], s4 offen offset:0 lds
buffer_load_dwordx4 v3, s[16:19], s5 offen offset:1024 lds
buffer_load_dwordx4 v3, s[12:15], s6 offen offset:2048 lds
buffer_load_dwordx4 v3, s[16:19], s7 offen offset:3072 lds
s_add_u32 m0, s83, 16384
s_nop 0
buffer_load_dwordx4 v2, s[12:15], s42 offen offset:0 lds
buffer_load_dwordx4 v2, s[16:19], s43 offen offset:1024 lds
s_add_u32 m0, s83, 65536
s_nop 0
buffer_load_dwordx4 v3, s[12:15], s42 offen offset:0 lds
buffer_load_dwordx4 v3, s[16:19], s43 offen offset:1024 lds
v_add_u32 v2, s88, v2
v_add_u32 v3, s88, v3
s_add_u32 m0, s83, 18432
s_nop 0
buffer_load_dwordx4 v2, s[12:15], s4 offen offset:0 lds
buffer_load_dwordx4 v2, s[16:19], s5 offen offset:1024 lds
buffer_load_dwordx4 v2, s[12:15], s6 offen offset:2048 lds
buffer_load_dwordx4 v2, s[16:19], s7 offen offset:3072 lds
s_add_u32 m0, s83, 67584
s_nop 0
buffer_load_dwordx4 v3, s[12:15], s4 offen offset:0 lds
buffer_load_dwordx4 v3, s[16:19], s5 offen offset:1024 lds
buffer_load_dwordx4 v3, s[12:15], s6 offen offset:2048 lds
buffer_load_dwordx4 v3, s[16:19], s7 offen offset:3072 lds
s_add_u32 m0, s83, 22528
s_nop 0
buffer_load_dwordx4 v2, s[12:15], s42 offen offset:0 lds
buffer_load_dwordx4 v2, s[16:19], s43 offen offset:1024 lds
s_waitcnt vmcnt(14)
s_barrier
s_add_u32 m0, s83, 71680
s_nop 0
buffer_load_dwordx4 v3, s[12:15], s42 offen offset:0 lds
buffer_load_dwordx4 v3, s[16:19], s43 offen offset:1024 lds
v_add_u32 v8, 128, v8
v_add_u32 v9, 128, v9
s_add_u32 m0, s84, 0
s_nop 0
buffer_load_dwordx4 v8, s[8:11], s68 offen offset:0 lds
buffer_load_dwordx4 v8, s[8:11], s69 offen offset:1024 lds
buffer_load_dwordx4 v8, s[8:11], s70 offen offset:2048 lds
buffer_load_dwordx4 v8, s[8:11], s71 offen offset:3072 lds
s_add_u32 m0, s84, 5120
s_nop 0
buffer_load_dwordx4 v9, s[8:11], s68 offen offset:0 lds
buffer_load_dwordx4 v9, s[8:11], s69 offen offset:1024 lds
buffer_load_dwordx4 v9, s[8:11], s70 offen offset:2048 lds
buffer_load_dwordx4 v9, s[8:11], s71 offen offset:3072 lds
v_add_u32 v2, s88, v2
v_add_u32 v3, s88, v3
s_add_u32 m0, s83, 0
s_nop 0
buffer_load_dwordx4 v2, s[12:15], s4 offen offset:0 lds
buffer_load_dwordx4 v2, s[16:19], s5 offen offset:1024 lds
buffer_load_dwordx4 v2, s[12:15], s6 offen offset:2048 lds
buffer_load_dwordx4 v2, s[16:19], s7 offen offset:3072 lds
s_add_u32 m0, s83, 49152
s_nop 0
buffer_load_dwordx4 v3, s[12:15], s4 offen offset:0 lds
buffer_load_dwordx4 v3, s[16:19], s5 offen offset:1024 lds
buffer_load_dwordx4 v3, s[12:15], s6 offen offset:2048 lds
buffer_load_dwordx4 v3, s[16:19], s7 offen offset:3072 lds
s_waitcnt vmcnt(20)
s_barrier
s_add_u32 m0, s83, 4096
s_nop 0
buffer_load_dwordx4 v2, s[12:15], s42 offen offset:0 lds
buffer_load_dwordx4 v2, s[16:19], s43 offen offset:1024 lds
s_add_u32 m0, s83, 53248
s_nop 0
buffer_load_dwordx4 v3, s[12:15], s42 offen offset:0 lds
buffer_load_dwordx4 v3, s[16:19], s43 offen offset:1024 lds
v_add_u32 v2, s88, v2
v_add_u32 v3, s88, v3
s_add_u32 m0, s83, 6144
s_nop 0
buffer_load_dwordx4 v2, s[12:15], s4 offen offset:0 lds
buffer_load_dwordx4 v2, s[16:19], s5 offen offset:1024 lds
buffer_load_dwordx4 v2, s[12:15], s6 offen offset:2048 lds
buffer_load_dwordx4 v2, s[16:19], s7 offen offset:3072 lds
s_add_u32 m0, s83, 55296
s_nop 0
buffer_load_dwordx4 v3, s[12:15], s4 offen offset:0 lds
buffer_load_dwordx4 v3, s[16:19], s5 offen offset:1024 lds
buffer_load_dwordx4 v3, s[12:15], s6 offen offset:2048 lds
buffer_load_dwordx4 v3, s[16:19], s7 offen offset:3072 lds
s_add_u32 m0, s83, 10240
s_nop 0
buffer_load_dwordx4 v2, s[12:15], s42 offen offset:0 lds
buffer_load_dwordx4 v2, s[16:19], s43 offen offset:1024 lds
s_add_u32 m0, s83, 59392
s_nop 0
buffer_load_dwordx4 v3, s[12:15], s42 offen offset:0 lds
buffer_load_dwordx4 v3, s[16:19], s43 offen offset:1024 lds
s_waitcnt vmcnt(16)
s_barrier
v_add_u32 v8, 128, v8
v_add_u32 v9, 128, v9
s_add_u32 m0, s84, 20480
s_nop 0
buffer_load_dwordx4 v8, s[8:11], s68 offen offset:0 lds
buffer_load_dwordx4 v8, s[8:11], s69 offen offset:1024 lds
buffer_load_dwordx4 v8, s[8:11], s70 offen offset:2048 lds
buffer_load_dwordx4 v8, s[8:11], s71 offen offset:3072 lds
s_add_u32 m0, s84, 25600
s_nop 0
buffer_load_dwordx4 v9, s[8:11], s68 offen offset:0 lds
buffer_load_dwordx4 v9, s[8:11], s69 offen offset:1024 lds
buffer_load_dwordx4 v9, s[8:11], s70 offen offset:2048 lds
buffer_load_dwordx4 v9, s[8:11], s71 offen offset:3072 lds
v_add_u32 v2, s88, v2
v_add_u32 v3, s88, v3
s_add_u32 m0, s83, 12288
s_nop 0
buffer_load_dwordx4 v2, s[12:15], s4 offen offset:0 lds
buffer_load_dwordx4 v2, s[16:19], s5 offen offset:1024 lds
buffer_load_dwordx4 v2, s[12:15], s6 offen offset:2048 lds
buffer_load_dwordx4 v2, s[16:19], s7 offen offset:3072 lds
s_add_u32 m0, s83, 61440
s_nop 0
buffer_load_dwordx4 v3, s[12:15], s4 offen offset:0 lds
buffer_load_dwordx4 v3, s[16:19], s5 offen offset:1024 lds
buffer_load_dwordx4 v3, s[12:15], s6 offen offset:2048 lds
buffer_load_dwordx4 v3, s[16:19], s7 offen offset:3072 lds
s_waitcnt vmcnt(20)
s_barrier
s_add_u32 m0, s83, 16384
s_nop 0
buffer_load_dwordx4 v2, s[12:15], s42 offen offset:0 lds
buffer_load_dwordx4 v2, s[16:19], s43 offen offset:1024 lds
s_add_u32 m0, s83, 65536
s_nop 0
buffer_load_dwordx4 v3, s[12:15], s42 offen offset:0 lds
buffer_load_dwordx4 v3, s[16:19], s43 offen offset:1024 lds
v_add_u32 v2, s88, v2
v_add_u32 v3, s88, v3
s_add_u32 m0, s83, 18432
s_nop 0
buffer_load_dwordx4 v2, s[12:15], s4 offen offset:0 lds
buffer_load_dwordx4 v2, s[16:19], s5 offen offset:1024 lds
buffer_load_dwordx4 v2, s[12:15], s6 offen offset:2048 lds
buffer_load_dwordx4 v2, s[16:19], s7 offen offset:3072 lds
s_add_u32 m0, s83, 67584
s_nop 0
buffer_load_dwordx4 v3, s[12:15], s4 offen offset:0 lds
buffer_load_dwordx4 v3, s[16:19], s5 offen offset:1024 lds
buffer_load_dwordx4 v3, s[12:15], s6 offen offset:2048 lds
buffer_load_dwordx4 v3, s[16:19], s7 offen offset:3072 lds
s_add_u32 m0, s83, 22528
s_nop 0
buffer_load_dwordx4 v2, s[12:15], s42 offen offset:0 lds
buffer_load_dwordx4 v2, s[16:19], s43 offen offset:1024 lds
s_add_u32 m0, s83, 71680
s_nop 0
buffer_load_dwordx4 v3, s[12:15], s42 offen offset:0 lds
buffer_load_dwordx4 v3, s[16:19], s43 offen offset:1024 lds
s_waitcnt vmcnt(16)
s_barrier
v_add_u32 v8, 128, v8
v_add_u32 v9, 128, v9
s_add_u32 m0, s84, 0
s_nop 0
buffer_load_dwordx4 v8, s[8:11], s68 offen offset:0 lds
buffer_load_dwordx4 v8, s[8:11], s69 offen offset:1024 lds
buffer_load_dwordx4 v8, s[8:11], s70 offen offset:2048 lds
buffer_load_dwordx4 v8, s[8:11], s71 offen offset:3072 lds
s_add_u32 m0, s84, 5120
s_nop 0
buffer_load_dwordx4 v9, s[8:11], s68 offen offset:0 lds
buffer_load_dwordx4 v9, s[8:11], s69 offen offset:1024 lds
buffer_load_dwordx4 v9, s[8:11], s70 offen offset:2048 lds
buffer_load_dwordx4 v9, s[8:11], s71 offen offset:3072 lds
v_add_u32 v2, s88, v2
v_add_u32 v3, s88, v3
s_add_u32 m0, s83, 0
s_nop 0
buffer_load_dwordx4 v2, s[12:15], s4 offen offset:0 lds
buffer_load_dwordx4 v2, s[16:19], s5 offen offset:1024 lds
buffer_load_dwordx4 v2, s[12:15], s6 offen offset:2048 lds
buffer_load_dwordx4 v2, s[16:19], s7 offen offset:3072 lds
s_add_u32 m0, s83, 49152
s_nop 0
buffer_load_dwordx4 v3, s[12:15], s4 offen offset:0 lds
buffer_load_dwordx4 v3, s[16:19], s5 offen offset:1024 lds
buffer_load_dwordx4 v3, s[12:15], s6 offen offset:2048 lds
buffer_load_dwordx4 v3, s[16:19], s7 offen offset:3072 lds
s_mov_b32 s73, 1
s_and_b32 s66, s2, 1
s_lshl_b32 s66, s66, 6
s_add_u32 s66, s66, 4
s_cmp_lg_u32 s86, 0
s_cselect_b64 vcc, 1, 0
s_waitcnt vmcnt(20)
s_barrier
s_cbranch_vccnz L_sk1
s_atomic_add s73, s[52:53], s66 glc
L_sk1:
s_add_u32 m0, s83, 4096
s_nop 0
buffer_load_dwordx4 v2, s[12:15], s42 offen offset:0 lds
buffer_load_dwordx4 v2, s[16:19], s43 offen offset:1024 lds
s_add_u32 m0, s83, 53248
s_nop 0
buffer_load_dwordx4 v3, s[12:15], s42 offen offset:0 lds
buffer_load_dwordx4 v3, s[16:19], s43 offen offset:1024 lds
v_add_u32 v2, s88, v2
v_add_u32 v3, s88, v3
s_add_u32 m0, s83, 6144
s_nop 0
buffer_load_dwordx4 v2, s[12:15], s4 offen offset:0 lds
buffer_load_dwordx4 v2, s[16:19], s5 offen offset:1024 lds
buffer_load_dwordx4 v2, s[12:15], s6 offen offset:2048 lds
buffer_load_dwordx4 v2, s[16:19], s7 offen offset:3072 lds
s_add_u32 m0, s83, 55296
s_nop 0
buffer_load_dwordx4 v3, s[12:15], s4 offen offset:0 lds
buffer_load_dwordx4 v3, s[16:19], s5 offen offset:1024 lds
buffer_load_dwordx4 v3, s[12:15], s6 offen offset:2048 lds
buffer_load_dwordx4 v3, s[16:19], s7 offen offset:3072 lds
s_add_u32 m0, s83, 10240
s_nop 0
buffer_load_dwordx4 v2, s[12:15], s42 offen offset:0 lds
buffer_load_dwordx4 v2, s[16:19], s43 offen offset:1024 lds
s_add_u32 m0, s83, 59392
s_nop 0
buffer_load_dwordx4 v3, s[12:15], s42 offen offset:0 lds
buffer_load_dwordx4 v3, s[16:19], s43 offen offset:1024 lds
s_getreg_b32 s60, hwreg(HW_REG_IB_STS, 8, 4)
s_cmp_lg_u32 s60, 0
s_cbranch_scc1 L_sk2
s_waitcnt lgkmcnt(0)
s_cmp_lg_u32 s73, 71
s_cbranch_scc1 L_sk2
s_mov_b32 s75, 1
s_mov_b32 s73, 0
s_atomic_add s75, s[52:53], 128
L_sk2:
s_waitcnt vmcnt(16)
s_barrier
s_getreg_b32 s60, hwreg(HW_REG_IB_STS, 8, 4)
s_cmp_lg_u32 s60, 0
s_cbranch_scc1 L_sk3
s_waitcnt lgkmcnt(0)
s_cmp_lg_u32 s73, 71
s_cbranch_scc1 L_sk3
s_mov_b32 s75, 1
s_mov_b32 s73, 0
s_atomic_add s75, s[52:53], 128
L_sk3:
v_add_u32 v8, 128, v8
v_add_u32 v9, 128, v9
s_add_u32 m0, s84, 20480
s_nop 0
buffer_load_dwordx4 v8, s[8:11], s68 offen offset:0 lds
buffer_load_dwordx4 v8, s[8:11], s69 offen offset:1024 lds
buffer_load_dwordx4 v8, s[8:11], s70 offen offset:2048 lds
buffer_load_dwordx4 v8, s[8:11], s71 offen offset:3072 lds
s_add_u32 m0, s84, 25600
s_nop 0
buffer_load_dwordx4 v9, s[8:11], s68 offen offset:0 lds
buffer_load_dwordx4 v9, s[8:11], s69 offen offset:1024 lds
buffer_load_dwordx4 v9, s[8:11], s70 offen offset:2048 lds
buffer_load_dwordx4 v9, s[8:11], s71 offen offset:3072 lds
v_add_u32 v2, s88, v2
v_add_u32 v3, s88, v3
s_add_u32 m0, s83, 12288
s_nop 0
buffer_load_dwordx4 v2, s[12:15], s4 offen offset:0 lds
buffer_load_dwordx4 v2, s[16:19], s5 offen offset:1024 lds
buffer_load_dwordx4 v2, s[12:15], s6 offen offset:2048 lds
buffer_load_dwordx4 v2, s[16:19], s7 offen offset:3072 lds
s_add_u32 m0, s83, 61440
s_nop 0
buffer_load_dwordx4 v3, s[12:15], s4 offen offset:0 lds
buffer_load_dwordx4 v3, s[16:19], s5 offen offset:1024 lds
buffer_load_dwordx4 v3, s[12:15], s6 offen offset:2048 lds
buffer_load_dwordx4 v3, s[16:19], s7 offen offset:3072 lds
s_getreg_b32 s60, hwreg(HW_REG_IB_STS, 8, 4)
s_cmp_lg_u32 s60, 0
s_cbranch_scc1 L_sk4
s_waitcnt lgkmcnt(0)
s_cmp_lg_u32 s73, 71
s_cbranch_scc1 L_sk4
s_mov_b32 s75, 1
s_mov_b32 s73, 0
s_atomic_add s75, s[52:53], 128
L_sk4:
s_waitcnt vmcnt(20)
s_barrier
s_getreg_b32 s60, hwreg(HW_REG_IB_STS, 8, 4)
s_cmp_lg_u32 s60, 0
s_cbranch_scc1 L_sk5
s_waitcnt lgkmcnt(0)
s_cmp_lg_u32 s73, 71
s_cbranch_scc1 L_sk5
s_mov_b32 s75, 1
s_mov_b32 s73, 0
s_atomic_add s75, s[52:53], 128
L_sk5:
s_add_u32 m0, s83, 16384
s_nop 0
buffer_load_dwordx4 v2, s[12:15], s42 offen offset:0 lds
buffer_load_dwordx4 v2, s[16:19], s43 offen offset:1024 lds
s_add_u32 m0, s83, 65536
s_nop 0
buffer_load_dwordx4 v3, s[12:15], s42 offen offset:0 lds
buffer_load_dwordx4 v3, s[16:19], s43 offen offset:1024 lds
v_add_u32 v2, s88, v2
v_add_u32 v3, s88, v3
s_add_u32 m0, s83, 18432
s_nop 0
buffer_load_dwordx4 v2, s[12:15], s4 offen offset:0 lds
buffer_load_dwordx4 v2, s[16:19], s5 offen offset:1024 lds
buffer_load_dwordx4 v2, s[12:15], s6 offen offset:2048 lds
buffer_load_dwordx4 v2, s[16:19], s7 offen offset:3072 lds
s_add_u32 m0, s83, 67584
s_nop 0
buffer_load_dwordx4 v3, s[12:15], s4 offen offset:0 lds
buffer_load_dwordx4 v3, s[16:19], s5 offen offset:1024 lds
buffer_load_dwordx4 v3, s[12:15], s6 offen offset:2048 lds
buffer_load_dwordx4 v3, s[16:19], s7 offen offset:3072 lds
s_add_u32 m0, s83, 22528
s_nop 0
buffer_load_dwordx4 v2, s[12:15], s42 offen offset:0 lds
buffer_load_dwordx4 v2, s[16:19], s43 offen offset:1024 lds
s_add_u32 m0, s83, 71680
s_nop 0
buffer_load_dwordx4 v3, s[12:15], s42 offen offset:0 lds
buffer_load_dwordx4 v3, s[16:19], s43 offen offset:1024 lds
s_waitcnt lgkmcnt(0)
s_cmp_lg_u32 s73, 71
s_cbranch_scc1 L_sk6
s_mov_b32 s75, 1
s_mov_b32 s73, 0
s_atomic_add s75, s[52:53], 128
L_sk6:
s_waitcnt vmcnt(16)
s_barrier
v_add_u32 v8, 128, v8
v_add_u32 v9, 128, v9
s_add_u32 m0, s84, 0
s_nop 0
buffer_load_dwordx4 v8, s[8:11], s68 offen offset:0 lds
buffer_load_dwordx4 v8, s[8:11], s69 offen offset:1024 lds
buffer_load_dwordx4 v8, s[8:11], s70 offen offset:2048 lds
buffer_load_dwordx4 v8, s[8:11], s71 offen offset:3072 lds
s_add_u32 m0, s84, 5120
s_nop 0
buffer_load_dwordx4 v9, s[8:11], s68 offen offset:0 lds
buffer_load_dwordx4 v9, s[8:11], s69 offen offset:1024 lds
buffer_load_dwordx4 v9, s[8:11], s70 offen offset:2048 lds
buffer_load_dwordx4 v9, s[8:11], s71 offen offset:3072 lds
v_add_u32 v2, s88, v2
v_add_u32 v3, s88, v3
s_add_u32 m0, s83, 0
s_nop 0
buffer_load_dwordx4 v2, s[12:15], s4 offen offset:0 lds
buffer_load_dwordx4 v2, s[16:19], s5 offen offset:1024 lds
buffer_load_dwordx4 v2, s[12:15], s6 offen offset:2048 lds
buffer_load_dwordx4 v2, s[16:19], s7 offen offset:3072 lds
s_add_u32 m0, s83, 49152
s_nop 0
buffer_load_dwordx4 v3, s[12:15], s4 offen offset:0 lds
buffer_load_dwordx4 v3, s[16:19], s5 offen offset:1024 lds
buffer_load_dwordx4 v3, s[12:15], s6 offen offset:2048 lds
buffer_load_dwordx4 v3, s[16:19], s7 offen offset:3072 lds
s_waitcnt vmcnt(20)
s_barrier
s_add_u32 m0, s83, 4096
s_nop 0
buffer_load_dwordx4 v2, s[12:15], s42 offen offset:0 lds
buffer_load_dwordx4 v2, s[16:19], s43 offen offset:1024 lds
s_add_u32 m0, s83, 53248
s_nop 0
buffer_load_dwordx4 v3, s[12:15], s42 offen offset:0 lds
buffer_load_dwordx4 v3, s[16:19], s43 offen offset:1024 lds
v_add_u32 v2, s88, v2
v_add_u32 v3, s88, v3
s_add_u32 m0, s83, 6144
s_nop 0
buffer_load_dwordx4 v2, s[12:15], s4 offen offset:0 lds
buffer_load_dwordx4 v2, s[16:19], s5 offen offset:1024 lds
buffer_load_dwordx4 v2, s[12:15], s6 offen offset:2048 lds
buffer_load_dwordx4 v2, s[16:19], s7 offen offset:3072 lds
s_add_u32 m0, s83, 55296
s_nop 0
buffer_load_dwordx4 v3, s[12:15], s4 offen offset:0 lds
buffer_load_dwordx4 v3, s[16:19], s5 offen offset:1024 lds
buffer_load_dwordx4 v3, s[12:15], s6 offen offset:2048 lds
buffer_load_dwordx4 v3, s[16:19], s7 offen offset:3072 lds
s_add_u32 m0, s83, 10240
s_nop 0
buffer_load_dwordx4 v2, s[12:15], s42 offen offset:0 lds
buffer_load_dwordx4 v2, s[16:19], s43 offen offset:1024 lds
s_add_u32 m0, s83, 59392
s_nop 0
buffer_load_dwordx4 v3, s[12:15], s42 offen offset:0 lds
buffer_load_dwordx4 v3, s[16:19], s43 offen offset:1024 lds
s_waitcnt vmcnt(16)
s_barrier
v_add_u32 v8, 128, v8
v_add_u32 v9, 128, v9
s_add_u32 m0, s84, 20480
s_nop 0
buffer_load_dwordx4 v8, s[8:11], s68 offen offset:0 lds
buffer_load_dwordx4 v8, s[8:11], s69 offen offset:1024 lds
buffer_load_dwordx4 v8, s[8:11], s70 offen offset:2048 lds
buffer_load_dwordx4 v8, s[8:11], s71 offen offset:3072 lds
s_add_u32 m0, s84, 25600
s_nop 0
buffer_load_dwordx4 v9, s[8:11], s68 offen offset:0 lds
buffer_load_dwordx4 v9, s[8:11], s69 offen offset:1024 lds
buffer_load_dwordx4 v9, s[8:11], s70 offen offset:2048 lds
buffer_load_dwordx4 v9, s[8:11], s71 offen offset:3072 lds
v_add_u32 v2, s88, v2
v_add_u32 v3, s88, v3
s_add_u32 m0, s83, 12288
s_nop 0
buffer_load_dwordx4 v2, s[12:15], s4 offen offset:0 lds
buffer_load_dwordx4 v2, s[16:19], s5 offen offset:1024 lds
buffer_load_dwordx4 v2, s[12:15], s6 offen offset:2048 lds
buffer_load_dwordx4 v2, s[16:19], s7 offen offset:3072 lds
s_add_u32 m0, s83, 61440
s_nop 0
buffer_load_dwordx4 v3, s[12:15], s4 offen offset:0 lds
buffer_load_dwordx4 v3, s[16:19], s5 offen offset:1024 lds
buffer_load_dwordx4 v3, s[12:15], s6 offen offset:2048 lds
buffer_load_dwordx4 v3, s[16:19], s7 offen offset:3072 lds
s_waitcnt vmcnt(20)
s_barrier
s_add_u32 m0, s83, 16384
s_nop 0
buffer_load_dwordx4 v2, s[12:15], s42 offen offset:0 lds
buffer_load_dwordx4 v2, s[16:19], s43 offen offset:1024 lds
s_add_u32 m0, s83, 65536
s_nop 0
buffer_load_dwordx4 v3, s[12:15], s42 offen offset:0 lds
buffer_load_dwordx4 v3, s[16:19], s43 offen offset:1024 lds
v_add_u32 v2, s88, v2
v_add_u32 v3, s88, v3
s_add_u32 m0, s83, 18432
s_nop 0
buffer_load_dwordx4 v2, s[12:15], s4 offen offset:0 lds
buffer_load_dwordx4 v2, s[16:19], s5 offen offset:1024 lds
buffer_load_dwordx4 v2, s[12:15], s6 offen offset:2048 lds
buffer_load_dwordx4 v2, s[16:19], s7 offen offset:3072 lds
s_add_u32 m0, s83, 67584
s_nop 0
buffer_load_dwordx4 v3, s[12:15], s4 offen offset:0 lds
buffer_load_dwordx4 v3, s[16:19], s5 offen offset:1024 lds
buffer_load_dwordx4 v3, s[12:15], s6 offen offset:2048 lds
buffer_load_dwordx4 v3, s[16:19], s7 offen offset:3072 lds
s_add_u32 m0, s83, 22528
s_nop 0
buffer_load_dwordx4 v2, s[12:15], s42 offen offset:0 lds
buffer_load_dwordx4 v2, s[16:19], s43 offen offset:1024 lds
s_add_u32 m0, s83, 71680
s_nop 0
buffer_load_dwordx4 v3, s[12:15], s42 offen offset:0 lds
buffer_load_dwordx4 v3, s[16:19], s43 offen offset:1024 lds
s_mov_b64 s[20:21], s[54:55]
s_mov_b32 s22, 25165824
s_mov_b32 s23, 0x20000
v_lshlrev_b32 v14, 4, v0
s_and_b32 s60, s2, 7
s_lshr_b32 s61, s2, 6
s_lshl_b32 s60, s60, 2
s_add_u32 s60, s60, s61
s_bfe_u32 s61, s2, 0x30003
s_sub_u32 s62, s56, 2
s_cmp_lt_u32 s56, 4
s_cselect_b32 s62, s56, s62
s_mul_i32 s62, s62, 9
s_add_u32 s62, s62, 20
s_sub_u32 s63, s56, 4
s_mul_i32 s67, s63, 10
s_cmp_lt_u32 s63, 2
s_cselect_b32 s62, s67, s62
s_mul_i32 s67, s60, 74
s_add_u32 s67, s67, s62
s_lshl_b32 s67, s67, 12
s_add_u32 s90, s67, 4194304
s_mul_i32 s67, s61, 74
s_add_u32 s67, s67, s62
s_mul_i32 s67, s67, 5120
s_add_u32 s91, s67, 1048576
s_mul_i32 s67, s61, 378880
s_add_u32 s77, s67, 1150976
s_mul_i32 s92, s60, 81920
s_mul_i32 s67, s61, 160
s_add_u32 s92, s92, s67
s_sub_u32 s62, s56, 2
s_cmp_lt_u32 s56, 4
s_cselect_b32 s62, s56, s62
s_mul_i32 s89, s60, 6
s_add_u32 s89, s89, s62
s_lshl_b32 s89, s89, 7
s_add_u32 s89, s89, 262144
s_waitcnt vmcnt(16)
s_barrier
s_waitcnt vmcnt(10)
s_add_u32 s85, s91, 0
buffer_load_dwordx4 v[240:243], v14, s[20:23], s85 offen offset:0 sc1
s_waitcnt vmcnt(10)
s_add_u32 s85, s91, 0
buffer_load_dwordx4 v[244:247], v14, s[20:23], s85 offen offset:1024 sc1
s_waitcnt vmcnt(10)
s_add_u32 s85, s91, 0
buffer_load_dwordx4 v[248:251], v14, s[20:23], s85 offen offset:2048 sc1
s_waitcnt vmcnt(10)
s_add_u32 s85, s91, 0
buffer_load_dwordx4 v[252:255], v14, s[20:23], s85 offen offset:3072 sc1
s_waitcnt vmcnt(10)
s_add_u32 s85, s91, 4096
buffer_load_dwordx4 v[172:175], v14, s[20:23], s85 offen offset:0 sc1
s_waitcnt vmcnt(10)
s_add_u32 s85, s91, 4096
buffer_load_dwordx4 v[168:171], v14, s[20:23], s85 offen offset:1024 sc1
s_waitcnt vmcnt(10)
s_barrier
s_waitcnt vmcnt(8)
s_add_u32 s85, s91, 4096
buffer_load_dwordx4 v[164:167], v14, s[20:23], s85 offen offset:2048 sc1
s_waitcnt vmcnt(8)
s_add_u32 s85, s91, 4096
buffer_load_dwordx4 v[160:163], v14, s[20:23], s85 offen offset:3072 sc1
s_waitcnt vmcnt(8)
s_add_u32 s85, s91, 8192
buffer_load_dwordx4 v[156:159], v14, s[20:23], s85 offen offset:0 sc1
s_waitcnt vmcnt(8)
s_add_u32 s85, s91, 8192
buffer_load_dwordx4 v[152:155], v14, s[20:23], s85 offen offset:1024 sc1
s_waitcnt vmcnt(8)
s_add_u32 s85, s91, 8192
buffer_load_dwordx4 v[148:151], v14, s[20:23], s85 offen offset:2048 sc1
s_waitcnt vmcnt(8)
s_add_u32 s85, s91, 8192
buffer_load_dwordx4 v[144:147], v14, s[20:23], s85 offen offset:3072 sc1
s_waitcnt vmcnt(8)
s_add_u32 s85, s91, 12288
buffer_load_dwordx4 v[140:143], v14, s[20:23], s85 offen offset:0 sc1
s_waitcnt vmcnt(8)
s_add_u32 s85, s91, 12288
buffer_load_dwordx4 v[136:139], v14, s[20:23], s85 offen offset:1024 sc1
s_waitcnt vmcnt(8)
s_add_u32 s85, s91, 12288
buffer_load_dwordx4 v[132:135], v14, s[20:23], s85 offen offset:2048 sc1
s_waitcnt vmcnt(8)
s_add_u32 s85, s91, 12288
buffer_load_dwordx4 v[128:131], v14, s[20:23], s85 offen offset:3072 sc1
s_waitcnt vmcnt(8)
s_add_u32 s85, s91, 16384
buffer_load_dwordx4 v[124:127], v14, s[20:23], s85 offen offset:0 sc1
s_waitcnt vmcnt(8)
s_add_u32 s85, s91, 16384
buffer_load_dwordx4 v[120:123], v14, s[20:23], s85 offen offset:1024 sc1
s_waitcnt vmcnt(8)
s_add_u32 s85, s91, 16384
buffer_load_dwordx4 v[116:119], v14, s[20:23], s85 offen offset:2048 sc1
s_waitcnt vmcnt(8)
s_add_u32 s85, s91, 16384
buffer_load_dwordx4 v[112:115], v14, s[20:23], s85 offen offset:3072 sc1
s_waitcnt vmcnt(8)
s_add_u32 s85, s91, 20480
buffer_load_dwordx4 v[108:111], v14, s[20:23], s85 offen offset:0 sc1
s_waitcnt vmcnt(8)
s_add_u32 s85, s91, 20480
buffer_load_dwordx4 v[104:107], v14, s[20:23], s85 offen offset:1024 sc1
s_waitcnt vmcnt(8)
s_add_u32 s85, s91, 20480
buffer_load_dwordx4 v[100:103], v14, s[20:23], s85 offen offset:2048 sc1
s_waitcnt vmcnt(8)
s_add_u32 s85, s91, 20480
buffer_load_dwordx4 v[96:99], v14, s[20:23], s85 offen offset:3072 sc1
s_waitcnt vmcnt(8)
s_add_u32 s85, s91, 24576
buffer_load_dwordx4 v[92:95], v14, s[20:23], s85 offen offset:0 sc1
s_waitcnt vmcnt(8)
s_add_u32 s85, s91, 24576
buffer_load_dwordx4 v[88:91], v14, s[20:23], s85 offen offset:1024 sc1
s_barrier
s_mov_b64 s[8:9], s[36:37]
s_mov_b32 s10, 2621440
s_mov_b32 s11, 0x20000
s_mul_i32 s83, s86, 24576
s_mul_i32 s84, s86, 46080
s_add_u32 s84, s84, s77
s_waitcnt vmcnt(8)
s_add_u32 s85, s91, 24576
buffer_load_dwordx4 v[84:87], v14, s[20:23], s85 offen offset:2048 sc1
s_waitcnt vmcnt(8)
s_add_u32 s85, s91, 24576
buffer_load_dwordx4 v[80:83], v14, s[20:23], s85 offen offset:3072 sc1
s_waitcnt vmcnt(8)
s_add_u32 s85, s91, 28672
buffer_load_dwordx4 v[76:79], v14, s[20:23], s85 offen offset:0 sc1
s_waitcnt vmcnt(8)
s_add_u32 s85, s91, 28672
buffer_load_dwordx4 v[72:75], v14, s[20:23], s85 offen offset:1024 sc1
s_lshl_b32 s61, s81, 14
s_add_u32 s61, s61, 98304
s_add_u32 m0, s61, 0
s_add_u32 s85, s91, 30720
s_waitcnt vmcnt(8)
buffer_load_dwordx4 v14, s[20:23], s85 offen offset:0 sc1 lds
s_waitcnt vmcnt(8)
buffer_load_dwordx4 v14, s[20:23], s85 offen offset:1024 sc1 lds
s_waitcnt vmcnt(8)
buffer_load_dwordx4 v14, s[20:23], s85 offen offset:2048 sc1 lds
s_waitcnt vmcnt(8)
buffer_load_dwordx4 v14, s[20:23], s85 offen offset:3072 sc1 lds
s_add_u32 m0, s61, 4096
s_add_u32 s85, s91, 34816
s_waitcnt vmcnt(8)
buffer_load_dwordx4 v14, s[20:23], s85 offen offset:0 sc1 lds
s_waitcnt vmcnt(8)
buffer_load_dwordx4 v14, s[20:23], s85 offen offset:1024 sc1 lds
s_waitcnt vmcnt(8)
buffer_load_dwordx4 v14, s[20:23], s85 offen offset:2048 sc1 lds
s_waitcnt vmcnt(8)
buffer_load_dwordx4 v14, s[20:23], s85 offen offset:3072 sc1 lds
s_add_u32 m0, s61, 8192
s_add_u32 s85, s91, 38912
s_waitcnt vmcnt(8)
buffer_load_dwordx4 v14, s[20:23], s85 offen offset:0 sc1 lds
s_waitcnt vmcnt(8)
buffer_load_dwordx4 v14, s[20:23], s85 offen offset:1024 sc1 lds
s_waitcnt vmcnt(8)
buffer_load_dwordx4 v14, s[20:23], s85 offen offset:2048 sc1 lds
s_waitcnt vmcnt(8)
buffer_load_dwordx4 v14, s[20:23], s85 offen offset:3072 sc1 lds
s_add_u32 m0, s61, 12288
s_add_u32 s85, s91, 43008
s_waitcnt vmcnt(8)
buffer_load_dwordx4 v14, s[20:23], s85 offen offset:0 sc1 lds
s_waitcnt vmcnt(8)
buffer_load_dwordx4 v14, s[20:23], s85 offen offset:1024 sc1 lds
s_waitcnt vmcnt(8)
buffer_load_dwordx4 v14, s[20:23], s85 offen offset:2048 sc1 lds
s_waitcnt vmcnt(8)
buffer_load_dwordx4 v14, s[20:23], s85 offen offset:3072 sc1 lds
s_barrier
s_add_u32 m0, s83, 12288
s_add_u32 s85, s84, 12288
s_waitcnt vmcnt(8)
buffer_load_dwordx4 v14, s[20:23], s85 offen offset:0 sc1 lds
s_waitcnt vmcnt(8)
buffer_load_dwordx4 v14, s[20:23], s85 offen offset:1024 sc1 lds
s_waitcnt vmcnt(8)
buffer_load_dwordx4 v14, s[20:23], s85 offen offset:2048 sc1 lds
s_waitcnt vmcnt(8)
buffer_load_dwordx4 v14, s[20:23], s85 offen offset:3072 sc1 lds
s_add_u32 m0, s83, 16384
s_add_u32 s85, s84, 16384
s_waitcnt vmcnt(8)
buffer_load_dwordx4 v14, s[20:23], s85 offen offset:0 sc1 lds
s_waitcnt vmcnt(8)
buffer_load_dwordx4 v14, s[20:23], s85 offen offset:1024 sc1 lds
s_add_u32 m0, s83, 61440
s_add_u32 s85, s84, 104448
s_waitcnt vmcnt(8)
buffer_load_dwordx4 v14, s[20:23], s85 offen offset:0 sc1 lds
s_waitcnt vmcnt(8)
buffer_load_dwordx4 v14, s[20:23], s85 offen offset:1024 sc1 lds
s_waitcnt vmcnt(8)
buffer_load_dwordx4 v14, s[20:23], s85 offen offset:2048 sc1 lds
s_waitcnt vmcnt(8)
buffer_load_dwordx4 v14, s[20:23], s85 offen offset:3072 sc1 lds
s_add_u32 m0, s83, 65536
s_add_u32 s85, s84, 108544
s_waitcnt vmcnt(8)
buffer_load_dwordx4 v14, s[20:23], s85 offen offset:0 sc1 lds
s_waitcnt vmcnt(8)
buffer_load_dwordx4 v14, s[20:23], s85 offen offset:1024 sc1 lds
s_add_u32 m0, s83, 18432
s_add_u32 s85, s84, 18432
s_waitcnt vmcnt(8)
buffer_load_dwordx4 v14, s[20:23], s85 offen offset:0 sc1 lds
s_waitcnt vmcnt(8)
buffer_load_dwordx4 v14, s[20:23], s85 offen offset:1024 sc1 lds
s_add_u32 m0, s83, 67584
s_add_u32 s85, s84, 110592
s_waitcnt vmcnt(8)
buffer_load_dwordx4 v14, s[20:23], s85 offen offset:0 sc1 lds
s_waitcnt vmcnt(8)
buffer_load_dwordx4 v14, s[20:23], s85 offen offset:1024 sc1 lds
s_mul_i32 s61, s81, 24576
s_add_u32 s61, s61, 4096
v_add_u32 v15, s61, v14
s_add_u32 m0, s61, 16384
s_add_u32 s85, s91, 47104
s_waitcnt vmcnt(8)
buffer_load_dwordx4 v14, s[20:23], s85 offen offset:0 sc1 lds
s_waitcnt vmcnt(8)
buffer_load_dwordx4 v14, s[20:23], s85 offen offset:1024 sc1 lds
s_waitcnt vmcnt(8)
buffer_load_dwordx4 v14, s[20:23], s85 offen offset:2048 sc1 lds
s_waitcnt vmcnt(8)
buffer_load_dwordx4 v14, s[20:23], s85 offen offset:3072 sc1 lds
s_lshl_b32 s60, s86, 2
s_add_u32 s60, s60, 146704
v_mov_b32 v4, s60
v_mov_b32 v7, 1
s_waitcnt vmcnt(4)
s_mov_b64 exec, 1
ds_write_b32 v4, v7
s_mov_b64 exec, -1
s_branch L_P2S
L_LDA:
v_add_u32 v2, s88, v2
v_add_u32 v3, s88, v3
s_add_u32 m0, s83, 6144
s_nop 0
buffer_load_dwordx4 v2, s[12:15], s4 offen offset:0 lds
buffer_load_dwordx4 v2, s[16:19], s5 offen offset:1024 lds
buffer_load_dwordx4 v2, s[12:15], s6 offen offset:2048 lds
buffer_load_dwordx4 v2, s[16:19], s7 offen offset:3072 lds
s_add_u32 m0, s83, 55296
s_nop 0
buffer_load_dwordx4 v3, s[12:15], s4 offen offset:0 lds
buffer_load_dwordx4 v3, s[16:19], s5 offen offset:1024 lds
buffer_load_dwordx4 v3, s[12:15], s6 offen offset:2048 lds
buffer_load_dwordx4 v3, s[16:19], s7 offen offset:3072 lds
s_waitcnt vmcnt(12)
s_barrier
s_add_u32 m0, s83, 10240
s_nop 0
buffer_load_dwordx4 v2, s[12:15], s42 offen offset:0 lds
buffer_load_dwordx4 v2, s[16:19], s43 offen offset:1024 lds
s_add_u32 m0, s83, 59392
s_nop 0
buffer_load_dwordx4 v3, s[12:15], s42 offen offset:0 lds
buffer_load_dwordx4 v3, s[16:19], s43 offen offset:1024 lds
v_add_u32 v8, 128, v8
v_add_u32 v9, 128, v9
s_add_u32 m0, s84, 20480
s_nop 0
buffer_load_dwordx4 v8, s[8:11], s68 offen offset:0 lds
buffer_load_dwordx4 v8, s[8:11], s69 offen offset:1024 lds
buffer_load_dwordx4 v8, s[8:11], s70 offen offset:2048 lds
buffer_load_dwordx4 v8, s[8:11], s71 offen offset:3072 lds
s_add_u32 m0, s84, 25600
s_nop 0
buffer_load_dwordx4 v9, s[8:11], s68 offen offset:0 lds
buffer_load_dwordx4 v9, s[8:11], s69 offen offset:1024 lds
buffer_load_dwordx4 v9, s[8:11], s70 offen offset:2048 lds
buffer_load_dwordx4 v9, s[8:11], s71 offen offset:3072 lds
s_add_u32 m0, s84, 24576
s_nop 0
buffer_load_dwordx4 v8, s[8:11], s72 offen offset:0 lds
s_add_u32 m0, s84, 29696
s_nop 0
buffer_load_dwordx4 v9, s[8:11], s72 offen offset:0 lds
v_add_u32 v2, s88, v2
v_add_u32 v3, s88, v3
s_add_u32 m0, s83, 12288
s_nop 0
buffer_load_dwordx4 v2, s[12:15], s4 offen offset:0 lds
buffer_load_dwordx4 v2, s[16:19], s5 offen offset:1024 lds
buffer_load_dwordx4 v2, s[12:15], s6 offen offset:2048 lds
buffer_load_dwordx4 v2, s[16:19], s7 offen offset:3072 lds
s_add_u32 m0, s83, 61440
s_nop 0
buffer_load_dwordx4 v3, s[12:15], s4 offen offset:0 lds
buffer_load_dwordx4 v3, s[16:19], s5 offen offset:1024 lds
buffer_load_dwordx4 v3, s[12:15], s6 offen offset:2048 lds
buffer_load_dwordx4 v3, s[16:19], s7 offen offset:3072 lds
s_waitcnt vmcnt(22)
s_barrier
s_add_u32 m0, s83, 16384
s_nop 0
buffer_load_dwordx4 v2, s[12:15], s42 offen offset:0 lds
buffer_load_dwordx4 v2, s[16:19], s43 offen offset:1024 lds
s_add_u32 m0, s83, 65536
s_nop 0
buffer_load_dwordx4 v3, s[12:15], s42 offen offset:0 lds
buffer_load_dwordx4 v3, s[16:19], s43 offen offset:1024 lds
v_add_u32 v2, s88, v2
v_add_u32 v3, s88, v3
s_add_u32 m0, s83, 18432
s_nop 0
buffer_load_dwordx4 v2, s[12:15], s4 offen offset:0 lds
buffer_load_dwordx4 v2, s[16:19], s5 offen offset:1024 lds
buffer_load_dwordx4 v2, s[12:15], s6 offen offset:2048 lds
buffer_load_dwordx4 v2, s[16:19], s7 offen offset:3072 lds
s_add_u32 m0, s83, 67584
s_nop 0
buffer_load_dwordx4 v3, s[12:15], s4 offen offset:0 lds
buffer_load_dwordx4 v3, s[16:19], s5 offen offset:1024 lds
buffer_load_dwordx4 v3, s[12:15], s6 offen offset:2048 lds
buffer_load_dwordx4 v3, s[16:19], s7 offen offset:3072 lds
s_add_u32 m0, s83, 22528
s_nop 0
buffer_load_dwordx4 v2, s[12:15], s42 offen offset:0 lds
buffer_load_dwordx4 v2, s[16:19], s43 offen offset:1024 lds
s_add_u32 m0, s83, 71680
s_nop 0
buffer_load_dwordx4 v3, s[12:15], s42 offen offset:0 lds
buffer_load_dwordx4 v3, s[16:19], s43 offen offset:1024 lds
s_waitcnt vmcnt(16)
s_barrier
v_add_u32 v8, 128, v8
v_add_u32 v9, 128, v9
s_add_u32 m0, s84, 0
s_nop 0
buffer_load_dwordx4 v8, s[8:11], s68 offen offset:0 lds
buffer_load_dwordx4 v8, s[8:11], s69 offen offset:1024 lds
buffer_load_dwordx4 v8, s[8:11], s70 offen offset:2048 lds
buffer_load_dwordx4 v8, s[8:11], s71 offen offset:3072 lds
s_add_u32 m0, s84, 5120
s_nop 0
buffer_load_dwordx4 v9, s[8:11], s68 offen offset:0 lds
buffer_load_dwordx4 v9, s[8:11], s69 offen offset:1024 lds
buffer_load_dwordx4 v9, s[8:11], s70 offen offset:2048 lds
buffer_load_dwordx4 v9, s[8:11], s71 offen offset:3072 lds
s_add_u32 m0, s84, 4096
s_nop 0
buffer_load_dwordx4 v8, s[8:11], s72 offen offset:0 lds
s_add_u32 m0, s84, 9216
s_nop 0
buffer_load_dwordx4 v9, s[8:11], s72 offen offset:0 lds
v_add_u32 v2, s88, v2
v_add_u32 v3, s88, v3
s_add_u32 m0, s83, 0
s_nop 0
buffer_load_dwordx4 v2, s[12:15], s4 offen offset:0 lds
buffer_load_dwordx4 v2, s[16:19], s5 offen offset:1024 lds
buffer_load_dwordx4 v2, s[12:15], s6 offen offset:2048 lds
buffer_load_dwordx4 v2, s[16:19], s7 offen offset:3072 lds
s_add_u32 m0, s83, 49152
s_nop 0
buffer_load_dwordx4 v3, s[12:15], s4 offen offset:0 lds
buffer_load_dwordx4 v3, s[16:19], s5 offen offset:1024 lds
buffer_load_dwordx4 v3, s[12:15], s6 offen offset:2048 lds
buffer_load_dwordx4 v3, s[16:19], s7 offen offset:3072 lds
s_waitcnt vmcnt(22)
s_barrier
s_add_u32 m0, s83, 4096
s_nop 0
buffer_load_dwordx4 v2, s[12:15], s42 offen offset:0 lds
buffer_load_dwordx4 v2, s[16:19], s43 offen offset:1024 lds
s_add_u32 m0, s83, 53248
s_nop 0
buffer_load_dwordx4 v3, s[12:15], s42 offen offset:0 lds
buffer_load_dwordx4 v3, s[16:19], s43 offen offset:1024 lds
v_add_u32 v2, s88, v2
v_add_u32 v3, s88, v3
s_add_u32 m0, s83, 6144
s_nop 0
buffer_load_dwordx4 v2, s[12:15], s4 offen offset:0 lds
buffer_load_dwordx4 v2, s[16:19], s5 offen offset:1024 lds
buffer_load_dwordx4 v2, s[12:15], s6 offen offset:2048 lds
buffer_load_dwordx4 v2, s[16:19], s7 offen offset:3072 lds
s_add_u32 m0, s83, 55296
s_nop 0
buffer_load_dwordx4 v3, s[12:15], s4 offen offset:0 lds
buffer_load_dwordx4 v3, s[16:19], s5 offen offset:1024 lds
buffer_load_dwordx4 v3, s[12:15], s6 offen offset:2048 lds
buffer_load_dwordx4 v3, s[16:19], s7 offen offset:3072 lds
s_add_u32 m0, s83, 10240
s_nop 0
buffer_load_dwordx4 v2, s[12:15], s42 offen offset:0 lds
buffer_load_dwordx4 v2, s[16:19], s43 offen offset:1024 lds
s_add_u32 m0, s83, 59392
s_nop 0
buffer_load_dwordx4 v3, s[12:15], s42 offen offset:0 lds
buffer_load_dwordx4 v3, s[16:19], s43 offen offset:1024 lds
s_waitcnt vmcnt(16)
s_barrier
v_add_u32 v8, 128, v8
v_add_u32 v9, 128, v9
s_add_u32 m0, s84, 20480
s_nop 0
buffer_load_dwordx4 v8, s[8:11], s68 offen offset:0 lds
buffer_load_dwordx4 v8, s[8:11], s69 offen offset:1024 lds
buffer_load_dwordx4 v8, s[8:11], s70 offen offset:2048 lds
buffer_load_dwordx4 v8, s[8:11], s71 offen offset:3072 lds
s_add_u32 m0, s84, 25600
s_nop 0
buffer_load_dwordx4 v9, s[8:11], s68 offen offset:0 lds
buffer_load_dwordx4 v9, s[8:11], s69 offen offset:1024 lds
buffer_load_dwordx4 v9, s[8:11], s70 offen offset:2048 lds
buffer_load_dwordx4 v9, s[8:11], s71 offen offset:3072 lds
s_add_u32 m0, s84, 24576
s_nop 0
buffer_load_dwordx4 v8, s[8:11], s72 offen offset:0 lds
s_add_u32 m0, s84, 29696
s_nop 0
buffer_load_dwordx4 v9, s[8:11], s72 offen offset:0 lds
v_add_u32 v2, s88, v2
v_add_u32 v3, s88, v3
s_add_u32 m0, s83, 12288
s_nop 0
buffer_load_dwordx4 v2, s[12:15], s4 offen offset:0 lds
buffer_load_dwordx4 v2, s[16:19], s5 offen offset:1024 lds
buffer_load_dwordx4 v2, s[12:15], s6 offen offset:2048 lds
buffer_load_dwordx4 v2, s[16:19], s7 offen offset:3072 lds
s_add_u32 m0, s83, 61440
s_nop 0
buffer_load_dwordx4 v3, s[12:15], s4 offen offset:0 lds
buffer_load_dwordx4 v3, s[16:19], s5 offen offset:1024 lds
buffer_load_dwordx4 v3, s[12:15], s6 offen offset:2048 lds
buffer_load_dwordx4 v3, s[16:19], s7 offen offset:3072 lds
s_waitcnt vmcnt(22)
s_barrier
s_add_u32 m0, s83, 16384
s_nop 0
buffer_load_dwordx4 v2, s[12:15], s42 offen offset:0 lds
buffer_load_dwordx4 v2, s[16:19], s43 offen offset:1024 lds
s_add_u32 m0, s83, 65536
s_nop 0
buffer_load_dwordx4 v3, s[12:15], s42 offen offset:0 lds
buffer_load_dwordx4 v3, s[16:19], s43 offen offset:1024 lds
v_add_u32 v2, s88, v2
v_add_u32 v3, s88, v3
s_add_u32 m0, s83, 18432
s_nop 0
buffer_load_dwordx4 v2, s[12:15], s4 offen offset:0 lds
buffer_load_dwordx4 v2, s[16:19], s5 offen offset:1024 lds
buffer_load_dwordx4 v2, s[12:15], s6 offen offset:2048 lds
buffer_load_dwordx4 v2, s[16:19], s7 offen offset:3072 lds
s_add_u32 m0, s83, 67584
s_nop 0
buffer_load_dwordx4 v3, s[12:15], s4 offen offset:0 lds
buffer_load_dwordx4 v3, s[16:19], s5 offen offset:1024 lds
buffer_load_dwordx4 v3, s[12:15], s6 offen offset:2048 lds
buffer_load_dwordx4 v3, s[16:19], s7 offen offset:3072 lds
s_add_u32 m0, s83, 22528
s_nop 0
buffer_load_dwordx4 v2, s[12:15], s42 offen offset:0 lds
buffer_load_dwordx4 v2, s[16:19], s43 offen offset:1024 lds
s_add_u32 m0, s83, 71680
s_nop 0
buffer_load_dwordx4 v3, s[12:15], s42 offen offset:0 lds
buffer_load_dwordx4 v3, s[16:19], s43 offen offset:1024 lds
s_waitcnt vmcnt(16)
s_barrier
v_add_u32 v8, 128, v8
v_add_u32 v9, 128, v9
s_add_u32 m0, s84, 0
s_nop 0
buffer_load_dwordx4 v8, s[8:11], s68 offen offset:0 lds
buffer_load_dwordx4 v8, s[8:11], s69 offen offset:1024 lds
buffer_load_dwordx4 v8, s[8:11], s70 offen offset:2048 lds
buffer_load_dwordx4 v8, s[8:11], s71 offen offset:3072 lds
s_add_u32 m0, s84, 5120
s_nop 0
buffer_load_dwordx4 v9, s[8:11], s68 offen offset:0 lds
buffer_load_dwordx4 v9, s[8:11], s69 offen offset:1024 lds
buffer_load_dwordx4 v9, s[8:11], s70 offen offset:2048 lds
buffer_load_dwordx4 v9, s[8:11], s71 offen offset:3072 lds
s_add_u32 m0, s84, 4096
s_nop 0
buffer_load_dwordx4 v8, s[8:11], s72 offen offset:0 lds
s_add_u32 m0, s84, 9216
s_nop 0
buffer_load_dwordx4 v9, s[8:11], s72 offen offset:0 lds
v_add_u32 v2, s88, v2
v_add_u32 v3, s88, v3
s_add_u32 m0, s83, 0
s_nop 0
buffer_load_dwordx4 v2, s[12:15], s4 offen offset:0 lds
buffer_load_dwordx4 v2, s[16:19], s5 offen offset:1024 lds
buffer_load_dwordx4 v2, s[12:15], s6 offen offset:2048 lds
buffer_load_dwordx4 v2, s[16:19], s7 offen offset:3072 lds
s_add_u32 m0, s83, 49152
s_nop 0
buffer_load_dwordx4 v3, s[12:15], s4 offen offset:0 lds
buffer_load_dwordx4 v3, s[16:19], s5 offen offset:1024 lds
buffer_load_dwordx4 v3, s[12:15], s6 offen offset:2048 lds
buffer_load_dwordx4 v3, s[16:19], s7 offen offset:3072 lds
s_waitcnt vmcnt(22)
s_barrier
s_add_u32 m0, s83, 4096
s_nop 0
buffer_load_dwordx4 v2, s[12:15], s42 offen offset:0 lds
buffer_load_dwordx4 v2, s[16:19], s43 offen offset:1024 lds
s_add_u32 m0, s83, 53248
s_nop 0
buffer_load_dwordx4 v3, s[12:15], s42 offen offset:0 lds
buffer_load_dwordx4 v3, s[16:19], s43 offen offset:1024 lds
v_add_u32 v2, s88, v2
v_add_u32 v3, s88, v3
s_add_u32 m0, s83, 6144
s_nop 0
buffer_load_dwordx4 v2, s[12:15], s4 offen offset:0 lds
buffer_load_dwordx4 v2, s[16:19], s5 offen offset:1024 lds
buffer_load_dwordx4 v2, s[12:15], s6 offen offset:2048 lds
buffer_load_dwordx4 v2, s[16:19], s7 offen offset:3072 lds
s_add_u32 m0, s83, 55296
s_nop 0
buffer_load_dwordx4 v3, s[12:15], s4 offen offset:0 lds
buffer_load_dwordx4 v3, s[16:19], s5 offen offset:1024 lds
buffer_load_dwordx4 v3, s[12:15], s6 offen offset:2048 lds
buffer_load_dwordx4 v3, s[16:19], s7 offen offset:3072 lds
s_add_u32 m0, s83, 10240
s_nop 0
buffer_load_dwordx4 v2, s[12:15], s42 offen offset:0 lds
buffer_load_dwordx4 v2, s[16:19], s43 offen offset:1024 lds
s_add_u32 m0, s83, 59392
s_nop 0
buffer_load_dwordx4 v3, s[12:15], s42 offen offset:0 lds
buffer_load_dwordx4 v3, s[16:19], s43 offen offset:1024 lds
s_waitcnt vmcnt(16)
s_barrier
v_add_u32 v8, 128, v8
v_add_u32 v9, 128, v9
s_add_u32 m0, s84, 20480
s_nop 0
buffer_load_dwordx4 v8, s[8:11], s68 offen offset:0 lds
buffer_load_dwordx4 v8, s[8:11], s69 offen offset:1024 lds
buffer_load_dwordx4 v8, s[8:11], s70 offen offset:2048 lds
buffer_load_dwordx4 v8, s[8:11], s71 offen offset:3072 lds
s_add_u32 m0, s84, 25600
s_nop 0
buffer_load_dwordx4 v9, s[8:11], s68 offen offset:0 lds
buffer_load_dwordx4 v9, s[8:11], s69 offen offset:1024 lds
buffer_load_dwordx4 v9, s[8:11], s70 offen offset:2048 lds
buffer_load_dwordx4 v9, s[8:11], s71 offen offset:3072 lds
s_add_u32 m0, s84, 24576
s_nop 0
buffer_load_dwordx4 v8, s[8:11], s72 offen offset:0 lds
s_add_u32 m0, s84, 29696
s_nop 0
buffer_load_dwordx4 v9, s[8:11], s72 offen offset:0 lds
v_add_u32 v2, s88, v2
v_add_u32 v3, s88, v3
s_add_u32 m0, s83, 12288
s_nop 0
buffer_load_dwordx4 v2, s[12:15], s4 offen offset:0 lds
buffer_load_dwordx4 v2, s[16:19], s5 offen offset:1024 lds
buffer_load_dwordx4 v2, s[12:15], s6 offen offset:2048 lds
buffer_load_dwordx4 v2, s[16:19], s7 offen offset:3072 lds
s_add_u32 m0, s83, 61440
s_nop 0
buffer_load_dwordx4 v3, s[12:15], s4 offen offset:0 lds
buffer_load_dwordx4 v3, s[16:19], s5 offen offset:1024 lds
buffer_load_dwordx4 v3, s[12:15], s6 offen offset:2048 lds
buffer_load_dwordx4 v3, s[16:19], s7 offen offset:3072 lds
s_mov_b32 s73, 1
s_and_b32 s66, s2, 1
s_lshl_b32 s66, s66, 6
s_add_u32 s66, s66, 0
s_cmp_lg_u32 s86, 0
s_cselect_b64 vcc, 1, 0
s_waitcnt vmcnt(22)
s_barrier
s_cbranch_vccnz L_sk7
s_atomic_add s73, s[52:53], s66 glc
L_sk7:
s_add_u32 m0, s83, 16384
s_nop 0
buffer_load_dwordx4 v2, s[12:15], s42 offen offset:0 lds
buffer_load_dwordx4 v2, s[16:19], s43 offen offset:1024 lds
s_add_u32 m0, s83, 65536
s_nop 0
buffer_load_dwordx4 v3, s[12:15], s42 offen offset:0 lds
buffer_load_dwordx4 v3, s[16:19], s43 offen offset:1024 lds
v_add_u32 v2, s88, v2
v_add_u32 v3, s88, v3
s_add_u32 m0, s83, 18432
s_nop 0
buffer_load_dwordx4 v2, s[12:15], s4 offen offset:0 lds
buffer_load_dwordx4 v2, s[16:19], s5 offen offset:1024 lds
buffer_load_dwordx4 v2, s[12:15], s6 offen offset:2048 lds
buffer_load_dwordx4 v2, s[16:19], s7 offen offset:3072 lds
s_add_u32 m0, s83, 67584
s_nop 0
buffer_load_dwordx4 v3, s[12:15], s4 offen offset:0 lds
buffer_load_dwordx4 v3, s[16:19], s5 offen offset:1024 lds
buffer_load_dwordx4 v3, s[12:15], s6 offen offset:2048 lds
buffer_load_dwordx4 v3, s[16:19], s7 offen offset:3072 lds
s_add_u32 m0, s83, 22528
s_nop 0
buffer_load_dwordx4 v2, s[12:15], s42 offen offset:0 lds
buffer_load_dwordx4 v2, s[16:19], s43 offen offset:1024 lds
s_add_u32 m0, s83, 71680
s_nop 0
buffer_load_dwordx4 v3, s[12:15], s42 offen offset:0 lds
buffer_load_dwordx4 v3, s[16:19], s43 offen offset:1024 lds
s_getreg_b32 s60, hwreg(HW_REG_IB_STS, 8, 4)
s_cmp_lg_u32 s60, 0
s_cbranch_scc1 L_sk8
s_waitcnt lgkmcnt(0)
s_cmp_lg_u32 s73, 55
s_cbranch_scc1 L_sk8
s_mov_b32 s75, 1
s_mov_b32 s73, 0
s_atomic_add s75, s[52:53], 128
L_sk8:
s_waitcnt vmcnt(16)
s_barrier
s_getreg_b32 s60, hwreg(HW_REG_IB_STS, 8, 4)
s_cmp_lg_u32 s60, 0
s_cbranch_scc1 L_sk9
s_waitcnt lgkmcnt(0)
s_cmp_lg_u32 s73, 55
s_cbranch_scc1 L_sk9
s_mov_b32 s75, 1
s_mov_b32 s73, 0
s_atomic_add s75, s[52:53], 128
L_sk9:
v_add_u32 v8, 128, v8
v_add_u32 v9, 128, v9
s_add_u32 m0, s84, 0
s_nop 0
buffer_load_dwordx4 v8, s[8:11], s68 offen offset:0 lds
buffer_load_dwordx4 v8, s[8:11], s69 offen offset:1024 lds
buffer_load_dwordx4 v8, s[8:11], s70 offen offset:2048 lds
buffer_load_dwordx4 v8, s[8:11], s71 offen offset:3072 lds
s_add_u32 m0, s84, 5120
s_nop 0
buffer_load_dwordx4 v9, s[8:11], s68 offen offset:0 lds
buffer_load_dwordx4 v9, s[8:11], s69 offen offset:1024 lds
buffer_load_dwordx4 v9, s[8:11], s70 offen offset:2048 lds
buffer_load_dwordx4 v9, s[8:11], s71 offen offset:3072 lds
s_add_u32 m0, s84, 4096
s_nop 0
buffer_load_dwordx4 v8, s[8:11], s72 offen offset:0 lds
s_add_u32 m0, s84, 9216
s_nop 0
buffer_load_dwordx4 v9, s[8:11], s72 offen offset:0 lds
v_add_u32 v2, s88, v2
v_add_u32 v3, s88, v3
s_add_u32 m0, s83, 0
s_nop 0
buffer_load_dwordx4 v2, s[12:15], s4 offen offset:0 lds
buffer_load_dwordx4 v2, s[16:19], s5 offen offset:1024 lds
buffer_load_dwordx4 v2, s[12:15], s6 offen offset:2048 lds
buffer_load_dwordx4 v2, s[16:19], s7 offen offset:3072 lds
s_add_u32 m0, s83, 49152
s_nop 0
buffer_load_dwordx4 v3, s[12:15], s4 offen offset:0 lds
buffer_load_dwordx4 v3, s[16:19], s5 offen offset:1024 lds
buffer_load_dwordx4 v3, s[12:15], s6 offen offset:2048 lds
buffer_load_dwordx4 v3, s[16:19], s7 offen offset:3072 lds
s_getreg_b32 s60, hwreg(HW_REG_IB_STS, 8, 4)
s_cmp_lg_u32 s60, 0
s_cbranch_scc1 L_sk10
s_waitcnt lgkmcnt(0)
s_cmp_lg_u32 s73, 55
s_cbranch_scc1 L_sk10
s_mov_b32 s75, 1
s_mov_b32 s73, 0
s_atomic_add s75, s[52:53], 128
L_sk10:
s_waitcnt vmcnt(22)
s_barrier
s_getreg_b32 s60, hwreg(HW_REG_IB_STS, 8, 4)
s_cmp_lg_u32 s60, 0
s_cbranch_scc1 L_sk11
s_waitcnt lgkmcnt(0)
s_cmp_lg_u32 s73, 55
s_cbranch_scc1 L_sk11
s_mov_b32 s75, 1
s_mov_b32 s73, 0
s_atomic_add s75, s[52:53], 128
L_sk11:
s_add_u32 m0, s83, 4096
s_nop 0
buffer_load_dwordx4 v2, s[12:15], s42 offen offset:0 lds
buffer_load_dwordx4 v2, s[16:19], s43 offen offset:1024 lds
s_add_u32 m0, s83, 53248
s_nop 0
buffer_load_dwordx4 v3, s[12:15], s42 offen offset:0 lds
buffer_load_dwordx4 v3, s[16:19], s43 offen offset:1024 lds
v_add_u32 v2, s88, v2
v_add_u32 v3, s88, v3
s_add_u32 m0, s83, 6144
s_nop 0
buffer_load_dwordx4 v2, s[12:15], s4 offen offset:0 lds
buffer_load_dwordx4 v2, s[16:19], s5 offen offset:1024 lds
buffer_load_dwordx4 v2, s[12:15], s6 offen offset:2048 lds
buffer_load_dwordx4 v2, s[16:19], s7 offen offset:3072 lds
s_add_u32 m0, s83, 55296
s_nop 0
buffer_load_dwordx4 v3, s[12:15], s4 offen offset:0 lds
buffer_load_dwordx4 v3, s[16:19], s5 offen offset:1024 lds
buffer_load_dwordx4 v3, s[12:15], s6 offen offset:2048 lds
buffer_load_dwordx4 v3, s[16:19], s7 offen offset:3072 lds
s_add_u32 m0, s83, 10240
s_nop 0
buffer_load_dwordx4 v2, s[12:15], s42 offen offset:0 lds
buffer_load_dwordx4 v2, s[16:19], s43 offen offset:1024 lds
s_add_u32 m0, s83, 59392
s_nop 0
buffer_load_dwordx4 v3, s[12:15], s42 offen offset:0 lds
buffer_load_dwordx4 v3, s[16:19], s43 offen offset:1024 lds
s_getreg_b32 s60, hwreg(HW_REG_IB_STS, 8, 4)
s_cmp_lg_u32 s60, 0
s_cbranch_scc1 L_sk12
s_waitcnt lgkmcnt(0)
s_cmp_lg_u32 s73, 55
s_cbranch_scc1 L_sk12
s_mov_b32 s75, 1
s_mov_b32 s73, 0
s_atomic_add s75, s[52:53], 128
L_sk12:
s_waitcnt vmcnt(16)
s_barrier
s_getreg_b32 s60, hwreg(HW_REG_IB_STS, 8, 4)
s_cmp_lg_u32 s60, 0
s_cbranch_scc1 L_sk13
s_waitcnt lgkmcnt(0)
s_cmp_lg_u32 s73, 55
s_cbranch_scc1 L_sk13
s_mov_b32 s75, 1
s_mov_b32 s73, 0
s_atomic_add s75, s[52:53], 128
L_sk13:
v_add_u32 v8, 128, v8
v_add_u32 v9, 128, v9
s_add_u32 m0, s84, 20480
s_nop 0
buffer_load_dwordx4 v8, s[8:11], s68 offen offset:0 lds
buffer_load_dwordx4 v8, s[8:11], s69 offen offset:1024 lds
buffer_load_dwordx4 v8, s[8:11], s70 offen offset:2048 lds
buffer_load_dwordx4 v8, s[8:11], s71 offen offset:3072 lds
s_add_u32 m0, s84, 25600
s_nop 0
buffer_load_dwordx4 v9, s[8:11], s68 offen offset:0 lds
buffer_load_dwordx4 v9, s[8:11], s69 offen offset:1024 lds
buffer_load_dwordx4 v9, s[8:11], s70 offen offset:2048 lds
buffer_load_dwordx4 v9, s[8:11], s71 offen offset:3072 lds
s_add_u32 m0, s84, 24576
s_nop 0
buffer_load_dwordx4 v8, s[8:11], s72 offen offset:0 lds
s_add_u32 m0, s84, 29696
s_nop 0
buffer_load_dwordx4 v9, s[8:11], s72 offen offset:0 lds
v_add_u32 v2, s88, v2
v_add_u32 v3, s88, v3
s_add_u32 m0, s83, 12288
s_nop 0
buffer_load_dwordx4 v2, s[12:15], s4 offen offset:0 lds
buffer_load_dwordx4 v2, s[16:19], s5 offen offset:1024 lds
buffer_load_dwordx4 v2, s[12:15], s6 offen offset:2048 lds
buffer_load_dwordx4 v2, s[16:19], s7 offen offset:3072 lds
s_add_u32 m0, s83, 61440
s_nop 0
buffer_load_dwordx4 v3, s[12:15], s4 offen offset:0 lds
buffer_load_dwordx4 v3, s[16:19], s5 offen offset:1024 lds
buffer_load_dwordx4 v3, s[12:15], s6 offen offset:2048 lds
buffer_load_dwordx4 v3, s[16:19], s7 offen offset:3072 lds
s_waitcnt lgkmcnt(0)
s_cmp_lg_u32 s73, 55
s_cbranch_scc1 L_sk14
s_mov_b32 s75, 1
s_mov_b32 s73, 0
s_atomic_add s75, s[52:53], 128
L_sk14:
s_waitcnt vmcnt(22)
s_barrier
s_add_u32 m0, s83, 16384
s_nop 0
buffer_load_dwordx4 v2, s[12:15], s42 offen offset:0 lds
buffer_load_dwordx4 v2, s[16:19], s43 offen offset:1024 lds
s_add_u32 m0, s83, 65536
s_nop 0
buffer_load_dwordx4 v3, s[12:15], s42 offen offset:0 lds
buffer_load_dwordx4 v3, s[16:19], s43 offen offset:1024 lds
v_add_u32 v2, s88, v2
v_add_u32 v3, s88, v3
s_add_u32 m0, s83, 18432
s_nop 0
buffer_load_dwordx4 v2, s[12:15], s4 offen offset:0 lds
buffer_load_dwordx4 v2, s[16:19], s5 offen offset:1024 lds
buffer_load_dwordx4 v2, s[12:15], s6 offen offset:2048 lds
buffer_load_dwordx4 v2, s[16:19], s7 offen offset:3072 lds
s_add_u32 m0, s83, 67584
s_nop 0
buffer_load_dwordx4 v3, s[12:15], s4 offen offset:0 lds
buffer_load_dwordx4 v3, s[16:19], s5 offen offset:1024 lds
buffer_load_dwordx4 v3, s[12:15], s6 offen offset:2048 lds
buffer_load_dwordx4 v3, s[16:19], s7 offen offset:3072 lds
s_add_u32 m0, s83, 22528
s_nop 0
buffer_load_dwordx4 v2, s[12:15], s42 offen offset:0 lds
buffer_load_dwordx4 v2, s[16:19], s43 offen offset:1024 lds
s_add_u32 m0, s83, 71680
s_nop 0
buffer_load_dwordx4 v3, s[12:15], s42 offen offset:0 lds
buffer_load_dwordx4 v3, s[16:19], s43 offen offset:1024 lds
s_waitcnt vmcnt(16)
s_barrier
v_add_u32 v8, 128, v8
v_add_u32 v9, 128, v9
s_add_u32 m0, s84, 0
s_nop 0
buffer_load_dwordx4 v8, s[8:11], s68 offen offset:0 lds
buffer_load_dwordx4 v8, s[8:11], s69 offen offset:1024 lds
buffer_load_dwordx4 v8, s[8:11], s70 offen offset:2048 lds
buffer_load_dwordx4 v8, s[8:11], s71 offen offset:3072 lds
s_add_u32 m0, s84, 5120
s_nop 0
buffer_load_dwordx4 v9, s[8:11], s68 offen offset:0 lds
buffer_load_dwordx4 v9, s[8:11], s69 offen offset:1024 lds
buffer_load_dwordx4 v9, s[8:11], s70 offen offset:2048 lds
buffer_load_dwordx4 v9, s[8:11], s71 offen offset:3072 lds
s_add_u32 m0, s84, 4096
s_nop 0
buffer_load_dwordx4 v8, s[8:11], s72 offen offset:0 lds
s_add_u32 m0, s84, 9216
s_nop 0
buffer_load_dwordx4 v9, s[8:11], s72 offen offset:0 lds
v_add_u32 v2, s88, v2
v_add_u32 v3, s88, v3
s_add_u32 m0, s83, 0
s_nop 0
buffer_load_dwordx4 v2, s[12:15], s4 offen offset:0 lds
buffer_load_dwordx4 v2, s[16:19], s5 offen offset:1024 lds
buffer_load_dwordx4 v2, s[12:15], s6 offen offset:2048 lds
buffer_load_dwordx4 v2, s[16:19], s7 offen offset:3072 lds
s_add_u32 m0, s83, 49152
s_nop 0
buffer_load_dwordx4 v3, s[12:15], s4 offen offset:0 lds
buffer_load_dwordx4 v3, s[16:19], s5 offen offset:1024 lds
buffer_load_dwordx4 v3, s[12:15], s6 offen offset:2048 lds
buffer_load_dwordx4 v3, s[16:19], s7 offen offset:3072 lds
s_waitcnt vmcnt(22)
s_barrier
s_add_u32 m0, s83, 4096
s_nop 0
buffer_load_dwordx4 v2, s[12:15], s42 offen offset:0 lds
buffer_load_dwordx4 v2, s[16:19], s43 offen offset:1024 lds
s_add_u32 m0, s83, 53248
s_nop 0
buffer_load_dwordx4 v3, s[12:15], s42 offen offset:0 lds
buffer_load_dwordx4 v3, s[16:19], s43 offen offset:1024 lds
v_add_u32 v2, s88, v2
v_add_u32 v3, s88, v3
s_add_u32 m0, s83, 6144
s_nop 0
buffer_load_dwordx4 v2, s[12:15], s4 offen offset:0 lds
buffer_load_dwordx4 v2, s[16:19], s5 offen offset:1024 lds
buffer_load_dwordx4 v2, s[12:15], s6 offen offset:2048 lds
buffer_load_dwordx4 v2, s[16:19], s7 offen offset:3072 lds
s_add_u32 m0, s83, 55296
s_nop 0
buffer_load_dwordx4 v3, s[12:15], s4 offen offset:0 lds
buffer_load_dwordx4 v3, s[16:19], s5 offen offset:1024 lds
buffer_load_dwordx4 v3, s[12:15], s6 offen offset:2048 lds
buffer_load_dwordx4 v3, s[16:19], s7 offen offset:3072 lds
s_add_u32 m0, s83, 10240
s_nop 0
buffer_load_dwordx4 v2, s[12:15], s42 offen offset:0 lds
buffer_load_dwordx4 v2, s[16:19], s43 offen offset:1024 lds
s_add_u32 m0, s83, 59392
s_nop 0
buffer_load_dwordx4 v3, s[12:15], s42 offen offset:0 lds
buffer_load_dwordx4 v3, s[16:19], s43 offen offset:1024 lds
s_waitcnt vmcnt(16)
s_barrier
v_add_u32 v8, 128, v8
v_add_u32 v9, 128, v9
s_add_u32 m0, s84, 20480
s_nop 0
buffer_load_dwordx4 v8, s[8:11], s68 offen offset:0 lds
buffer_load_dwordx4 v8, s[8:11], s69 offen offset:1024 lds
buffer_load_dwordx4 v8, s[8:11], s70 offen offset:2048 lds
buffer_load_dwordx4 v8, s[8:11], s71 offen offset:3072 lds
s_add_u32 m0, s84, 25600
s_nop 0
buffer_load_dwordx4 v9, s[8:11], s68 offen offset:0 lds
buffer_load_dwordx4 v9, s[8:11], s69 offen offset:1024 lds
buffer_load_dwordx4 v9, s[8:11], s70 offen offset:2048 lds
buffer_load_dwordx4 v9, s[8:11], s71 offen offset:3072 lds
s_add_u32 m0, s84, 24576
s_nop 0
buffer_load_dwordx4 v8, s[8:11], s72 offen offset:0 lds
s_add_u32 m0, s84, 29696
s_nop 0
buffer_load_dwordx4 v9, s[8:11], s72 offen offset:0 lds
v_add_u32 v2, s88, v2
v_add_u32 v3, s88, v3
s_add_u32 m0, s83, 12288
s_nop 0
buffer_load_dwordx4 v2, s[12:15], s4 offen offset:0 lds
buffer_load_dwordx4 v2, s[16:19], s5 offen offset:1024 lds
buffer_load_dwordx4 v2, s[12:15], s6 offen offset:2048 lds
buffer_load_dwordx4 v2, s[16:19], s7 offen offset:3072 lds
s_add_u32 m0, s83, 61440
s_nop 0
buffer_load_dwordx4 v3, s[12:15], s4 offen offset:0 lds
buffer_load_dwordx4 v3, s[16:19], s5 offen offset:1024 lds
buffer_load_dwordx4 v3, s[12:15], s6 offen offset:2048 lds
buffer_load_dwordx4 v3, s[16:19], s7 offen offset:3072 lds
s_waitcnt vmcnt(22)
s_barrier
s_add_u32 m0, s83, 16384
s_nop 0
buffer_load_dwordx4 v2, s[12:15], s42 offen offset:0 lds
buffer_load_dwordx4 v2, s[16:19], s43 offen offset:1024 lds
s_add_u32 m0, s83, 65536
s_nop 0
buffer_load_dwordx4 v3, s[12:15], s42 offen offset:0 lds
buffer_load_dwordx4 v3, s[16:19], s43 offen offset:1024 lds
v_add_u32 v2, s88, v2
v_add_u32 v3, s88, v3
s_add_u32 m0, s83, 18432
s_nop 0
buffer_load_dwordx4 v2, s[12:15], s4 offen offset:0 lds
buffer_load_dwordx4 v2, s[16:19], s5 offen offset:1024 lds
buffer_load_dwordx4 v2, s[12:15], s6 offen offset:2048 lds
buffer_load_dwordx4 v2, s[16:19], s7 offen offset:3072 lds
s_add_u32 m0, s83, 67584
s_nop 0
buffer_load_dwordx4 v3, s[12:15], s4 offen offset:0 lds
buffer_load_dwordx4 v3, s[16:19], s5 offen offset:1024 lds
buffer_load_dwordx4 v3, s[12:15], s6 offen offset:2048 lds
buffer_load_dwordx4 v3, s[16:19], s7 offen offset:3072 lds
s_add_u32 m0, s83, 22528
s_nop 0
buffer_load_dwordx4 v2, s[12:15], s42 offen offset:0 lds
buffer_load_dwordx4 v2, s[16:19], s43 offen offset:1024 lds
s_add_u32 m0, s83, 71680
s_nop 0
buffer_load_dwordx4 v3, s[12:15], s42 offen offset:0 lds
buffer_load_dwordx4 v3, s[16:19], s43 offen offset:1024 lds
s_waitcnt vmcnt(16)
s_barrier
s_mov_b64 s[20:21], s[54:55]
s_mov_b32 s22, 25165824
s_mov_b32 s23, 0x20000
v_lshlrev_b32 v14, 4, v0
s_and_b32 s60, s2, 7
s_lshr_b32 s61, s2, 6
s_lshl_b32 s60, s60, 2
s_add_u32 s60, s60, s61
s_bfe_u32 s61, s2, 0x30003
s_sub_u32 s62, s56, 2
s_cmp_lt_u32 s56, 4
s_cselect_b32 s62, s56, s62
s_mul_i32 s62, s62, 9
s_add_u32 s62, s62, 20
s_sub_u32 s63, s56, 4
s_mul_i32 s67, s63, 10
s_cmp_lt_u32 s63, 2
s_cselect_b32 s62, s67, s62
s_mul_i32 s67, s60, 74
s_add_u32 s67, s67, s62
s_lshl_b32 s67, s67, 12
s_add_u32 s90, s67, 4194304
s_mul_i32 s67, s61, 74
s_add_u32 s67, s67, s62
s_mul_i32 s67, s67, 5120
s_add_u32 s91, s67, 1048576
s_mul_i32 s67, s61, 378880
s_add_u32 s77, s67, 1150976
s_mul_i32 s92, s60, 81920
s_mul_i32 s67, s61, 160
s_add_u32 s92, s92, s67
s_sub_u32 s62, s56, 2
s_cmp_lt_u32 s56, 4
s_cselect_b32 s62, s56, s62
s_mul_i32 s89, s60, 6
s_add_u32 s89, s89, s62
s_lshl_b32 s89, s89, 7
s_add_u32 s89, s89, 262144
s_waitcnt vmcnt(4)
s_barrier
s_add_u32 s85, s91, 0
buffer_load_dwordx4 v[240:243], v14, s[20:23], s85 offen offset:0 sc1
s_add_u32 s85, s91, 0
buffer_load_dwordx4 v[244:247], v14, s[20:23], s85 offen offset:1024 sc1
s_add_u32 s85, s91, 0
buffer_load_dwordx4 v[248:251], v14, s[20:23], s85 offen offset:2048 sc1
s_add_u32 s85, s91, 0
buffer_load_dwordx4 v[252:255], v14, s[20:23], s85 offen offset:3072 sc1
s_add_u32 s85, s91, 4096
buffer_load_dwordx4 v[172:175], v14, s[20:23], s85 offen offset:0 sc1
s_add_u32 s85, s91, 4096
buffer_load_dwordx4 v[168:171], v14, s[20:23], s85 offen offset:1024 sc1
s_add_u32 s85, s91, 4096
buffer_load_dwordx4 v[164:167], v14, s[20:23], s85 offen offset:2048 sc1
s_waitcnt vmcnt(10)
s_add_u32 s85, s91, 4096
buffer_load_dwordx4 v[160:163], v14, s[20:23], s85 offen offset:3072 sc1
s_waitcnt vmcnt(8)
s_barrier
s_add_u32 s85, s91, 8192
buffer_load_dwordx4 v[156:159], v14, s[20:23], s85 offen offset:0 sc1
s_add_u32 s85, s91, 8192
buffer_load_dwordx4 v[152:155], v14, s[20:23], s85 offen offset:1024 sc1
s_add_u32 s85, s91, 8192
buffer_load_dwordx4 v[148:151], v14, s[20:23], s85 offen offset:2048 sc1
s_waitcnt vmcnt(10)
s_add_u32 s85, s91, 8192
buffer_load_dwordx4 v[144:147], v14, s[20:23], s85 offen offset:3072 sc1
s_waitcnt vmcnt(10)
s_add_u32 s85, s91, 12288
buffer_load_dwordx4 v[140:143], v14, s[20:23], s85 offen offset:0 sc1
s_waitcnt vmcnt(10)
s_add_u32 s85, s91, 12288
buffer_load_dwordx4 v[136:139], v14, s[20:23], s85 offen offset:1024 sc1
s_waitcnt vmcnt(10)
s_add_u32 s85, s91, 12288
buffer_load_dwordx4 v[132:135], v14, s[20:23], s85 offen offset:2048 sc1
s_waitcnt vmcnt(10)
s_add_u32 s85, s91, 12288
buffer_load_dwordx4 v[128:131], v14, s[20:23], s85 offen offset:3072 sc1
s_mov_b64 s[8:9], s[36:37]
s_mov_b32 s10, 2621440
s_mov_b32 s11, 0x20000
s_mul_i32 s83, s86, 24576
s_mul_i32 s84, s86, 46080
s_add_u32 s84, s84, s77
s_barrier
s_add_u32 m0, s83, 12288
s_add_u32 s85, s84, 12288
s_waitcnt vmcnt(8)
buffer_load_dwordx4 v14, s[20:23], s85 offen offset:0 sc1 lds
s_waitcnt vmcnt(8)
buffer_load_dwordx4 v14, s[20:23], s85 offen offset:1024 sc1 lds
s_waitcnt vmcnt(8)
buffer_load_dwordx4 v14, s[20:23], s85 offen offset:2048 sc1 lds
s_waitcnt vmcnt(8)
buffer_load_dwordx4 v14, s[20:23], s85 offen offset:3072 sc1 lds
s_add_u32 m0, s83, 16384
s_add_u32 s85, s84, 16384
s_waitcnt vmcnt(8)
buffer_load_dwordx4 v14, s[20:23], s85 offen offset:0 sc1 lds
s_waitcnt vmcnt(8)
buffer_load_dwordx4 v14, s[20:23], s85 offen offset:1024 sc1 lds
s_add_u32 m0, s83, 61440
s_add_u32 s85, s84, 104448
s_waitcnt vmcnt(8)
buffer_load_dwordx4 v14, s[20:23], s85 offen offset:0 sc1 lds
s_waitcnt vmcnt(8)
buffer_load_dwordx4 v14, s[20:23], s85 offen offset:1024 sc1 lds
s_waitcnt vmcnt(8)
buffer_load_dwordx4 v14, s[20:23], s85 offen offset:2048 sc1 lds
s_waitcnt vmcnt(8)
buffer_load_dwordx4 v14, s[20:23], s85 offen offset:3072 sc1 lds
s_add_u32 m0, s83, 65536
s_add_u32 s85, s84, 108544
s_waitcnt vmcnt(8)
buffer_load_dwordx4 v14, s[20:23], s85 offen offset:0 sc1 lds
s_waitcnt vmcnt(8)
buffer_load_dwordx4 v14, s[20:23], s85 offen offset:1024 sc1 lds
s_add_u32 m0, s83, 18432
s_add_u32 s85, s84, 18432
s_waitcnt vmcnt(8)
buffer_load_dwordx4 v14, s[20:23], s85 offen offset:0 sc1 lds
s_waitcnt vmcnt(8)
buffer_load_dwordx4 v14, s[20:23], s85 offen offset:1024 sc1 lds
s_add_u32 m0, s83, 67584
s_add_u32 s85, s84, 110592
s_waitcnt vmcnt(8)
buffer_load_dwordx4 v14, s[20:23], s85 offen offset:0 sc1 lds
s_waitcnt vmcnt(8)
buffer_load_dwordx4 v14, s[20:23], s85 offen offset:1024 sc1 lds
s_mul_i32 s61, s81, 24576
s_add_u32 s61, s61, 4096
v_add_u32 v15, s61, v14
s_add_u32 m0, s61, 16384
s_add_u32 s85, s91, 47104
s_waitcnt vmcnt(8)
buffer_load_dwordx4 v14, s[20:23], s85 offen offset:0 sc1 lds
s_waitcnt vmcnt(8)
buffer_load_dwordx4 v14, s[20:23], s85 offen offset:1024 sc1 lds
s_waitcnt vmcnt(8)
buffer_load_dwordx4 v14, s[20:23], s85 offen offset:2048 sc1 lds
s_waitcnt vmcnt(8)
buffer_load_dwordx4 v14, s[20:23], s85 offen offset:3072 sc1 lds
s_waitcnt vmcnt(8)
s_add_u32 s85, s91, 16384
buffer_load_dwordx4 v[124:127], v14, s[20:23], s85 offen offset:0 sc1
s_waitcnt vmcnt(8)
s_add_u32 s85, s91, 16384
buffer_load_dwordx4 v[120:123], v14, s[20:23], s85 offen offset:1024 sc1
s_waitcnt vmcnt(8)
s_add_u32 s85, s91, 16384
buffer_load_dwordx4 v[116:119], v14, s[20:23], s85 offen offset:2048 sc1
s_waitcnt vmcnt(8)
s_add_u32 s85, s91, 16384
buffer_load_dwordx4 v[112:115], v14, s[20:23], s85 offen offset:3072 sc1
s_waitcnt vmcnt(8)
s_add_u32 s85, s91, 20480
buffer_load_dwordx4 v[108:111], v14, s[20:23], s85 offen offset:0 sc1
s_waitcnt vmcnt(8)
s_add_u32 s85, s91, 20480
buffer_load_dwordx4 v[104:107], v14, s[20:23], s85 offen offset:1024 sc1
s_waitcnt vmcnt(8)
s_add_u32 s85, s91, 20480
buffer_load_dwordx4 v[100:103], v14, s[20:23], s85 offen offset:2048 sc1
s_waitcnt vmcnt(8)
s_add_u32 s85, s91, 20480
buffer_load_dwordx4 v[96:99], v14, s[20:23], s85 offen offset:3072 sc1
s_waitcnt vmcnt(8)
s_add_u32 s85, s91, 24576
buffer_load_dwordx4 v[92:95], v14, s[20:23], s85 offen offset:0 sc1
s_waitcnt vmcnt(8)
s_add_u32 s85, s91, 24576
buffer_load_dwordx4 v[88:91], v14, s[20:23], s85 offen offset:1024 sc1
s_waitcnt vmcnt(8)
s_add_u32 s85, s91, 24576
buffer_load_dwordx4 v[84:87], v14, s[20:23], s85 offen offset:2048 sc1
s_waitcnt vmcnt(8)
s_add_u32 s85, s91, 24576
buffer_load_dwordx4 v[80:83], v14, s[20:23], s85 offen offset:3072 sc1
s_waitcnt vmcnt(8)
s_add_u32 s85, s91, 28672
buffer_load_dwordx4 v[76:79], v14, s[20:23], s85 offen offset:0 sc1
s_waitcnt vmcnt(8)
s_add_u32 s85, s91, 28672
buffer_load_dwordx4 v[72:75], v14, s[20:23], s85 offen offset:1024 sc1
s_lshl_b32 s60, s86, 2
s_add_u32 s60, s60, 146704
v_mov_b32 v4, s60
v_mov_b32 v7, 1
s_mov_b64 exec, 1
ds_write_b32 v4, v7
s_mov_b64 exec, -1
s_lshl_b32 s61, s81, 14
s_add_u32 s61, s61, 98304
s_add_u32 m0, s61, 0
s_add_u32 s85, s91, 30720
s_waitcnt vmcnt(8)
buffer_load_dwordx4 v14, s[20:23], s85 offen offset:0 sc1 lds
s_waitcnt vmcnt(8)
buffer_load_dwordx4 v14, s[20:23], s85 offen offset:1024 sc1 lds
s_waitcnt vmcnt(8)
buffer_load_dwordx4 v14, s[20:23], s85 offen offset:2048 sc1 lds
s_waitcnt vmcnt(8)
buffer_load_dwordx4 v14, s[20:23], s85 offen offset:3072 sc1 lds
s_add_u32 m0, s61, 4096
s_add_u32 s85, s91, 34816
s_waitcnt vmcnt(8)
buffer_load_dwordx4 v14, s[20:23], s85 offen offset:0 sc1 lds
s_waitcnt vmcnt(8)
buffer_load_dwordx4 v14, s[20:23], s85 offen offset:1024 sc1 lds
s_waitcnt vmcnt(8)
buffer_load_dwordx4 v14, s[20:23], s85 offen offset:2048 sc1 lds
s_waitcnt vmcnt(8)
buffer_load_dwordx4 v14, s[20:23], s85 offen offset:3072 sc1 lds
s_add_u32 m0, s61, 8192
s_add_u32 s85, s91, 38912
s_waitcnt vmcnt(8)
buffer_load_dwordx4 v14, s[20:23], s85 offen offset:0 sc1 lds
s_waitcnt vmcnt(8)
buffer_load_dwordx4 v14, s[20:23], s85 offen offset:1024 sc1 lds
s_waitcnt vmcnt(8)
buffer_load_dwordx4 v14, s[20:23], s85 offen offset:2048 sc1 lds
s_waitcnt vmcnt(8)
buffer_load_dwordx4 v14, s[20:23], s85 offen offset:3072 sc1 lds
s_add_u32 m0, s61, 12288
s_add_u32 s85, s91, 43008
s_waitcnt vmcnt(8)
buffer_load_dwordx4 v14, s[20:23], s85 offen offset:0 sc1 lds
s_waitcnt vmcnt(8)
buffer_load_dwordx4 v14, s[20:23], s85 offen offset:1024 sc1 lds
s_waitcnt vmcnt(8)
buffer_load_dwordx4 v14, s[20:23], s85 offen offset:2048 sc1 lds
s_waitcnt vmcnt(8)
buffer_load_dwordx4 v14, s[20:23], s85 offen offset:3072 sc1 lds
s_branch L_P2S
L_SIDEB:
v_lshlrev_b32 v14, 4, v0
v_and_b32 v5, 7, v0
s_mov_b64 s[20:21], s[54:55]
s_mov_b32 s22, 25165824
s_mov_b32 s23, 0x20000
s_mov_b64 s[24:25], s[54:55]
s_mov_b32 s26, 65536
s_mov_b32 s27, 0x20000
s_sub_u32 s60, s2, 112
s_lshl_b32 s79, s60, 1
s_add_u32 s79, s79, s86
s_lshl_b32 s79, s79, 7
s_add_u32 s79, s79, 262144
s_mul_i32 s84, s86, 144
s_mul_i32 s61, s60, 1
s_add_u32 s84, s84, s61
s_add_u32 s84, s84, 0
s_lshr_b32 s60, s60, 3
s_lshl_b32 s60, s60, 1
s_add_u32 s87, s60, s86
s_lshl_b32 s67, s87, 1
s_and_b32 s62, s2, 1
s_add_u32 s67, s67, s62
s_sub_u32 s67, 71, s67
s_mul_i32 s60, s67, 49933
s_lshr_b32 s60, s60, 20
s_mul_i32 s61, s60, 21
s_sub_u32 s61, s67, s61
s_bfe_u32 s62, s2, 0x20001
s_sub_u32 s63, s61, 12
s_max_i32 s63, s63, 0
s_mul_i32 s64, s63, 349526
s_lshr_b32 s64, s64, 20
s_mul_i32 s65, s64, 3
s_sub_u32 s65, s63, s65
s_mul_i32 s66, s64, 10
s_add_u32 s66, s66, s65
s_mul_i32 s67, s62, 5
s_add_u32 s67, s67, 1
s_lshr_b32 s67, s67, 1
s_add_u32 s66, s66, s67
s_lshr_b32 s67, s62, 1
s_mul_i32 s67, s67, 27
s_add_u32 s67, s67, 54
s_add_u32 s67, s67, s64
s_lshl_b32 s63, s62, 1
s_and_b32 s63, s63, s65
s_cselect_b32 s66, s67, s66
s_mul_i32 s67, s62, 6
s_add_u32 s67, s67, s61
s_cmp_lt_u32 s61, 6
s_cselect_b32 s63, 30, 51
s_add_u32 s67, s67, s63
s_cmp_lt_u32 s61, 12
s_cselect_b32 s61, s67, s66
s_cmp_lt_u32 s61, 57
s_cselect_b64 s[28:29], s[44:45], s[46:47]
s_cselect_b32 s62, 30, 57
s_cmp_lt_u32 s61, 30
s_cselect_b64 s[28:29], s[38:39], s[28:29]
s_cselect_b32 s62, 0, s62
s_mov_b32 s63, 3456
s_cselect_b32 s63, 3840, s63
s_mul_i32 s30, s63, 640
s_mov_b32 s31, 0x20000
s_sub_u32 s62, s61, s62
s_lshl_b32 s62, s62, 7
s_mul_i32 s64, s60, s63
s_mul_i32 s64, s64, 8
s_add_u32 s64, s64, s62
s_mul_i32 s65, s63, 24
s_cmp_eq_u32 s60, 3
s_cselect_b32 s64, 1073741824, s64
s_mul_i32 s66, s60, 21504
s_lshl_b32 s67, s61, 8
s_add_u32 s66, s66, s67
s_add_u32 s66, s66, 65536
v_lshrrev_b32 v16, 3, v0
v_mul_lo_u32 v16, v16, s63
v_and_b32 v17, 7, v0
v_lshl_add_u32 v16, v17, 4, v16
v_and_b32 v18, 1, v0
v_lshlrev_b32 v18, 4, v18
v_mov_b32 v19, 0x3f80
v_lshlrev_b32 v18, v18, v19
v_bfe_u32 v19, v0, 1, 3
v_cmp_eq_u32 vcc, 0, v19
s_nop 1
v_cndmask_b32 v20, 0, v18, vcc
v_cmp_eq_u32 vcc, 1, v19
s_nop 1
v_cndmask_b32 v21, 0, v18, vcc
v_cmp_eq_u32 vcc, 2, v19
s_nop 1
v_cndmask_b32 v22, 0, v18, vcc
v_cmp_eq_u32 vcc, 3, v19
s_nop 1
v_cndmask_b32 v23, 0, v18, vcc
v_lshrrev_b32 v18, 4, v0
v_lshlrev_b32 v18, 4, v18
v_lshl_add_u32 v17, v17, 5, v18
v_mov_b64 v[8:9], 0
v_mov_b64 v[10:11], 0
v_lshlrev_b32 v177, 5, v177
v_lshl_add_u32 v177, v178, 3, v177
v_mov_b32 v184, 0x3f803f80
v_mov_b32 v185, 0x3f80
v_mov_b32 v186, 0x3f800000
s_waitcnt vmcnt(0)
v_dot2_f32_bf16 v180, v188, v184, 0
v_dot2_f32_bf16 v181, v189, v184, 0
v_dot2_f32_bf16 v180, v190, v184, v180
v_dot2_f32_bf16 v181, v191, v184, v181
v_dot2_f32_bf16 v180, v192, v184, v180
v_dot2_f32_bf16 v181, v193, v184, v181
v_dot2_f32_bf16 v180, v194, v184, v180
v_dot2_f32_bf16 v181, v195, v184, v181
v_dot2_f32_bf16 v180, v196, v184, v180
v_dot2_f32_bf16 v181, v197, v184, v181
v_dot2_f32_bf16 v180, v198, v184, v180
v_dot2_f32_bf16 v181, v199, v184, v181
v_dot2_f32_bf16 v180, v200, v184, v180
v_dot2_f32_bf16 v181, v201, v184, v181
v_dot2_f32_bf16 v180, v202, v184, v180
v_dot2_f32_bf16 v181, v203, v184, v181
v_dot2_f32_bf16 v180, v204, v184, v180
v_dot2_f32_bf16 v181, v205, v184, v181
v_dot2_f32_bf16 v180, v206, v184, v180
v_dot2_f32_bf16 v181, v207, v184, v181
s_nop 2
v_add_f32 v180, v180, v181
s_nop 1
v_add_f32_dpp v180, v180, v180 row_ror:8 row_mask:0xf bank_mask:0xf
s_nop 1
v_add_f32_dpp v180, v180, v180 row_ror:4 row_mask:0xf bank_mask:0xf
s_nop 1
v_add_f32_dpp v180, v180, v180 row_ror:2 row_mask:0xf bank_mask:0xf
s_nop 1
v_add_f32_dpp v180, v180, v180 row_ror:1 row_mask:0xf bank_mask:0xf
v_mul_f32 v181, 0xbacccccd, v180
v_dot2_f32_bf16 v208, v188, v185, v181
v_dot2_f32_bf16 v209, v188, v186, v181
v_dot2_f32_bf16 v210, v189, v185, v181
v_dot2_f32_bf16 v211, v189, v186, v181
v_dot2_f32_bf16 v212, v190, v185, v181
v_dot2_f32_bf16 v213, v190, v186, v181
v_dot2_f32_bf16 v214, v191, v185, v181
v_dot2_f32_bf16 v215, v191, v186, v181
v_dot2_f32_bf16 v216, v192, v185, v181
v_dot2_f32_bf16 v217, v192, v186, v181
v_dot2_f32_bf16 v218, v193, v185, v181
v_dot2_f32_bf16 v219, v193, v186, v181
v_dot2_f32_bf16 v220, v194, v185, v181
v_dot2_f32_bf16 v221, v194, v186, v181
v_dot2_f32_bf16 v222, v195, v185, v181
v_dot2_f32_bf16 v223, v195, v186, v181
v_dot2_f32_bf16 v224, v196, v185, v181
v_dot2_f32_bf16 v225, v196, v186, v181
v_dot2_f32_bf16 v226, v197, v185, v181
v_dot2_f32_bf16 v227, v197, v186, v181
v_dot2_f32_bf16 v228, v198, v185, v181
v_dot2_f32_bf16 v229, v198, v186, v181
v_dot2_f32_bf16 v230, v199, v185, v181
v_dot2_f32_bf16 v231, v199, v186, v181
v_dot2_f32_bf16 v232, v200, v185, v181
v_dot2_f32_bf16 v233, v200, v186, v181
v_dot2_f32_bf16 v234, v201, v185, v181
v_dot2_f32_bf16 v235, v201, v186, v181
v_dot2_f32_bf16 v236, v202, v185, v181
v_dot2_f32_bf16 v237, v202, v186, v181
v_dot2_f32_bf16 v238, v203, v185, v181
v_dot2_f32_bf16 v239, v203, v186, v181
v_dot2_f32_bf16 v240, v204, v185, v181
v_dot2_f32_bf16 v241, v204, v186, v181
v_dot2_f32_bf16 v242, v205, v185, v181
v_dot2_f32_bf16 v243, v205, v186, v181
v_dot2_f32_bf16 v244, v206, v185, v181
v_dot2_f32_bf16 v245, v206, v186, v181
v_dot2_f32_bf16 v246, v207, v185, v181
v_dot2_f32_bf16 v247, v207, v186, v181
v_pk_mul_f32 v[182:183], v[208:209], v[208:209]
v_pk_fma_f32 v[182:183], v[210:211], v[210:211], v[182:183]
v_pk_fma_f32 v[182:183], v[212:213], v[212:213], v[182:183]
v_pk_fma_f32 v[182:183], v[214:215], v[214:215], v[182:183]
v_pk_fma_f32 v[182:183], v[216:217], v[216:217], v[182:183]
v_pk_fma_f32 v[182:183], v[218:219], v[218:219], v[182:183]
v_pk_fma_f32 v[182:183], v[220:221], v[220:221], v[182:183]
v_pk_fma_f32 v[182:183], v[222:223], v[222:223], v[182:183]
v_pk_fma_f32 v[182:183], v[224:225], v[224:225], v[182:183]
v_pk_fma_f32 v[182:183], v[226:227], v[226:227], v[182:183]
v_pk_fma_f32 v[182:183], v[228:229], v[228:229], v[182:183]
v_pk_fma_f32 v[182:183], v[230:231], v[230:231], v[182:183]
v_pk_fma_f32 v[182:183], v[232:233], v[232:233], v[182:183]
v_pk_fma_f32 v[182:183], v[234:235], v[234:235], v[182:183]
v_pk_fma_f32 v[182:183], v[236:237], v[236:237], v[182:183]
v_pk_fma_f32 v[182:183], v[238:239], v[238:239], v[182:183]
v_pk_fma_f32 v[182:183], v[240:241], v[240:241], v[182:183]
v_pk_fma_f32 v[182:183], v[242:243], v[242:243], v[182:183]
v_pk_fma_f32 v[182:183], v[244:245], v[244:245], v[182:183]
v_pk_fma_f32 v[182:183], v[246:247], v[246:247], v[182:183]
v_add_f32 v182, v182, v183
s_nop 1
v_add_f32_dpp v182, v182, v182 row_ror:8 row_mask:0xf bank_mask:0xf
s_nop 1
v_add_f32_dpp v182, v182, v182 row_ror:4 row_mask:0xf bank_mask:0xf
s_nop 1
v_add_f32_dpp v182, v182, v182 row_ror:2 row_mask:0xf bank_mask:0xf
s_nop 1
v_add_f32_dpp v182, v182, v182 row_ror:1 row_mask:0xf bank_mask:0xf
v_mul_f32 v180, 0x3acccccd, v180
v_mov_b32 v181, 0x3727c5ac
v_fmac_f32 v181, 0x3acccccd, v182
v_rsq_f32 v181, v181
s_mov_b32 exec_lo, 0x000f000f
s_mov_b32 exec_hi, 0x000f000f
buffer_store_dwordx2 v[180:181], v177, s[24:27], 0 offen sc1
s_mov_b64 exec, -1
v_lshlrev_b32 v4, 2, v0
v_add_u32 v4, 146688, v4
v_mov_b32 v7, 0
s_mov_b64 exec, 0xff
ds_write_b32 v4, v7
s_mov_b64 exec, -1
s_waitcnt lgkmcnt(0)
s_setprio 2
s_barrier
s_barrier
s_mov_b64 exec, 0xff
buffer_store_dwordx4 v[8:11], v14, s[20:23], s79 offen sc1
s_mov_b64 exec, -1
s_lshl_b32 s88, s86, 13
s_add_u32 s88, s88, 147456
v_lshrrev_b32 v6, 4, v0
v_bfe_u32 v7, v0, 2, 2
v_lshlrev_b32 v144, 10, v6
v_lshl_add_u32 v144, v7, 7, v144
v_lshrrev_b32 v7, 1, v7
v_and_b32 v6, 1, v6
v_lshl_or_b32 v7, v6, 1, v7
v_lshl_add_u32 v144, v7, 5, v144
v_and_b32 v7, 3, v0
v_lshl_add_u32 v144, v7, 3, v144
v_add_u32 v144, s88, v144
v_xor_b32 v145, 32, v144
v_xor_b32 v146, 64, v144
v_xor_b32 v147, 96, v144
s_mul_i32 s68, s84, 209716
s_lshr_b32 s68, s68, 20
s_mul_i32 s69, s68, 5
s_sub_u32 s69, s84, s69
s_lshl_b32 s69, s69, 1
s_cmp_lt_u32 s84, 370
s_cselect_b32 s84, 2, 0
s_sub_u32 s70, s68, 20
s_max_i32 s70, s70, 0
s_mul_i32 s71, s70, 209716
s_lshr_b32 s71, s71, 20
s_mul_i32 s73, s71, 5
s_sub_u32 s73, s70, s73
s_mov_b32 s72, 0x80c2040
s_cmp_eq_u32 s71, 1
s_cmov_b32 s72, 0x62ca144
s_cmp_eq_u32 s71, 2
s_cmov_b32 s72, 0x103ce247
s_cmp_eq_u32 s71, 3
s_cmov_b32 s72, 0xd317591
s_barrier
buffer_load_dwordx4 v[28:31], v16, s[28:31], s64 offen
s_add_u32 s64, s64, s65
buffer_load_dwordx4 v[32:35], v16, s[28:31], s64 offen
s_add_u32 s64, s64, s65
buffer_load_dwordx4 v[36:39], v16, s[28:31], s64 offen
s_add_u32 s64, s64, s65
buffer_load_dwordx4 v[40:43], v16, s[28:31], s64 offen
s_add_u32 s64, s64, s65
buffer_load_dwordx4 v[44:47], v16, s[28:31], s64 offen
s_add_u32 s64, s64, s65
s_cmp_eq_u32 s71, 4
s_cmov_b32 s72, 0x2275c554
s_cmp_eq_u32 s71, 5
s_cmov_b32 s72, 0x1a4d2a23
s_cmp_eq_u32 s71, 6
s_cmov_b32 s72, 0x34beea5b
s_cmp_eq_u32 s71, 7
s_cmov_b32 s72, 0x1f799635
s_cmp_eq_u32 s71, 8
s_cmov_b32 s72, 0x279a1824
s_cmp_eq_u32 s71, 9
s_cmov_b32 s72, 0x31c2baa5
s_cmp_eq_u32 s71, 10
s_cmov_b32 s72, 0xcf2b6c
s_mul_i32 s73, s73, 6
s_lshr_b32 s72, s72, s73
s_and_b32 s72, s72, 63
s_lshl_b32 s72, s72, 5
s_mul_i32 s73, s68, 40
s_mul_i32 s74, s68, 160
s_sub_u32 s74, s74, 2544
s_cmp_lt_u32 s68, 16
s_cselect_b32 s73, s73, s74
s_cselect_b32 s75, 4, 40
s_cmp_lt_u32 s68, 20
s_cselect_b32 s72, s73, s72
s_cselect_b32 s75, s75, 4
s_cselect_b32 s76, 20, 16
s_cselect_b64 s[32:33], s[40:41], s[48:49]
s_mov_b32 s34, 2211840
s_cselect_b32 s34, 819200, s34
s_mov_b32 s35, 0x20000
s_cmp_lt_u32 s68, 74
s_cselect_b32 s74, 0, 1073741824
s_mul_i32 s72, s72, 1280
s_lshl_b32 s70, s69, 7
s_add_u32 s72, s72, s70
s_add_u32 s72, s72, s74
s_mul_i32 s75, s75, 1280
s_sub_u32 s75, s75, 1024
s_barrier
buffer_load_dwordx4 v[48:51], v16, s[28:31], s64 offen
s_add_u32 s64, s64, s65
buffer_load_dwordx4 v[52:55], v16, s[28:31], s64 offen
s_add_u32 s64, s64, s65
buffer_load_dwordx4 v[56:59], v16, s[28:31], s64 offen
s_add_u32 s64, s64, s65
buffer_load_dwordx4 v[60:63], v16, s[28:31], s64 offen
s_add_u32 s64, s64, s65
buffer_load_dwordx4 v[64:67], v16, s[28:31], s64 offen
s_add_u32 s64, s64, s65
v_lshrrev_b32 v6, 5, v0
v_bfe_u32 v7, v0, 3, 2
v_mad_u32_u24 v6, v6, s76, v7
v_mul_u32_u24 v6, 1280, v6
v_and_b32 v7, 2, v7
v_xor_b32 v7, v7, v5
v_lshl_add_u32 v6, v7, 4, v6
v_add_u32 v136, s72, v6
v_xor_b32 v6, 64, v6
s_add_u32 s72, s72, s75
v_add_u32 v137, s72, v6
s_lshl_b32 s75, s75, 1
v_add_u32 v138, s75, v136
v_add_u32 v139, s75, v137
s_mul_i32 s73, s68, 5120
s_add_u32 s74, s74, 1048576
s_add_u32 s74, s74, s73
s_lshl_b32 s70, s69, 2
v_and_b32 v6, 15, v0
v_add_u32 v6, s70, v6
v_mul_u32_u24 v7, 52, v6
v_lshrrev_b32 v7, 8, v7
v_mad_i32_i24 v6, v7, -5, v6
v_and_b32 v140, 1, v7
v_sub_u32 v6, v6, v140
v_min_u32 v6, 4, v6
v_mul_u32_u24 v7, 370, v7
v_add_u32 v6, v6, v7
v_lshl_add_u32 v140, v6, 10, s74
s_barrier
s_add_u32 m0, s88, 4096
s_movk_i32 s60, 128
buffer_load_dwordx4 v136, s[32:35], s60 offen offset:0 lds
buffer_load_dwordx4 v137, s[32:35], s60 offen offset:1024 lds
buffer_load_dwordx4 v138, s[32:35], s60 offen offset:2048 lds
buffer_load_dwordx4 v139, s[32:35], s60 offen offset:3072 lds
s_add_u32 m0, s88, 0
s_movk_i32 s60, 0
buffer_load_dwordx4 v136, s[32:35], s60 offen offset:0 lds
buffer_load_dwordx4 v137, s[32:35], s60 offen offset:1024 lds
buffer_load_dwordx4 v138, s[32:35], s60 offen offset:2048 lds
buffer_load_dwordx4 v139, s[32:35], s60 offen offset:3072 lds
buffer_load_dwordx4 v[68:71], v16, s[28:31], s64 offen
s_add_u32 s64, s64, s65
buffer_load_dwordx4 v[72:75], v16, s[28:31], s64 offen
s_add_u32 s64, s64, s65
s_waitcnt vmcnt(15)
v_mfma_f32_16x16x32_bf16 v[24:27], v[20:23], v[28:31], 0
v_mfma_f32_16x16x32_bf16 v[24:27], v[20:23], v[32:35], v[24:27]
v_mfma_f32_16x16x32_bf16 v[24:27], v[20:23], v[36:39], v[24:27]
v_mfma_f32_16x16x32_bf16 v[24:27], v[20:23], v[40:43], v[24:27]
v_mfma_f32_16x16x32_bf16 v[24:27], v[20:23], v[44:47], v[24:27]
s_barrier
buffer_load_dwordx4 v[76:79], v16, s[28:31], s64 offen
s_add_u32 s64, s64, s65
buffer_load_dwordx4 v[80:83], v16, s[28:31], s64 offen
s_add_u32 s64, s64, s65
buffer_load_dwordx4 v[84:87], v16, s[28:31], s64 offen
s_add_u32 s64, s64, s65
buffer_load_dwordx4 v[88:91], v16, s[28:31], s64 offen
s_add_u32 s64, s64, s65
buffer_load_dwordx4 v[92:95], v16, s[28:31], s64 offen
s_add_u32 s64, s64, s65
s_waitcnt vmcnt(15)
v_mfma_f32_16x16x32_bf16 v[24:27], v[20:23], v[48:51], v[24:27]
v_mfma_f32_16x16x32_bf16 v[24:27], v[20:23], v[52:55], v[24:27]
v_mfma_f32_16x16x32_bf16 v[24:27], v[20:23], v[56:59], v[24:27]
v_mfma_f32_16x16x32_bf16 v[24:27], v[20:23], v[60:63], v[24:27]
v_mfma_f32_16x16x32_bf16 v[24:27], v[20:23], v[64:67], v[24:27]
s_barrier
buffer_load_dwordx4 v[96:99], v16, s[28:31], s64 offen
s_add_u32 s64, s64, s65
buffer_load_dwordx4 v[100:103], v16, s[28:31], s64 offen
s_add_u32 s64, s64, s65
buffer_load_dwordx4 v[104:107], v16, s[28:31], s64 offen
s_add_u32 s64, s64, s65
buffer_load_dwordx4 v[108:111], v16, s[28:31], s64 offen
s_add_u32 s64, s64, s65
buffer_load_dwordx4 v[112:115], v16, s[28:31], s64 offen
s_add_u32 s64, s64, s65
s_waitcnt vmcnt(10)
v_mfma_f32_16x16x32_bf16 v[24:27], v[20:23], v[68:71], v[24:27]
v_mfma_f32_16x16x32_bf16 v[24:27], v[20:23], v[72:75], v[24:27]
s_barrier
buffer_load_dwordx4 v[116:119], v16, s[28:31], s64 offen
s_add_u32 s64, s64, s65
buffer_load_dwordx4 v[120:123], v16, s[28:31], s64 offen
s_add_u32 s64, s64, s65
buffer_load_dwordx4 v[124:127], v16, s[28:31], s64 offen
s_add_u32 s64, s64, s65
buffer_load_dwordx4 v[128:131], v16, s[28:31], s64 offen
s_add_u32 s64, s64, s65
buffer_load_dwordx4 v[132:135], v16, s[28:31], s64 offen
s_add_u32 s64, s64, s65
s_waitcnt vmcnt(10)
v_mfma_f32_16x16x32_bf16 v[24:27], v[20:23], v[76:79], v[24:27]
v_mfma_f32_16x16x32_bf16 v[24:27], v[20:23], v[80:83], v[24:27]
v_mfma_f32_16x16x32_bf16 v[24:27], v[20:23], v[84:87], v[24:27]
v_mfma_f32_16x16x32_bf16 v[24:27], v[20:23], v[88:91], v[24:27]
v_mfma_f32_16x16x32_bf16 v[24:27], v[20:23], v[92:95], v[24:27]
s_waitcnt vmcnt(17)
ds_read_b64_tr_b16 v[152:153], v144 offset:0
ds_read_b64_tr_b16 v[154:155], v144 offset:512
ds_read_b64_tr_b16 v[156:157], v145 offset:0
ds_read_b64_tr_b16 v[158:159], v145 offset:512
ds_read_b64_tr_b16 v[160:161], v146 offset:0
ds_read_b64_tr_b16 v[162:163], v146 offset:512
ds_read_b64_tr_b16 v[164:165], v147 offset:0
ds_read_b64_tr_b16 v[166:167], v147 offset:512
v_readlane_b32 s68, v140, 0
v_readlane_b32 s69, v140, 1
v_readlane_b32 s70, v140, 2
v_readlane_b32 s71, v140, 3
s_waitcnt lgkmcnt(0)
s_nop 0
buffer_store_dwordx4 v[152:155], v14, s[20:23], s68 offen sc1
buffer_store_dwordx4 v[156:159], v14, s[20:23], s69 offen sc1
buffer_store_dwordx4 v[160:163], v14, s[20:23], s70 offen sc1
buffer_store_dwordx4 v[164:167], v14, s[20:23], s71 offen sc1
s_barrier
s_waitcnt vmcnt(9)
v_mfma_f32_16x16x32_bf16 v[24:27], v[20:23], v[96:99], v[24:27]
v_mfma_f32_16x16x32_bf16 v[24:27], v[20:23], v[100:103], v[24:27]
v_mfma_f32_16x16x32_bf16 v[24:27], v[20:23], v[104:107], v[24:27]
v_mfma_f32_16x16x32_bf16 v[24:27], v[20:23], v[108:111], v[24:27]
v_mfma_f32_16x16x32_bf16 v[24:27], v[20:23], v[112:115], v[24:27]
s_barrier
s_waitcnt vmcnt(4)
v_mfma_f32_16x16x32_bf16 v[24:27], v[20:23], v[116:119], v[24:27]
v_mfma_f32_16x16x32_bf16 v[24:27], v[20:23], v[120:123], v[24:27]
v_mfma_f32_16x16x32_bf16 v[24:27], v[20:23], v[124:127], v[24:27]
v_mfma_f32_16x16x32_bf16 v[24:27], v[20:23], v[128:131], v[24:27]
v_mfma_f32_16x16x32_bf16 v[24:27], v[20:23], v[132:135], v[24:27]
s_nop 7
v_add_f32_dpp v24, v24, v24 row_ror:8 row_mask:0xf bank_mask:0xf
v_add_f32_dpp v25, v25, v25 row_ror:8 row_mask:0xf bank_mask:0xf
v_add_f32_dpp v26, v26, v26 row_ror:8 row_mask:0xf bank_mask:0xf
v_add_f32_dpp v27, v27, v27 row_ror:8 row_mask:0xf bank_mask:0xf
s_mov_b32 exec_lo, 0x00ff00ff
s_mov_b32 exec_hi, 0
buffer_store_dwordx4 v[24:27], v17, s[20:23], s66 offen sc1
s_mov_b64 exec, -1
s_waitcnt vmcnt(26)
ds_read_b64_tr_b16 v[152:153], v144 offset:4096
ds_read_b64_tr_b16 v[154:155], v144 offset:4608
ds_read_b64_tr_b16 v[156:157], v145 offset:4096
ds_read_b64_tr_b16 v[158:159], v145 offset:4608
ds_read_b64_tr_b16 v[160:161], v146 offset:4096
ds_read_b64_tr_b16 v[162:163], v146 offset:4608
ds_read_b64_tr_b16 v[164:165], v147 offset:4096
ds_read_b64_tr_b16 v[166:167], v147 offset:4608
v_readlane_b32 s68, v140, 4
v_readlane_b32 s69, v140, 5
v_readlane_b32 s70, v140, 6
v_readlane_b32 s71, v140, 7
s_waitcnt lgkmcnt(0)
s_nop 0
buffer_store_dwordx4 v[152:155], v14, s[20:23], s68 offen sc1
buffer_store_dwordx4 v[156:159], v14, s[20:23], s69 offen sc1
buffer_store_dwordx4 v[160:163], v14, s[20:23], s70 offen sc1
buffer_store_dwordx4 v[164:167], v14, s[20:23], s71 offen sc1
s_barrier
s_waitcnt vmcnt(0)
s_barrier
s_mov_b64 s[12:13], s[52:53]
s_mov_b32 s14, 256
s_mov_b32 s15, 0x20000
s_and_b32 s60, s2, 7
s_lshr_b32 s61, s2, 6
s_lshl_b32 s60, s60, 2
s_add_u32 s60, s60, s61
s_bfe_u32 s61, s2, 0x30003
s_sub_u32 s62, s56, 2
s_cmp_lt_u32 s56, 4
s_cselect_b32 s62, s56, s62
s_mul_i32 s62, s62, 9
s_add_u32 s62, s62, 20
s_sub_u32 s63, s56, 4
s_mul_i32 s67, s63, 10
s_cmp_lt_u32 s63, 2
s_cselect_b32 s62, s67, s62
s_mul_i32 s67, s60, 74
s_add_u32 s67, s67, s62
s_lshl_b32 s67, s67, 12
s_add_u32 s90, s67, 4194304
s_barrier
s_mul_i32 s67, s61, 74
s_add_u32 s67, s67, s62
s_mul_i32 s67, s67, 5120
s_add_u32 s91, s67, 1048576
s_mul_i32 s67, s61, 378880
s_add_u32 s77, s67, 1150976
s_mul_i32 s92, s60, 81920
s_mul_i32 s67, s61, 160
s_add_u32 s92, s92, s67
s_sub_u32 s62, s56, 2
s_cmp_lt_u32 s56, 4
s_cselect_b32 s62, s56, s62
s_mul_i32 s89, s60, 6
s_add_u32 s89, s89, s62
s_lshl_b32 s89, s89, 7
s_add_u32 s89, s89, 262144
v_min_u32 v8, 47, v0
s_mul_i32 s60, s86, 192
v_lshl_add_u32 v8, v8, 2, s60
v_lshrrev_b32 v9, 6, v8
v_and_b32 v10, 63, v8
s_barrier
s_mul_i32 s60, s58, 3
s_mul_i32 s61, s86, 24
s_add_u32 s60, s60, s61
s_add_u32 s60, s60, 30
v_add_u32 v9, s60, v9
v_lshlrev_b32 v9, 8, v9
v_lshl_add_u32 v9, v10, 2, v9
v_min_u32 v12, 63, v0
s_mul_i32 s60, s86, 64
s_add_u32 s60, s60, 0
v_add_u32 v12, s60, v12
v_lshrrev_b32 v10, 5, v12
v_and_b32 v15, 15, v12
v_lshl_add_u32 v10, v10, 4, v15
v_add_u32 v10, s57, v10
v_bfe_u32 v15, v12, 4, 1
v_lshl_add_u32 v10, v10, 1, v15
v_lshlrev_b32 v2, 5, v10
s_getpc_b64 s[28:29]
L_pc15:
s_add_u32 s28, s28, L_P2Y-L_pc15
s_addc_u32 s29, s29, 0
s_mov_b32 s30, L_codeend-L_P2Y
s_mov_b32 s31, 0x20000
s_lshr_b32 s60, s2, 3
s_lshl_b32 s60, s60, 1
s_add_u32 s60, s60, s86
s_lshl_b32 s60, s60, 7
v_lshlrev_b32 v7, 13, v0
s_mov_b64 exec, 31
buffer_load_dword v7, v7, s[28:31], s60 offen
s_mov_b64 exec, -1
s_barrier
buffer_load_dword v6, off, s[12:15], 0 offset:128 sc1
s_barrier
s_waitcnt vmcnt(0)
s_mov_b32 s78, 40000
s_branch L_sc17
L_sp16:
s_sleep 3
L_sl19:
buffer_load_dword v6, off, s[12:15], 0 offset:128 sc1
s_waitcnt vmcnt(0)
L_sc17:
v_readfirstlane_b32 s60, v6
s_nop 0
s_cmp_eq_u32 s60, 4
s_cbranch_scc1 L_so18
s_sub_u32 s78, s78, 1
s_cmp_lg_u32 s78, 0
s_cbranch_scc1 L_sp16
L_so18:
s_mov_b32 s85, 65536
buffer_load_dwordx4 v[16:19], v9, s[20:23], s85 offen sc1
s_mov_b32 s85, 87040
buffer_load_dwordx4 v[20:23], v9, s[20:23], s85 offen sc1
s_mov_b32 s85, 108544
buffer_load_dwordx4 v[24:27], v9, s[20:23], s85 offen sc1
buffer_load_dwordx2 v[28:29], v2, s[24:27], 0 offen sc1
s_mul_i32 s83, s86, 24576
s_mul_i32 s84, s86, 46080
s_add_u32 s84, s84, s77
s_add_u32 s85, s91, 0
buffer_load_dwordx4 v[240:243], v14, s[20:23], s85 offen offset:0 sc1
s_add_u32 s85, s91, 0
buffer_load_dwordx4 v[244:247], v14, s[20:23], s85 offen offset:1024 sc1
s_add_u32 s85, s91, 0
buffer_load_dwordx4 v[248:251], v14, s[20:23], s85 offen offset:2048 sc1
s_barrier
s_add_u32 s85, s91, 0
buffer_load_dwordx4 v[252:255], v14, s[20:23], s85 offen offset:3072 sc1
s_add_u32 s85, s91, 4096
buffer_load_dwordx4 v[172:175], v14, s[20:23], s85 offen offset:0 sc1
s_add_u32 s85, s91, 4096
buffer_load_dwordx4 v[168:171], v14, s[20:23], s85 offen offset:1024 sc1
s_add_u32 s85, s91, 4096
buffer_load_dwordx4 v[164:167], v14, s[20:23], s85 offen offset:2048 sc1
s_waitcnt vmcnt(10)
s_add_u32 s85, s91, 4096
buffer_load_dwordx4 v[160:163], v14, s[20:23], s85 offen offset:3072 sc1
s_waitcnt vmcnt(10)
s_add_u32 s85, s91, 8192
buffer_load_dwordx4 v[156:159], v14, s[20:23], s85 offen offset:0 sc1
s_barrier
s_waitcnt vmcnt(9)
v_add_f32 v16, v16, v20
v_add_f32 v17, v17, v21
v_add_f32 v18, v18, v22
v_add_f32 v19, v19, v23
v_add_f32 v16, v16, v24
v_add_f32 v17, v17, v25
v_add_f32 v18, v18, v26
v_add_f32 v19, v19, v27
v_lshlrev_b32 v8, 2, v8
v_add_u32 v8, 141312, v8
ds_write_b128 v8, v[16:19]
v_xor_b32 v28, 0x80000000, v28
v_mul_f32 v32, v29, v29
v_rcp_f32 v31, v32
v_mul_f32 v30, v32, v29
v_mul_f32 v30, 0xbdd2d3e8, v30
v_mul_f32 v29, 0xc0135761, v29
v_lshlrev_b32 v12, 4, v12
v_add_u32 v12, 142848, v12
ds_write_b128 v12, v[28:31]
s_waitcnt lgkmcnt(0)
s_add_u32 s85, s91, 8192
buffer_load_dwordx4 v[152:155], v14, s[20:23], s85 offen offset:1024 sc1
s_add_u32 s85, s91, 8192
buffer_load_dwordx4 v[148:151], v14, s[20:23], s85 offen offset:2048 sc1
s_waitcnt vmcnt(10)
s_add_u32 s85, s91, 8192
buffer_load_dwordx4 v[144:147], v14, s[20:23], s85 offen offset:3072 sc1
s_waitcnt vmcnt(10)
s_add_u32 s85, s91, 12288
buffer_load_dwordx4 v[140:143], v14, s[20:23], s85 offen offset:0 sc1
s_barrier
s_add_u32 m0, s83, 0
s_add_u32 s85, s84, 0
s_waitcnt vmcnt(10)
buffer_load_dwordx4 v14, s[20:23], s85 offen offset:0 sc1 lds
s_waitcnt vmcnt(10)
buffer_load_dwordx4 v14, s[20:23], s85 offen offset:1024 sc1 lds
s_waitcnt vmcnt(10)
buffer_load_dwordx4 v14, s[20:23], s85 offen offset:2048 sc1 lds
s_waitcnt vmcnt(10)
buffer_load_dwordx4 v14, s[20:23], s85 offen offset:3072 sc1 lds
s_add_u32 m0, s83, 4096
s_add_u32 s85, s84, 4096
s_waitcnt vmcnt(10)
buffer_load_dwordx4 v14, s[20:23], s85 offen offset:0 sc1 lds
s_waitcnt vmcnt(10)
buffer_load_dwordx4 v14, s[20:23], s85 offen offset:1024 sc1 lds
s_add_u32 m0, s83, 49152
s_add_u32 s85, s84, 92160
s_waitcnt vmcnt(10)
buffer_load_dwordx4 v14, s[20:23], s85 offen offset:0 sc1 lds
s_waitcnt vmcnt(10)
buffer_load_dwordx4 v14, s[20:23], s85 offen offset:1024 sc1 lds
s_waitcnt vmcnt(10)
buffer_load_dwordx4 v14, s[20:23], s85 offen offset:2048 sc1 lds
s_waitcnt vmcnt(10)
buffer_load_dwordx4 v14, s[20:23], s85 offen offset:3072 sc1 lds
s_add_u32 m0, s83, 53248
s_add_u32 s85, s84, 96256
s_waitcnt vmcnt(10)
buffer_load_dwordx4 v14, s[20:23], s85 offen offset:0 sc1 lds
s_waitcnt vmcnt(10)
buffer_load_dwordx4 v14, s[20:23], s85 offen offset:1024 sc1 lds
s_barrier
s_add_u32 m0, s83, 6144
s_add_u32 s85, s84, 6144
s_waitcnt vmcnt(8)
buffer_load_dwordx4 v14, s[20:23], s85 offen offset:0 sc1 lds
s_waitcnt vmcnt(8)
buffer_load_dwordx4 v14, s[20:23], s85 offen offset:1024 sc1 lds
s_waitcnt vmcnt(8)
buffer_load_dwordx4 v14, s[20:23], s85 offen offset:2048 sc1 lds
s_waitcnt vmcnt(8)
buffer_load_dwordx4 v14, s[20:23], s85 offen offset:3072 sc1 lds
s_add_u32 m0, s83, 10240
s_add_u32 s85, s84, 10240
s_waitcnt vmcnt(8)
buffer_load_dwordx4 v14, s[20:23], s85 offen offset:0 sc1 lds
s_waitcnt vmcnt(8)
buffer_load_dwordx4 v14, s[20:23], s85 offen offset:1024 sc1 lds
s_add_u32 m0, s83, 55296
s_add_u32 s85, s84, 98304
s_waitcnt vmcnt(8)
buffer_load_dwordx4 v14, s[20:23], s85 offen offset:0 sc1 lds
s_waitcnt vmcnt(8)
buffer_load_dwordx4 v14, s[20:23], s85 offen offset:1024 sc1 lds
s_waitcnt vmcnt(8)
buffer_load_dwordx4 v14, s[20:23], s85 offen offset:2048 sc1 lds
s_waitcnt vmcnt(8)
buffer_load_dwordx4 v14, s[20:23], s85 offen offset:3072 sc1 lds
s_add_u32 m0, s83, 59392
s_add_u32 s85, s84, 102400
s_waitcnt vmcnt(8)
buffer_load_dwordx4 v14, s[20:23], s85 offen offset:0 sc1 lds
s_waitcnt vmcnt(8)
buffer_load_dwordx4 v14, s[20:23], s85 offen offset:1024 sc1 lds
s_waitcnt vmcnt(8)
s_add_u32 s85, s91, 12288
buffer_load_dwordx4 v[136:139], v14, s[20:23], s85 offen offset:1024 sc1
s_waitcnt vmcnt(8)
s_add_u32 s85, s91, 12288
buffer_load_dwordx4 v[132:135], v14, s[20:23], s85 offen offset:2048 sc1
s_waitcnt vmcnt(8)
s_add_u32 s85, s91, 12288
buffer_load_dwordx4 v[128:131], v14, s[20:23], s85 offen offset:3072 sc1
s_waitcnt vmcnt(8)
s_add_u32 s85, s91, 16384
buffer_load_dwordx4 v[124:127], v14, s[20:23], s85 offen offset:0 sc1
s_waitcnt vmcnt(8)
s_add_u32 s85, s91, 16384
buffer_load_dwordx4 v[120:123], v14, s[20:23], s85 offen offset:1024 sc1
s_waitcnt vmcnt(8)
s_add_u32 s85, s91, 16384
buffer_load_dwordx4 v[116:119], v14, s[20:23], s85 offen offset:2048 sc1
s_waitcnt vmcnt(8)
s_add_u32 s85, s91, 16384
buffer_load_dwordx4 v[112:115], v14, s[20:23], s85 offen offset:3072 sc1
s_waitcnt vmcnt(8)
s_add_u32 s85, s91, 20480
buffer_load_dwordx4 v[108:111], v14, s[20:23], s85 offen offset:0 sc1
s_barrier
s_setprio 0
s_waitcnt vmcnt(8)
s_add_u32 s85, s91, 20480
buffer_load_dwordx4 v[104:107], v14, s[20:23], s85 offen offset:1024 sc1
s_waitcnt vmcnt(8)
s_add_u32 s85, s91, 20480
buffer_load_dwordx4 v[100:103], v14, s[20:23], s85 offen offset:2048 sc1
s_waitcnt vmcnt(8)
s_add_u32 s85, s91, 20480
buffer_load_dwordx4 v[96:99], v14, s[20:23], s85 offen offset:3072 sc1
s_waitcnt vmcnt(8)
s_add_u32 s85, s91, 24576
buffer_load_dwordx4 v[92:95], v14, s[20:23], s85 offen offset:0 sc1
s_waitcnt vmcnt(8)
s_add_u32 s85, s91, 24576
buffer_load_dwordx4 v[88:91], v14, s[20:23], s85 offen offset:1024 sc1
s_waitcnt vmcnt(8)
s_add_u32 s85, s91, 24576
buffer_load_dwordx4 v[84:87], v14, s[20:23], s85 offen offset:2048 sc1
s_waitcnt vmcnt(8)
s_add_u32 s85, s91, 24576
buffer_load_dwordx4 v[80:83], v14, s[20:23], s85 offen offset:3072 sc1
s_waitcnt vmcnt(8)
s_add_u32 s85, s91, 28672
buffer_load_dwordx4 v[76:79], v14, s[20:23], s85 offen offset:0 sc1
s_lshl_b32 s60, s86, 2
s_add_u32 s60, s60, 146688
v_mov_b32 v4, s60
v_mov_b32 v7, 1
s_mov_b64 exec, 1
ds_write_b32 v4, v7
s_mov_b64 exec, -1
s_waitcnt vmcnt(8)
s_add_u32 s85, s91, 28672
buffer_load_dwordx4 v[72:75], v14, s[20:23], s85 offen offset:1024 sc1
s_waitcnt vmcnt(8)
s_add_u32 s85, s91, 28672
buffer_load_dwordx4 v[68:71], v14, s[20:23], s85 offen offset:2048 sc1
s_waitcnt vmcnt(8)
s_add_u32 s85, s91, 28672
buffer_load_dwordx4 v[64:67], v14, s[20:23], s85 offen offset:3072 sc1
s_waitcnt vmcnt(8)
s_add_u32 s85, s91, 32768
buffer_load_dwordx4 v[60:63], v14, s[20:23], s85 offen offset:0 sc1
s_waitcnt vmcnt(8)
s_add_u32 s85, s91, 32768
buffer_load_dwordx4 v[56:59], v14, s[20:23], s85 offen offset:1024 sc1
s_waitcnt vmcnt(8)
s_add_u32 s85, s91, 32768
buffer_load_dwordx4 v[52:55], v14, s[20:23], s85 offen offset:2048 sc1
s_lshl_b32 s61, s81, 14
s_add_u32 s61, s61, 98304
s_add_u32 m0, s61, 0
s_add_u32 s85, s91, 35840
s_waitcnt vmcnt(8)
buffer_load_dwordx4 v14, s[20:23], s85 offen offset:0 sc1 lds
s_waitcnt vmcnt(8)
buffer_load_dwordx4 v14, s[20:23], s85 offen offset:1024 sc1 lds
s_waitcnt vmcnt(8)
buffer_load_dwordx4 v14, s[20:23], s85 offen offset:2048 sc1 lds
s_waitcnt vmcnt(8)
buffer_load_dwordx4 v14, s[20:23], s85 offen offset:3072 sc1 lds
s_add_u32 m0, s61, 4096
s_add_u32 s85, s91, 39936
s_waitcnt vmcnt(8)
buffer_load_dwordx4 v14, s[20:23], s85 offen offset:0 sc1 lds
s_waitcnt vmcnt(8)
buffer_load_dwordx4 v14, s[20:23], s85 offen offset:1024 sc1 lds
s_waitcnt vmcnt(8)
buffer_load_dwordx4 v14, s[20:23], s85 offen offset:2048 sc1 lds
s_waitcnt vmcnt(8)
buffer_load_dwordx4 v14, s[20:23], s85 offen offset:3072 sc1 lds
s_add_u32 m0, s61, 8192
s_add_u32 s85, s91, 44032
s_waitcnt vmcnt(8)
buffer_load_dwordx4 v14, s[20:23], s85 offen offset:0 sc1 lds
s_waitcnt vmcnt(8)
buffer_load_dwordx4 v14, s[20:23], s85 offen offset:1024 sc1 lds
s_barrier
s_branch L_P2Y
L_SIDEA:
s_lshl_b32 s60, s2, 1
s_add_u32 s60, s60, s86
s_mul_i32 s61, s60, 349526
s_lshr_b32 s61, s61, 20
s_mul_i32 s62, s61, 3
s_sub_u32 s62, s60, s62
s_cmp_eq_u32 s62, 1
s_cselect_b64 s[28:29], s[44:45], s[46:47]
s_cmp_eq_u32 s62, 0
s_cselect_b64 s[28:29], s[38:39], s[28:29]
s_mov_b32 s30, 2211840
s_cmov_b32 s30, 2457600
s_mov_b32 s31, 0x20000
s_lshl_b32 s64, s61, 13
s_cmp_eq_u32 s62, 2
s_subb_u32 s65, 75, 0
s_lshl_b32 s65, s65, 13
v_lshlrev_b32 v16, 7, v0
buffer_load_dword v17, v16, s[28:31], s64 offen
s_add_u32 s64, s64, s65
v_lshlrev_b32 v14, 4, v0
v_and_b32 v5, 7, v0
s_mov_b64 s[20:21], s[54:55]
s_mov_b32 s22, 25165824
s_mov_b32 s23, 0x20000
s_mov_b64 s[24:25], s[54:55]
s_mov_b32 s26, 65536
s_mov_b32 s27, 0x20000
s_mul_i32 s84, s86, 112
s_add_u32 s84, s84, s2
s_add_u32 s84, s84, 288
s_lshl_b32 s88, s86, 13
s_add_u32 s88, s88, 147456
v_lshrrev_b32 v6, 4, v0
v_bfe_u32 v7, v0, 2, 2
v_lshlrev_b32 v144, 10, v6
v_lshl_add_u32 v144, v7, 7, v144
v_lshrrev_b32 v7, 1, v7
v_and_b32 v6, 1, v6
v_lshl_or_b32 v7, v6, 1, v7
v_lshl_add_u32 v144, v7, 5, v144
v_and_b32 v7, 3, v0
v_lshl_add_u32 v144, v7, 3, v144
v_add_u32 v144, s88, v144
v_xor_b32 v145, 32, v144
v_xor_b32 v146, 64, v144
v_xor_b32 v147, 96, v144
s_mul_i32 s68, s84, 209716
s_lshr_b32 s68, s68, 20
s_mul_i32 s69, s68, 5
s_sub_u32 s69, s84, s69
s_lshl_b32 s69, s69, 1
s_cmp_lt_u32 s84, 370
s_cselect_b32 s84, 2, 0
s_sub_u32 s70, s68, 20
s_max_i32 s70, s70, 0
s_mul_i32 s71, s70, 209716
s_lshr_b32 s71, s71, 20
s_mul_i32 s73, s71, 5
s_sub_u32 s73, s70, s73
s_mov_b32 s72, 0x80c2040
s_cmp_eq_u32 s71, 1
s_cmov_b32 s72, 0x62ca144
s_cmp_eq_u32 s71, 2
s_cmov_b32 s72, 0x103ce247
s_cmp_eq_u32 s71, 3
s_cmov_b32 s72, 0xd317591
s_cmp_eq_u32 s71, 4
s_cmov_b32 s72, 0x2275c554
s_cmp_eq_u32 s71, 5
s_cmov_b32 s72, 0x1a4d2a23
s_cmp_eq_u32 s71, 6
s_cmov_b32 s72, 0x34beea5b
s_cmp_eq_u32 s71, 7
s_cmov_b32 s72, 0x1f799635
s_cmp_eq_u32 s71, 8
s_cmov_b32 s72, 0x279a1824
s_cmp_eq_u32 s71, 9
s_cmov_b32 s72, 0x31c2baa5
s_cmp_eq_u32 s71, 10
s_cmov_b32 s72, 0xcf2b6c
s_mul_i32 s73, s73, 6
s_lshr_b32 s72, s72, s73
s_and_b32 s72, s72, 63
s_lshl_b32 s72, s72, 5
s_mul_i32 s73, s68, 40
s_mul_i32 s74, s68, 160
s_sub_u32 s74, s74, 2544
s_cmp_lt_u32 s68, 16
s_cselect_b32 s73, s73, s74
s_cselect_b32 s75, 4, 40
s_cmp_lt_u32 s68, 20
s_cselect_b32 s72, s73, s72
s_cselect_b32 s75, s75, 4
s_cselect_b32 s76, 20, 16
s_cselect_b64 s[32:33], s[40:41], s[48:49]
s_mov_b32 s34, 2211840
s_cselect_b32 s34, 819200, s34
s_mov_b32 s35, 0x20000
s_cmp_lt_u32 s68, 74
s_cselect_b32 s74, 0, 1073741824
s_mul_i32 s72, s72, 1280
s_lshl_b32 s70, s69, 7
s_add_u32 s72, s72, s70
s_add_u32 s72, s72, s74
s_mul_i32 s75, s75, 1280
s_sub_u32 s75, s75, 1024
v_lshrrev_b32 v6, 5, v0
v_bfe_u32 v7, v0, 3, 2
v_mad_u32_u24 v6, v6, s76, v7
v_mul_u32_u24 v6, 1280, v6
v_and_b32 v7, 2, v7
v_xor_b32 v7, v7, v5
v_lshl_add_u32 v6, v7, 4, v6
v_add_u32 v136, s72, v6
v_xor_b32 v6, 64, v6
s_add_u32 s72, s72, s75
v_add_u32 v137, s72, v6
s_lshl_b32 s75, s75, 1
v_add_u32 v138, s75, v136
v_add_u32 v139, s75, v137
s_mul_i32 s73, s68, 5120
s_add_u32 s74, s74, 1048576
s_add_u32 s74, s74, s73
s_lshl_b32 s70, s69, 2
v_and_b32 v6, 15, v0
v_add_u32 v6, s70, v6
v_mul_u32_u24 v7, 52, v6
v_lshrrev_b32 v7, 8, v7
v_mad_i32_i24 v6, v7, -5, v6
v_and_b32 v140, 1, v7
v_sub_u32 v6, v6, v140
v_min_u32 v6, 4, v6
v_mul_u32_u24 v7, 370, v7
v_add_u32 v6, v6, v7
v_lshl_add_u32 v140, v6, 10, s74
v_lshlrev_b32 v177, 5, v177
v_lshl_add_u32 v177, v178, 3, v177
v_mov_b32 v184, 0x3f803f80
v_mov_b32 v185, 0x3f80
v_mov_b32 v186, 0x3f800000
s_waitcnt vmcnt(1)
v_dot2_f32_bf16 v180, v188, v184, 0
v_dot2_f32_bf16 v181, v189, v184, 0
v_dot2_f32_bf16 v180, v190, v184, v180
v_dot2_f32_bf16 v181, v191, v184, v181
v_dot2_f32_bf16 v180, v192, v184, v180
v_dot2_f32_bf16 v181, v193, v184, v181
v_dot2_f32_bf16 v180, v194, v184, v180
v_dot2_f32_bf16 v181, v195, v184, v181
v_dot2_f32_bf16 v180, v196, v184, v180
v_dot2_f32_bf16 v181, v197, v184, v181
v_dot2_f32_bf16 v180, v198, v184, v180
v_dot2_f32_bf16 v181, v199, v184, v181
v_dot2_f32_bf16 v180, v200, v184, v180
v_dot2_f32_bf16 v181, v201, v184, v181
v_dot2_f32_bf16 v180, v202, v184, v180
v_dot2_f32_bf16 v181, v203, v184, v181
v_dot2_f32_bf16 v180, v204, v184, v180
v_dot2_f32_bf16 v181, v205, v184, v181
v_dot2_f32_bf16 v180, v206, v184, v180
v_dot2_f32_bf16 v181, v207, v184, v181
s_nop 2
v_add_f32 v180, v180, v181
s_nop 1
v_add_f32_dpp v180, v180, v180 row_ror:8 row_mask:0xf bank_mask:0xf
s_nop 1
v_add_f32_dpp v180, v180, v180 row_ror:4 row_mask:0xf bank_mask:0xf
s_nop 1
v_add_f32_dpp v180, v180, v180 row_ror:2 row_mask:0xf bank_mask:0xf
s_nop 1
v_add_f32_dpp v180, v180, v180 row_ror:1 row_mask:0xf bank_mask:0xf
v_mul_f32 v181, 0xbacccccd, v180
v_dot2_f32_bf16 v208, v188, v185, v181
v_dot2_f32_bf16 v209, v188, v186, v181
v_dot2_f32_bf16 v210, v189, v185, v181
v_dot2_f32_bf16 v211, v189, v186, v181
v_dot2_f32_bf16 v212, v190, v185, v181
v_dot2_f32_bf16 v213, v190, v186, v181
v_dot2_f32_bf16 v214, v191, v185, v181
v_dot2_f32_bf16 v215, v191, v186, v181
v_dot2_f32_bf16 v216, v192, v185, v181
v_dot2_f32_bf16 v217, v192, v186, v181
v_dot2_f32_bf16 v218, v193, v185, v181
v_dot2_f32_bf16 v219, v193, v186, v181
v_dot2_f32_bf16 v220, v194, v185, v181
v_dot2_f32_bf16 v221, v194, v186, v181
v_dot2_f32_bf16 v222, v195, v185, v181
v_dot2_f32_bf16 v223, v195, v186, v181
v_dot2_f32_bf16 v224, v196, v185, v181
v_dot2_f32_bf16 v225, v196, v186, v181
v_dot2_f32_bf16 v226, v197, v185, v181
v_dot2_f32_bf16 v227, v197, v186, v181
v_dot2_f32_bf16 v228, v198, v185, v181
v_dot2_f32_bf16 v229, v198, v186, v181
v_dot2_f32_bf16 v230, v199, v185, v181
v_dot2_f32_bf16 v231, v199, v186, v181
v_dot2_f32_bf16 v232, v200, v185, v181
v_dot2_f32_bf16 v233, v200, v186, v181
v_dot2_f32_bf16 v234, v201, v185, v181
v_dot2_f32_bf16 v235, v201, v186, v181
v_dot2_f32_bf16 v236, v202, v185, v181
v_dot2_f32_bf16 v237, v202, v186, v181
v_dot2_f32_bf16 v238, v203, v185, v181
v_dot2_f32_bf16 v239, v203, v186, v181
v_dot2_f32_bf16 v240, v204, v185, v181
v_dot2_f32_bf16 v241, v204, v186, v181
v_dot2_f32_bf16 v242, v205, v185, v181
v_dot2_f32_bf16 v243, v205, v186, v181
v_dot2_f32_bf16 v244, v206, v185, v181
v_dot2_f32_bf16 v245, v206, v186, v181
v_dot2_f32_bf16 v246, v207, v185, v181
v_dot2_f32_bf16 v247, v207, v186, v181
v_pk_mul_f32 v[182:183], v[208:209], v[208:209]
v_pk_fma_f32 v[182:183], v[210:211], v[210:211], v[182:183]
v_pk_fma_f32 v[182:183], v[212:213], v[212:213], v[182:183]
v_pk_fma_f32 v[182:183], v[214:215], v[214:215], v[182:183]
v_pk_fma_f32 v[182:183], v[216:217], v[216:217], v[182:183]
v_pk_fma_f32 v[182:183], v[218:219], v[218:219], v[182:183]
v_pk_fma_f32 v[182:183], v[220:221], v[220:221], v[182:183]
v_pk_fma_f32 v[182:183], v[222:223], v[222:223], v[182:183]
v_pk_fma_f32 v[182:183], v[224:225], v[224:225], v[182:183]
v_pk_fma_f32 v[182:183], v[226:227], v[226:227], v[182:183]
v_pk_fma_f32 v[182:183], v[228:229], v[228:229], v[182:183]
v_pk_fma_f32 v[182:183], v[230:231], v[230:231], v[182:183]
v_pk_fma_f32 v[182:183], v[232:233], v[232:233], v[182:183]
v_pk_fma_f32 v[182:183], v[234:235], v[234:235], v[182:183]
v_pk_fma_f32 v[182:183], v[236:237], v[236:237], v[182:183]
v_pk_fma_f32 v[182:183], v[238:239], v[238:239], v[182:183]
v_pk_fma_f32 v[182:183], v[240:241], v[240:241], v[182:183]
v_pk_fma_f32 v[182:183], v[242:243], v[242:243], v[182:183]
v_pk_fma_f32 v[182:183], v[244:245], v[244:245], v[182:183]
v_pk_fma_f32 v[182:183], v[246:247], v[246:247], v[182:183]
v_add_f32 v182, v182, v183
s_nop 1
v_add_f32_dpp v182, v182, v182 row_ror:8 row_mask:0xf bank_mask:0xf
s_nop 1
v_add_f32_dpp v182, v182, v182 row_ror:4 row_mask:0xf bank_mask:0xf
s_nop 1
v_add_f32_dpp v182, v182, v182 row_ror:2 row_mask:0xf bank_mask:0xf
s_nop 1
v_add_f32_dpp v182, v182, v182 row_ror:1 row_mask:0xf bank_mask:0xf
v_mul_f32 v180, 0x3acccccd, v180
v_mov_b32 v181, 0x3727c5ac
v_fmac_f32 v181, 0x3acccccd, v182
v_rsq_f32 v181, v181
s_mov_b32 exec_lo, 0x000f000f
s_mov_b32 exec_hi, 0x000f000f
buffer_store_dwordx2 v[180:181], v177, s[24:27], 0 offen sc1
s_mov_b64 exec, -1
v_lshlrev_b32 v4, 2, v0
v_add_u32 v4, 146688, v4
v_mov_b32 v7, 0
s_mov_b64 exec, 0xff
ds_write_b32 v4, v7
s_mov_b64 exec, -1
s_waitcnt lgkmcnt(0)
s_setprio 2
s_barrier
s_barrier
buffer_load_dword v17, v16, s[28:31], s64 offen
s_add_u32 s64, s64, s65
s_barrier
buffer_load_dword v17, v16, s[28:31], s64 offen
s_add_u32 s64, s64, s65
s_barrier
s_cmp_le_u32 s84, 1
s_cbranch_scc1 L_sk21
s_add_u32 m0, s88, 4096
s_movk_i32 s60, 128
buffer_load_dwordx4 v136, s[32:35], s60 offen offset:0 lds
buffer_load_dwordx4 v137, s[32:35], s60 offen offset:1024 lds
buffer_load_dwordx4 v138, s[32:35], s60 offen offset:2048 lds
buffer_load_dwordx4 v139, s[32:35], s60 offen offset:3072 lds
L_sk21:
s_cmp_le_u32 s84, 0
s_cbranch_scc1 L_sk20
s_add_u32 m0, s88, 0
s_movk_i32 s60, 0
buffer_load_dwordx4 v136, s[32:35], s60 offen offset:0 lds
buffer_load_dwordx4 v137, s[32:35], s60 offen offset:1024 lds
buffer_load_dwordx4 v138, s[32:35], s60 offen offset:2048 lds
buffer_load_dwordx4 v139, s[32:35], s60 offen offset:3072 lds
L_sk20:
buffer_load_dword v17, v16, s[28:31], s64 offen
s_add_u32 s64, s64, s65
s_barrier
s_barrier
s_waitcnt vmcnt(1)
s_cmp_le_u32 s84, 0
s_cbranch_scc1 L_sk22
ds_read_b64_tr_b16 v[152:153], v144 offset:0
ds_read_b64_tr_b16 v[154:155], v144 offset:512
ds_read_b64_tr_b16 v[156:157], v145 offset:0
ds_read_b64_tr_b16 v[158:159], v145 offset:512
ds_read_b64_tr_b16 v[160:161], v146 offset:0
ds_read_b64_tr_b16 v[162:163], v146 offset:512
ds_read_b64_tr_b16 v[164:165], v147 offset:0
ds_read_b64_tr_b16 v[166:167], v147 offset:512
v_readlane_b32 s68, v140, 0
v_readlane_b32 s69, v140, 1
v_readlane_b32 s70, v140, 2
v_readlane_b32 s71, v140, 3
s_waitcnt lgkmcnt(0)
s_nop 0
buffer_store_dwordx4 v[152:155], v14, s[20:23], s68 offen sc1
buffer_store_dwordx4 v[156:159], v14, s[20:23], s69 offen sc1
buffer_store_dwordx4 v[160:163], v14, s[20:23], s70 offen sc1
buffer_store_dwordx4 v[164:167], v14, s[20:23], s71 offen sc1
L_sk22:
s_barrier
s_barrier
s_waitcnt vmcnt(1)
s_cmp_le_u32 s84, 1
s_cbranch_scc1 L_sk23
ds_read_b64_tr_b16 v[152:153], v144 offset:4096
ds_read_b64_tr_b16 v[154:155], v144 offset:4608
ds_read_b64_tr_b16 v[156:157], v145 offset:4096
ds_read_b64_tr_b16 v[158:159], v145 offset:4608
ds_read_b64_tr_b16 v[160:161], v146 offset:4096
ds_read_b64_tr_b16 v[162:163], v146 offset:4608
ds_read_b64_tr_b16 v[164:165], v147 offset:4096
ds_read_b64_tr_b16 v[166:167], v147 offset:4608
v_readlane_b32 s68, v140, 4
v_readlane_b32 s69, v140, 5
v_readlane_b32 s70, v140, 6
v_readlane_b32 s71, v140, 7
s_waitcnt lgkmcnt(0)
s_nop 0
buffer_store_dwordx4 v[152:155], v14, s[20:23], s68 offen sc1
buffer_store_dwordx4 v[156:159], v14, s[20:23], s69 offen sc1
buffer_store_dwordx4 v[160:163], v14, s[20:23], s70 offen sc1
buffer_store_dwordx4 v[164:167], v14, s[20:23], s71 offen sc1
L_sk23:
s_barrier
s_waitcnt vmcnt(0)
s_barrier
s_mov_b64 s[12:13], s[52:53]
s_mov_b32 s14, 256
s_mov_b32 s15, 0x20000
s_and_b32 s60, s2, 7
s_lshr_b32 s61, s2, 6
s_lshl_b32 s60, s60, 2
s_add_u32 s60, s60, s61
s_bfe_u32 s61, s2, 0x30003
s_sub_u32 s62, s56, 2
s_cmp_lt_u32 s56, 4
s_cselect_b32 s62, s56, s62
s_mul_i32 s62, s62, 9
s_add_u32 s62, s62, 20
s_sub_u32 s63, s56, 4
s_mul_i32 s67, s63, 10
s_cmp_lt_u32 s63, 2
s_cselect_b32 s62, s67, s62
s_mul_i32 s67, s60, 74
s_add_u32 s67, s67, s62
s_lshl_b32 s67, s67, 12
s_add_u32 s90, s67, 4194304
s_mul_i32 s67, s61, 74
s_add_u32 s67, s67, s62
s_mul_i32 s67, s67, 5120
s_add_u32 s91, s67, 1048576
s_barrier
s_mul_i32 s67, s61, 378880
s_add_u32 s77, s67, 1150976
s_mul_i32 s92, s60, 81920
s_mul_i32 s67, s61, 160
s_add_u32 s92, s92, s67
s_sub_u32 s62, s56, 2
s_cmp_lt_u32 s56, 4
s_cselect_b32 s62, s56, s62
s_mul_i32 s89, s60, 6
s_add_u32 s89, s89, s62
s_lshl_b32 s89, s89, 7
s_add_u32 s89, s89, 262144
v_min_u32 v8, 47, v0
s_mul_i32 s60, s86, 192
v_lshl_add_u32 v8, v8, 2, s60
v_lshrrev_b32 v9, 6, v8
v_and_b32 v10, 63, v8
v_lshrrev_b32 v11, 1, v9
v_and_b32 v9, 1, v9
v_mad_u32_u24 v9, v11, 10, v9
v_add_u32 v9, s59, v9
v_lshlrev_b32 v9, 8, v9
v_lshl_add_u32 v9, v10, 2, v9
v_min_u32 v12, 39, v0
s_mul_i32 s60, s86, 80
s_add_u32 s60, s60, 0
v_add_u32 v12, s60, v12
s_barrier
v_lshrrev_b32 v10, 5, v12
v_and_b32 v15, 15, v12
v_lshl_add_u32 v10, v10, 4, v15
v_add_u32 v10, s57, v10
v_bfe_u32 v15, v12, 4, 1
v_lshl_add_u32 v10, v10, 1, v15
v_lshlrev_b32 v2, 5, v10
v_min_u32 v13, 39, v0
s_mul_i32 s60, s86, 80
s_add_u32 s60, s60, 40
v_add_u32 v13, s60, v13
v_lshrrev_b32 v10, 5, v13
v_and_b32 v15, 15, v13
v_lshl_add_u32 v10, v10, 4, v15
v_add_u32 v10, s57, v10
v_bfe_u32 v15, v13, 4, 1
v_lshl_add_u32 v10, v10, 1, v15
v_lshlrev_b32 v3, 5, v10
s_barrier
s_barrier
s_barrier
s_barrier
s_barrier
s_getpc_b64 s[28:29]
L_pc24:
s_add_u32 s28, s28, L_P2Y-L_pc24
s_addc_u32 s29, s29, 0
s_mov_b32 s30, L_codeend-L_P2Y
s_mov_b32 s31, 0x20000
s_lshr_b32 s60, s2, 3
s_lshl_b32 s60, s60, 1
s_add_u32 s60, s60, s86
s_lshl_b32 s60, s60, 7
v_lshlrev_b32 v7, 13, v0
s_mov_b64 exec, 31
buffer_load_dword v7, v7, s[28:31], s60 offen
s_mov_b64 exec, -1
s_barrier
buffer_load_dword v6, off, s[12:15], 0 offset:128 sc1
s_barrier
s_waitcnt vmcnt(0)
s_mov_b32 s78, 40000
s_branch L_sc26
L_sp25:
s_sleep 3
L_sl28:
buffer_load_dword v6, off, s[12:15], 0 offset:128 sc1
s_waitcnt vmcnt(0)
L_sc26:
v_readfirstlane_b32 s60, v6
s_nop 0
s_cmp_eq_u32 s60, 4
s_cbranch_scc1 L_so27
s_sub_u32 s78, s78, 1
s_cmp_lg_u32 s78, 0
s_cbranch_scc1 L_sp25
L_so27:
s_mov_b32 s85, 65536
buffer_load_dwordx4 v[16:19], v9, s[20:23], s85 offen sc1
s_mov_b32 s85, 87040
buffer_load_dwordx4 v[20:23], v9, s[20:23], s85 offen sc1
s_mov_b32 s85, 108544
buffer_load_dwordx4 v[24:27], v9, s[20:23], s85 offen sc1
buffer_load_dwordx2 v[28:29], v2, s[24:27], 0 offen sc1
buffer_load_dwordx2 v[32:33], v3, s[24:27], 0 offen sc1
s_mul_i32 s83, s86, 24576
s_mul_i32 s84, s86, 46080
s_add_u32 s84, s84, s77
s_add_u32 s85, s91, 0
buffer_load_dwordx4 v[240:243], v14, s[20:23], s85 offen offset:0 sc1
s_add_u32 s85, s91, 0
buffer_load_dwordx4 v[244:247], v14, s[20:23], s85 offen offset:1024 sc1
s_add_u32 s85, s91, 0
buffer_load_dwordx4 v[248:251], v14, s[20:23], s85 offen offset:2048 sc1
s_add_u32 s85, s91, 0
buffer_load_dwordx4 v[252:255], v14, s[20:23], s85 offen offset:3072 sc1
s_add_u32 s85, s91, 4096
buffer_load_dwordx4 v[172:175], v14, s[20:23], s85 offen offset:0 sc1
s_add_u32 s85, s91, 4096
buffer_load_dwordx4 v[168:171], v14, s[20:23], s85 offen offset:1024 sc1
s_barrier
s_waitcnt vmcnt(10)
s_add_u32 s85, s91, 4096
buffer_load_dwordx4 v[164:167], v14, s[20:23], s85 offen offset:2048 sc1
s_waitcnt vmcnt(10)
s_add_u32 s85, s91, 4096
buffer_load_dwordx4 v[160:163], v14, s[20:23], s85 offen offset:3072 sc1
s_waitcnt vmcnt(10)
s_add_u32 s85, s91, 8192
buffer_load_dwordx4 v[156:159], v14, s[20:23], s85 offen offset:0 sc1
s_waitcnt vmcnt(10)
s_add_u32 s85, s91, 8192
buffer_load_dwordx4 v[152:155], v14, s[20:23], s85 offen offset:1024 sc1
s_waitcnt vmcnt(10)
s_add_u32 s85, s91, 8192
buffer_load_dwordx4 v[148:151], v14, s[20:23], s85 offen offset:2048 sc1
s_waitcnt vmcnt(10)
s_add_u32 s85, s91, 8192
buffer_load_dwordx4 v[144:147], v14, s[20:23], s85 offen offset:3072 sc1
s_waitcnt vmcnt(10)
s_add_u32 s85, s91, 12288
buffer_load_dwordx4 v[140:143], v14, s[20:23], s85 offen offset:0 sc1
s_barrier
v_add_f32 v16, v16, v20
v_add_f32 v17, v17, v21
v_add_f32 v18, v18, v22
v_add_f32 v19, v19, v23
v_add_f32 v16, v16, v24
v_add_f32 v17, v17, v25
v_add_f32 v18, v18, v26
v_add_f32 v19, v19, v27
v_lshlrev_b32 v8, 2, v8
v_add_u32 v8, 141312, v8
ds_write_b128 v8, v[16:19]
v_xor_b32 v28, 0x80000000, v28
v_lshlrev_b32 v10, 3, v12
v_add_u32 v10, 142848, v10
v_lshlrev_b32 v12, 2, v12
v_add_u32 v12, 145408, v12
ds_write_b64 v10, v[28:29]
ds_write_b32 v12, v28
ds_write_b32 v12, v29 offset:640
v_xor_b32 v32, 0x80000000, v32
v_lshlrev_b32 v10, 3, v13
v_add_u32 v10, 142848, v10
v_lshlrev_b32 v13, 2, v13
v_add_u32 v13, 145408, v13
ds_write_b64 v10, v[32:33]
ds_write_b32 v13, v32
ds_write_b32 v13, v33 offset:640
s_waitcnt lgkmcnt(0)
s_waitcnt vmcnt(10)
s_add_u32 s85, s91, 12288
buffer_load_dwordx4 v[136:139], v14, s[20:23], s85 offen offset:1024 sc1
s_waitcnt vmcnt(10)
s_add_u32 s85, s91, 12288
buffer_load_dwordx4 v[132:135], v14, s[20:23], s85 offen offset:2048 sc1
s_waitcnt vmcnt(10)
s_add_u32 s85, s91, 12288
buffer_load_dwordx4 v[128:131], v14, s[20:23], s85 offen offset:3072 sc1
s_waitcnt vmcnt(10)
s_add_u32 s85, s91, 16384
buffer_load_dwordx4 v[124:127], v14, s[20:23], s85 offen offset:0 sc1
s_waitcnt vmcnt(10)
s_add_u32 s85, s91, 16384
buffer_load_dwordx4 v[120:123], v14, s[20:23], s85 offen offset:1024 sc1
s_waitcnt vmcnt(10)
s_add_u32 s85, s91, 16384
buffer_load_dwordx4 v[116:119], v14, s[20:23], s85 offen offset:2048 sc1
s_waitcnt vmcnt(10)
s_add_u32 s85, s91, 16384
buffer_load_dwordx4 v[112:115], v14, s[20:23], s85 offen offset:3072 sc1
s_setprio 0
s_barrier
s_add_u32 m0, s83, 0
s_add_u32 s85, s84, 0
s_waitcnt vmcnt(8)
buffer_load_dwordx4 v14, s[20:23], s85 offen offset:0 sc1 lds
s_waitcnt vmcnt(8)
buffer_load_dwordx4 v14, s[20:23], s85 offen offset:1024 sc1 lds
s_waitcnt vmcnt(8)
buffer_load_dwordx4 v14, s[20:23], s85 offen offset:2048 sc1 lds
s_waitcnt vmcnt(8)
buffer_load_dwordx4 v14, s[20:23], s85 offen offset:3072 sc1 lds
s_add_u32 m0, s83, 4096
s_add_u32 s85, s84, 4096
s_waitcnt vmcnt(8)
buffer_load_dwordx4 v14, s[20:23], s85 offen offset:0 sc1 lds
s_waitcnt vmcnt(8)
buffer_load_dwordx4 v14, s[20:23], s85 offen offset:1024 sc1 lds
s_add_u32 m0, s83, 49152
s_add_u32 s85, s84, 92160
s_waitcnt vmcnt(8)
buffer_load_dwordx4 v14, s[20:23], s85 offen offset:0 sc1 lds
s_waitcnt vmcnt(8)
buffer_load_dwordx4 v14, s[20:23], s85 offen offset:1024 sc1 lds
s_waitcnt vmcnt(8)
buffer_load_dwordx4 v14, s[20:23], s85 offen offset:2048 sc1 lds
s_waitcnt vmcnt(8)
buffer_load_dwordx4 v14, s[20:23], s85 offen offset:3072 sc1 lds
s_add_u32 m0, s83, 53248
s_add_u32 s85, s84, 96256
s_waitcnt vmcnt(8)
buffer_load_dwordx4 v14, s[20:23], s85 offen offset:0 sc1 lds
s_waitcnt vmcnt(8)
buffer_load_dwordx4 v14, s[20:23], s85 offen offset:1024 sc1 lds
s_add_u32 m0, s83, 6144
s_add_u32 s85, s84, 6144
s_waitcnt vmcnt(8)
buffer_load_dwordx4 v14, s[20:23], s85 offen offset:0 sc1 lds
s_waitcnt vmcnt(8)
buffer_load_dwordx4 v14, s[20:23], s85 offen offset:1024 sc1 lds
s_waitcnt vmcnt(8)
buffer_load_dwordx4 v14, s[20:23], s85 offen offset:2048 sc1 lds
s_waitcnt vmcnt(8)
buffer_load_dwordx4 v14, s[20:23], s85 offen offset:3072 sc1 lds
s_add_u32 m0, s83, 10240
s_add_u32 s85, s84, 10240
s_waitcnt vmcnt(8)
buffer_load_dwordx4 v14, s[20:23], s85 offen offset:0 sc1 lds
s_waitcnt vmcnt(8)
buffer_load_dwordx4 v14, s[20:23], s85 offen offset:1024 sc1 lds
s_add_u32 m0, s83, 55296
s_add_u32 s85, s84, 98304
s_waitcnt vmcnt(8)
buffer_load_dwordx4 v14, s[20:23], s85 offen offset:0 sc1 lds
s_waitcnt vmcnt(8)
buffer_load_dwordx4 v14, s[20:23], s85 offen offset:1024 sc1 lds
s_waitcnt vmcnt(8)
buffer_load_dwordx4 v14, s[20:23], s85 offen offset:2048 sc1 lds
s_waitcnt vmcnt(8)
buffer_load_dwordx4 v14, s[20:23], s85 offen offset:3072 sc1 lds
s_add_u32 m0, s83, 59392
s_add_u32 s85, s84, 102400
s_waitcnt vmcnt(8)
buffer_load_dwordx4 v14, s[20:23], s85 offen offset:0 sc1 lds
s_waitcnt vmcnt(8)
buffer_load_dwordx4 v14, s[20:23], s85 offen offset:1024 sc1 lds
s_waitcnt vmcnt(8)
s_add_u32 s85, s91, 20480
buffer_load_dwordx4 v[108:111], v14, s[20:23], s85 offen offset:0 sc1
s_waitcnt vmcnt(8)
s_add_u32 s85, s91, 20480
buffer_load_dwordx4 v[104:107], v14, s[20:23], s85 offen offset:1024 sc1
s_waitcnt vmcnt(8)
s_add_u32 s85, s91, 20480
buffer_load_dwordx4 v[100:103], v14, s[20:23], s85 offen offset:2048 sc1
s_waitcnt vmcnt(8)
s_add_u32 s85, s91, 20480
buffer_load_dwordx4 v[96:99], v14, s[20:23], s85 offen offset:3072 sc1
s_waitcnt vmcnt(8)
s_add_u32 s85, s91, 24576
buffer_load_dwordx4 v[92:95], v14, s[20:23], s85 offen offset:0 sc1
s_waitcnt vmcnt(8)
s_add_u32 s85, s91, 24576
buffer_load_dwordx4 v[88:91], v14, s[20:23], s85 offen offset:1024 sc1
s_waitcnt vmcnt(8)
s_add_u32 s85, s91, 24576
buffer_load_dwordx4 v[84:87], v14, s[20:23], s85 offen offset:2048 sc1
s_waitcnt vmcnt(8)
s_add_u32 s85, s91, 24576
buffer_load_dwordx4 v[80:83], v14, s[20:23], s85 offen offset:3072 sc1
s_lshl_b32 s60, s86, 2
s_add_u32 s60, s60, 146688
v_mov_b32 v4, s60
v_mov_b32 v7, 1
s_waitcnt vmcnt(8)
s_mov_b64 exec, 1
ds_write_b32 v4, v7
s_mov_b64 exec, -1
s_add_u32 s85, s91, 28672
buffer_load_dwordx4 v[76:79], v14, s[20:23], s85 offen offset:0 sc1
s_waitcnt vmcnt(8)
s_add_u32 s85, s91, 28672
buffer_load_dwordx4 v[72:75], v14, s[20:23], s85 offen offset:1024 sc1
s_waitcnt vmcnt(8)
s_add_u32 s85, s91, 28672
buffer_load_dwordx4 v[68:71], v14, s[20:23], s85 offen offset:2048 sc1
s_waitcnt vmcnt(8)
s_add_u32 s85, s91, 28672
buffer_load_dwordx4 v[64:67], v14, s[20:23], s85 offen offset:3072 sc1
s_waitcnt vmcnt(8)
s_add_u32 s85, s91, 32768
buffer_load_dwordx4 v[60:63], v14, s[20:23], s85 offen offset:0 sc1
s_waitcnt vmcnt(8)
s_add_u32 s85, s91, 32768
buffer_load_dwordx4 v[56:59], v14, s[20:23], s85 offen offset:1024 sc1
s_waitcnt vmcnt(8)
s_add_u32 s85, s91, 32768
buffer_load_dwordx4 v[52:55], v14, s[20:23], s85 offen offset:2048 sc1
s_lshl_b32 s61, s81, 14
s_add_u32 s61, s61, 98304
s_add_u32 m0, s61, 0
s_add_u32 s85, s91, 35840
s_waitcnt vmcnt(8)
buffer_load_dwordx4 v14, s[20:23], s85 offen offset:0 sc1 lds
s_waitcnt vmcnt(8)
buffer_load_dwordx4 v14, s[20:23], s85 offen offset:1024 sc1 lds
s_waitcnt vmcnt(8)
buffer_load_dwordx4 v14, s[20:23], s85 offen offset:2048 sc1 lds
s_waitcnt vmcnt(8)
buffer_load_dwordx4 v14, s[20:23], s85 offen offset:3072 sc1 lds
s_add_u32 m0, s61, 4096
s_add_u32 s85, s91, 39936
s_waitcnt vmcnt(8)
buffer_load_dwordx4 v14, s[20:23], s85 offen offset:0 sc1 lds
s_waitcnt vmcnt(8)
buffer_load_dwordx4 v14, s[20:23], s85 offen offset:1024 sc1 lds
s_waitcnt vmcnt(8)
buffer_load_dwordx4 v14, s[20:23], s85 offen offset:2048 sc1 lds
s_waitcnt vmcnt(8)
buffer_load_dwordx4 v14, s[20:23], s85 offen offset:3072 sc1 lds
s_add_u32 m0, s61, 8192
s_add_u32 s85, s91, 44032
s_waitcnt vmcnt(8)
buffer_load_dwordx4 v14, s[20:23], s85 offen offset:0 sc1 lds
s_waitcnt vmcnt(8)
buffer_load_dwordx4 v14, s[20:23], s85 offen offset:1024 sc1 lds
s_branch L_P2Y
L_P2Y:
v_lshrrev_b32 v5, 4, v0
v_and_b32 v2, 15, v0
v_and_b32 v3, 7, v0
v_xor_b32 v3, v3, v5
v_lshlrev_b32 v4, 8, v2
v_lshl_add_u32 v4, v3, 4, v4
s_mul_i32 s61, s81, 24576
s_lshl_b32 s60, s81, 14
s_add_u32 s60, s60, 98304
s_add_u32 s61, s61, 20480
v_add_u32 v13, s60, v4
v_xor_b32 v7, 64, v13
v_add_u32 v12, s60, v14
v_bfe_u32 v3, v0, 1, 2
v_xor_b32 v3, v3, v5
v_lshlrev_b32 v4, 6, v2
v_lshl_add_u32 v4, v3, 4, v4
v_add_u32 v6, s61, v4
s_mov_b32 s78, 40000
s_branch L_sl32
L_sp29:
s_sleep 3
L_sl32:
s_load_dword s74, s[54:55], s89 glc
L_sc30:
s_waitcnt lgkmcnt(0)
s_bfe_u32 s85, s74, 0x80000
s_cmp_eq_u32 s85, 5
s_cbranch_scc1 L_so31
s_sub_u32 s78, s78, 1
s_cmp_lg_u32 s78, 0
s_cbranch_scc1 L_sp29
L_so31:
s_add_u32 s87, s90, 0
buffer_load_dwordx4 v[16:19], v14, s[20:23], s87 offen offset:0 sc1
buffer_load_dwordx4 v[20:23], v14, s[20:23], s87 offen offset:1024 sc1
buffer_load_dwordx4 v[24:27], v14, s[20:23], s87 offen offset:2048 sc1
buffer_load_dwordx4 v[28:31], v14, s[20:23], s87 offen offset:3072 sc1
s_add_u32 s87, s90, 4096
buffer_load_dwordx4 v[32:35], v14, s[20:23], s87 offen offset:0 sc1
buffer_load_dwordx4 v[36:39], v14, s[20:23], s87 offen offset:1024 sc1
buffer_load_dwordx4 v[40:43], v14, s[20:23], s87 offen offset:2048 sc1
buffer_load_dwordx4 v[44:47], v14, s[20:23], s87 offen offset:3072 sc1
s_waitcnt vmcnt(4)
v_mfma_f32_16x16x32_bf16 v[176:179], v[240:243], v[16:19], 0
v_mfma_f32_16x16x32_bf16 v[180:183], v[240:243], v[20:23], 0
s_add_u32 s87, s90, 8192
buffer_load_dwordx4 v[48:51], v14, s[20:23], s87 offen offset:0 sc1
v_mfma_f32_16x16x32_bf16 v[184:187], v[240:243], v[24:27], 0
v_mfma_f32_16x16x32_bf16 v[188:191], v[240:243], v[28:31], 0
v_mfma_f32_16x16x32_bf16 v[204:207], v[244:247], v[28:31], 0
v_mfma_f32_16x16x32_bf16 v[200:203], v[244:247], v[24:27], 0
v_mfma_f32_16x16x32_bf16 v[196:199], v[244:247], v[20:23], 0
v_mfma_f32_16x16x32_bf16 v[192:195], v[244:247], v[16:19], 0
v_mfma_f32_16x16x32_bf16 v[208:211], v[248:251], v[16:19], 0
v_mfma_f32_16x16x32_bf16 v[212:215], v[248:251], v[20:23], 0
v_mfma_f32_16x16x32_bf16 v[216:219], v[248:251], v[24:27], 0
v_mfma_f32_16x16x32_bf16 v[220:223], v[248:251], v[28:31], 0
v_mfma_f32_16x16x32_bf16 v[236:239], v[252:255], v[28:31], 0
v_mfma_f32_16x16x32_bf16 v[232:235], v[252:255], v[24:27], 0
v_mfma_f32_16x16x32_bf16 v[228:231], v[252:255], v[20:23], 0
v_mfma_f32_16x16x32_bf16 v[224:227], v[252:255], v[16:19], 0
v_mfma_f32_16x16x32_bf16 v[240:243], v[172:175], v[16:19], 0
v_mfma_f32_16x16x32_bf16 v[244:247], v[172:175], v[20:23], 0
v_mfma_f32_16x16x32_bf16 v[248:251], v[172:175], v[24:27], 0
v_mfma_f32_16x16x32_bf16 v[252:255], v[172:175], v[28:31], 0
s_waitcnt vmcnt(1)
v_mfma_f32_16x16x32_bf16 v[176:179], v[168:171], v[32:35], v[176:179]
v_mfma_f32_16x16x32_bf16 v[180:183], v[168:171], v[36:39], v[180:183]
buffer_load_dwordx4 v[172:175], v14, s[20:23], s87 offen offset:1024 sc1
v_mfma_f32_16x16x32_bf16 v[184:187], v[168:171], v[40:43], v[184:187]
v_mfma_f32_16x16x32_bf16 v[188:191], v[168:171], v[44:47], v[188:191]
buffer_load_dwordx4 v[16:19], v14, s[20:23], s87 offen offset:2048 sc1
v_mfma_f32_16x16x32_bf16 v[204:207], v[164:167], v[44:47], v[204:207]
v_mfma_f32_16x16x32_bf16 v[200:203], v[164:167], v[40:43], v[200:203]
buffer_load_dwordx4 v[20:23], v14, s[20:23], s87 offen offset:3072 sc1
v_mfma_f32_16x16x32_bf16 v[196:199], v[164:167], v[36:39], v[196:199]
v_mfma_f32_16x16x32_bf16 v[192:195], v[164:167], v[32:35], v[192:195]
s_add_u32 s87, s90, 12288
buffer_load_dwordx4 v[24:27], v14, s[20:23], s87 offen offset:0 sc1
v_mfma_f32_16x16x32_bf16 v[208:211], v[160:163], v[32:35], v[208:211]
v_mfma_f32_16x16x32_bf16 v[212:215], v[160:163], v[36:39], v[212:215]
buffer_load_dwordx4 v[28:31], v14, s[20:23], s87 offen offset:1024 sc1
v_mfma_f32_16x16x32_bf16 v[216:219], v[160:163], v[40:43], v[216:219]
v_mfma_f32_16x16x32_bf16 v[220:223], v[160:163], v[44:47], v[220:223]
buffer_load_dwordx4 v[168:171], v14, s[20:23], s87 offen offset:2048 sc1
v_mfma_f32_16x16x32_bf16 v[236:239], v[156:159], v[44:47], v[236:239]
v_mfma_f32_16x16x32_bf16 v[232:235], v[156:159], v[40:43], v[232:235]
buffer_load_dwordx4 v[164:167], v14, s[20:23], s87 offen offset:3072 sc1
v_mfma_f32_16x16x32_bf16 v[228:231], v[156:159], v[36:39], v[228:231]
v_mfma_f32_16x16x32_bf16 v[224:227], v[156:159], v[32:35], v[224:227]
v_mfma_f32_16x16x32_bf16 v[240:243], v[152:155], v[32:35], v[240:243]
v_mfma_f32_16x16x32_bf16 v[244:247], v[152:155], v[36:39], v[244:247]
v_mfma_f32_16x16x32_bf16 v[248:251], v[152:155], v[40:43], v[248:251]
v_mfma_f32_16x16x32_bf16 v[252:255], v[152:155], v[44:47], v[252:255]
s_waitcnt vmcnt(4)
v_mfma_f32_16x16x32_bf16 v[176:179], v[148:151], v[48:51], v[176:179]
v_mfma_f32_16x16x32_bf16 v[180:183], v[148:151], v[172:175], v[180:183]
s_add_u32 s87, s90, 16384
buffer_load_dwordx4 v[160:163], v14, s[20:23], s87 offen offset:0 sc1
v_mfma_f32_16x16x32_bf16 v[184:187], v[148:151], v[16:19], v[184:187]
v_mfma_f32_16x16x32_bf16 v[188:191], v[148:151], v[20:23], v[188:191]
buffer_load_dwordx4 v[156:159], v14, s[20:23], s87 offen offset:1024 sc1
s_load_dword s74, s[54:55], s89 glc
v_mfma_f32_16x16x32_bf16 v[204:207], v[144:147], v[20:23], v[204:207]
v_mfma_f32_16x16x32_bf16 v[200:203], v[144:147], v[16:19], v[200:203]
buffer_load_dwordx4 v[152:155], v14, s[20:23], s87 offen offset:2048 sc1
v_mfma_f32_16x16x32_bf16 v[196:199], v[144:147], v[172:175], v[196:199]
v_mfma_f32_16x16x32_bf16 v[192:195], v[144:147], v[48:51], v[192:195]
buffer_load_dwordx4 v[32:35], v14, s[20:23], s87 offen offset:3072 sc1
v_mfma_f32_16x16x32_bf16 v[208:211], v[140:143], v[48:51], v[208:211]
v_mfma_f32_16x16x32_bf16 v[212:215], v[140:143], v[172:175], v[212:215]
v_mfma_f32_16x16x32_bf16 v[216:219], v[140:143], v[16:19], v[216:219]
v_mfma_f32_16x16x32_bf16 v[220:223], v[140:143], v[20:23], v[220:223]
v_mfma_f32_16x16x32_bf16 v[236:239], v[136:139], v[20:23], v[236:239]
v_mfma_f32_16x16x32_bf16 v[232:235], v[136:139], v[16:19], v[232:235]
v_mfma_f32_16x16x32_bf16 v[228:231], v[136:139], v[172:175], v[228:231]
v_mfma_f32_16x16x32_bf16 v[224:227], v[136:139], v[48:51], v[224:227]
v_mfma_f32_16x16x32_bf16 v[240:243], v[132:135], v[48:51], v[240:243]
v_mfma_f32_16x16x32_bf16 v[244:247], v[132:135], v[172:175], v[244:247]
v_mfma_f32_16x16x32_bf16 v[248:251], v[132:135], v[16:19], v[248:251]
v_mfma_f32_16x16x32_bf16 v[252:255], v[132:135], v[20:23], v[252:255]
s_waitcnt vmcnt(4)
s_mov_b32 s78, 40000
s_branch L_sc34
L_sp33:
s_sleep 3
L_sl36:
s_load_dword s74, s[54:55], s89 glc
L_sc34:
s_waitcnt lgkmcnt(0)
s_bfe_u32 s85, s74, 0x80008
s_cmp_eq_u32 s85, 4
s_cbranch_scc1 L_so35
s_sub_u32 s78, s78, 1
s_cmp_lg_u32 s78, 0
s_cbranch_scc1 L_sp33
L_so35:
v_mfma_f32_16x16x32_bf16 v[176:179], v[128:131], v[24:27], v[176:179]
v_mfma_f32_16x16x32_bf16 v[180:183], v[128:131], v[28:31], v[180:183]
s_add_u32 s87, s90, 20480
buffer_load_dwordx4 v[36:39], v14, s[20:23], s87 offen offset:0 sc1
v_mfma_f32_16x16x32_bf16 v[184:187], v[128:131], v[168:171], v[184:187]
v_mfma_f32_16x16x32_bf16 v[188:191], v[128:131], v[164:167], v[188:191]
buffer_load_dwordx4 v[40:43], v14, s[20:23], s87 offen offset:1024 sc1
v_mfma_f32_16x16x32_bf16 v[204:207], v[124:127], v[164:167], v[204:207]
v_mfma_f32_16x16x32_bf16 v[200:203], v[124:127], v[168:171], v[200:203]
buffer_load_dwordx4 v[44:47], v14, s[20:23], s87 offen offset:2048 sc1
v_mfma_f32_16x16x32_bf16 v[196:199], v[124:127], v[28:31], v[196:199]
v_mfma_f32_16x16x32_bf16 v[192:195], v[124:127], v[24:27], v[192:195]
buffer_load_dwordx4 v[148:151], v14, s[20:23], s87 offen offset:3072 sc1
v_mfma_f32_16x16x32_bf16 v[208:211], v[120:123], v[24:27], v[208:211]
v_mfma_f32_16x16x32_bf16 v[212:215], v[120:123], v[28:31], v[212:215]
v_mfma_f32_16x16x32_bf16 v[216:219], v[120:123], v[168:171], v[216:219]
v_mfma_f32_16x16x32_bf16 v[220:223], v[120:123], v[164:167], v[220:223]
v_mfma_f32_16x16x32_bf16 v[236:239], v[116:119], v[164:167], v[236:239]
v_mfma_f32_16x16x32_bf16 v[232:235], v[116:119], v[168:171], v[232:235]
v_mfma_f32_16x16x32_bf16 v[228:231], v[116:119], v[28:31], v[228:231]
v_mfma_f32_16x16x32_bf16 v[224:227], v[116:119], v[24:27], v[224:227]
v_mfma_f32_16x16x32_bf16 v[240:243], v[112:115], v[24:27], v[240:243]
v_mfma_f32_16x16x32_bf16 v[244:247], v[112:115], v[28:31], v[244:247]
v_mfma_f32_16x16x32_bf16 v[248:251], v[112:115], v[168:171], v[248:251]
v_mfma_f32_16x16x32_bf16 v[252:255], v[112:115], v[164:167], v[252:255]
s_waitcnt vmcnt(4)
v_mfma_f32_16x16x32_bf16 v[176:179], v[108:111], v[160:163], v[176:179]
v_mfma_f32_16x16x32_bf16 v[180:183], v[108:111], v[156:159], v[180:183]
s_add_u32 s87, s90, 24576
buffer_load_dwordx4 v[144:147], v14, s[20:23], s87 offen offset:0 sc1
v_mfma_f32_16x16x32_bf16 v[184:187], v[108:111], v[152:155], v[184:187]
v_mfma_f32_16x16x32_bf16 v[188:191], v[108:111], v[32:35], v[188:191]
buffer_load_dwordx4 v[140:143], v14, s[20:23], s87 offen offset:1024 sc1
v_mfma_f32_16x16x32_bf16 v[204:207], v[104:107], v[32:35], v[204:207]
v_mfma_f32_16x16x32_bf16 v[200:203], v[104:107], v[152:155], v[200:203]
buffer_load_dwordx4 v[136:139], v14, s[20:23], s87 offen offset:2048 sc1
v_mfma_f32_16x16x32_bf16 v[196:199], v[104:107], v[156:159], v[196:199]
v_mfma_f32_16x16x32_bf16 v[192:195], v[104:107], v[160:163], v[192:195]
buffer_load_dwordx4 v[132:135], v14, s[20:23], s87 offen offset:3072 sc1
v_mfma_f32_16x16x32_bf16 v[208:211], v[100:103], v[160:163], v[208:211]
v_mfma_f32_16x16x32_bf16 v[212:215], v[100:103], v[156:159], v[212:215]
v_mfma_f32_16x16x32_bf16 v[216:219], v[100:103], v[152:155], v[216:219]
v_mfma_f32_16x16x32_bf16 v[220:223], v[100:103], v[32:35], v[220:223]
v_mfma_f32_16x16x32_bf16 v[236:239], v[96:99], v[32:35], v[236:239]
v_mfma_f32_16x16x32_bf16 v[232:235], v[96:99], v[152:155], v[232:235]
v_mfma_f32_16x16x32_bf16 v[228:231], v[96:99], v[156:159], v[228:231]
v_mfma_f32_16x16x32_bf16 v[224:227], v[96:99], v[160:163], v[224:227]
v_mfma_f32_16x16x32_bf16 v[240:243], v[92:95], v[160:163], v[240:243]
v_mfma_f32_16x16x32_bf16 v[244:247], v[92:95], v[156:159], v[244:247]
v_mfma_f32_16x16x32_bf16 v[248:251], v[92:95], v[152:155], v[248:251]
v_mfma_f32_16x16x32_bf16 v[252:255], v[92:95], v[32:35], v[252:255]
s_waitcnt vmcnt(4)
v_mfma_f32_16x16x32_bf16 v[176:179], v[88:91], v[36:39], v[176:179]
v_mfma_f32_16x16x32_bf16 v[180:183], v[88:91], v[40:43], v[180:183]
s_add_u32 s87, s90, 28672
buffer_load_dwordx4 v[48:51], v14, s[20:23], s87 offen offset:0 sc1
v_mfma_f32_16x16x32_bf16 v[184:187], v[88:91], v[44:47], v[184:187]
v_mfma_f32_16x16x32_bf16 v[188:191], v[88:91], v[148:151], v[188:191]
buffer_load_dwordx4 v[172:175], v14, s[20:23], s87 offen offset:1024 sc1
v_mfma_f32_16x16x32_bf16 v[204:207], v[84:87], v[148:151], v[204:207]
v_mfma_f32_16x16x32_bf16 v[200:203], v[84:87], v[44:47], v[200:203]
buffer_load_dwordx4 v[128:131], v14, s[20:23], s87 offen offset:2048 sc1
v_mfma_f32_16x16x32_bf16 v[196:199], v[84:87], v[40:43], v[196:199]
v_mfma_f32_16x16x32_bf16 v[192:195], v[84:87], v[36:39], v[192:195]
buffer_load_dwordx4 v[124:127], v14, s[20:23], s87 offen offset:3072 sc1
v_mfma_f32_16x16x32_bf16 v[208:211], v[80:83], v[36:39], v[208:211]
v_mfma_f32_16x16x32_bf16 v[212:215], v[80:83], v[40:43], v[212:215]
s_add_u32 s87, s90, 32768
buffer_load_dwordx4 v[120:123], v14, s[20:23], s87 offen offset:0 sc1
v_mfma_f32_16x16x32_bf16 v[216:219], v[80:83], v[44:47], v[216:219]
v_mfma_f32_16x16x32_bf16 v[220:223], v[80:83], v[148:151], v[220:223]
buffer_load_dwordx4 v[116:119], v14, s[20:23], s87 offen offset:1024 sc1
v_mfma_f32_16x16x32_bf16 v[236:239], v[76:79], v[148:151], v[236:239]
v_mfma_f32_16x16x32_bf16 v[232:235], v[76:79], v[44:47], v[232:235]
buffer_load_dwordx4 v[112:115], v14, s[20:23], s87 offen offset:2048 sc1
v_mfma_f32_16x16x32_bf16 v[228:231], v[76:79], v[40:43], v[228:231]
v_mfma_f32_16x16x32_bf16 v[224:227], v[76:79], v[36:39], v[224:227]
buffer_load_dwordx4 v[168:171], v14, s[20:23], s87 offen offset:3072 sc1
v_mfma_f32_16x16x32_bf16 v[240:243], v[72:75], v[36:39], v[240:243]
v_mfma_f32_16x16x32_bf16 v[244:247], v[72:75], v[40:43], v[244:247]
v_mfma_f32_16x16x32_bf16 v[248:251], v[72:75], v[44:47], v[248:251]
v_mfma_f32_16x16x32_bf16 v[252:255], v[72:75], v[148:151], v[252:255]
s_waitcnt vmcnt(8)
v_mfma_f32_16x16x32_bf16 v[176:179], v[68:71], v[144:147], v[176:179]
ds_read_b128 v[164:167], v12 offset:0
s_mov_b64 s[24:25], s[50:51]
s_mov_b32 s26, 2621440
v_mfma_f32_16x16x32_bf16 v[180:183], v[68:71], v[140:143], v[180:183]
ds_read_b128 v[108:111], v12 offset:1024
s_mov_b32 s27, 0x20000
s_lshl_b32 s60, s56, 6
v_mfma_f32_16x16x32_bf16 v[184:187], v[68:71], v[136:139], v[184:187]
ds_read_b128 v[104:107], v12 offset:2048
v_mov_b32 v30, 0xbfb8aa3b
v_mfma_f32_16x16x32_bf16 v[188:191], v[68:71], v[132:135], v[188:191]
ds_read_b128 v[100:103], v12 offset:3072
v_mov_b32 v31, 1.0
v_mfma_f32_16x16x32_bf16 v[204:207], v[64:67], v[132:135], v[204:207]
ds_read_b128 v[96:99], v12 offset:4096
s_bfe_u32 s61, s92, 0x10005
s_lshl_b32 s62, s61, 5
v_mfma_f32_16x16x32_bf16 v[200:203], v[64:67], v[136:139], v[200:203]
ds_read_b128 v[92:95], v12 offset:5120
s_lshl_b32 s61, s61, 7
s_sub_u32 s61, 128, s61
v_mfma_f32_16x16x32_bf16 v[196:199], v[64:67], v[140:143], v[196:199]
ds_read_b128 v[160:163], v12 offset:6144
v_add_u32 v5, s60, v0
v_mfma_f32_16x16x32_bf16 v[192:195], v[64:67], v[144:147], v[192:195]
ds_read_b128 v[156:159], v12 offset:7168
v_lshrrev_b32 v2, 4, v5
v_mfma_f32_16x16x32_bf16 v[208:211], v[60:63], v[144:147], v[208:211]
ds_read_b128 v[152:155], v12 offset:8192
v_and_b32 v4, 7, v2
v_mfma_f32_16x16x32_bf16 v[212:215], v[60:63], v[140:143], v[212:215]
ds_read_b128 v[32:35], v12 offset:9216
v_xor_b32 v4, v4, v5
v_mfma_f32_16x16x32_bf16 v[216:219], v[60:63], v[136:139], v[216:219]
v_lshlrev_b32 v16, 4, v4
v_and_b32 v3, 15, v5
v_mfma_f32_16x16x32_bf16 v[220:223], v[60:63], v[132:135], v[220:223]
v_lshl_add_u32 v3, v3, 3, s62
v_and_b32 v5, 15, v2
v_mfma_f32_16x16x32_bf16 v[236:239], v[56:59], v[132:135], v[236:239]
v_bfe_u32 v4, v2, 4, 1
v_lshl_add_u32 v5, v5, 1, v4
v_mfma_f32_16x16x32_bf16 v[232:235], v[56:59], v[136:139], v[232:235]
v_and_or_b32 v5, v2, 32, v5
v_mul_u32_u24 v5, 1280, v5
v_mfma_f32_16x16x32_bf16 v[228:231], v[56:59], v[140:143], v[228:231]
v_add_u32 v20, v3, v5
buffer_load_dwordx2 v[24:25], v20, s[8:11], s92 offen
s_add_u32 s60, s60, 512
v_mfma_f32_16x16x32_bf16 v[224:227], v[56:59], v[144:147], v[224:227]
v_add_u32 v5, s60, v0
v_lshrrev_b32 v2, 4, v5
v_mfma_f32_16x16x32_bf16 v[240:243], v[52:55], v[144:147], v[240:243]
v_and_b32 v4, 7, v2
v_xor_b32 v4, v4, v5
v_mfma_f32_16x16x32_bf16 v[244:247], v[52:55], v[140:143], v[244:247]
v_lshlrev_b32 v17, 4, v4
v_and_b32 v3, 15, v5
v_mfma_f32_16x16x32_bf16 v[248:251], v[52:55], v[136:139], v[248:251]
v_lshl_add_u32 v3, v3, 3, s62
v_and_b32 v5, 15, v2
v_mfma_f32_16x16x32_bf16 v[252:255], v[52:55], v[132:135], v[252:255]
v_bfe_u32 v4, v2, 4, 1
v_lshl_add_u32 v5, v5, 1, v4
s_waitcnt vmcnt(1)
s_waitcnt lgkmcnt(0)
s_cmp_lg_u32 s56, 6
s_cbranch_scc1 L_sk37
v_mov_b32 v8, 146696
s_mov_b32 s78, 400000
s_branch L_lc39
L_lp38:
s_sleep 1
L_lc39:
ds_read_b32 v9, v8
s_waitcnt lgkmcnt(0)
v_cmp_ne_u32 vcc, 4, v9
s_sub_u32 s78, s78, 1
s_cbranch_vccz L_lo40
s_cmp_lg_u32 s78, 0
s_cbranch_scc1 L_lp38
L_lo40:
L_sk37:
v_mfma_f32_16x16x32_bf16 v[176:179], v[164:167], v[48:51], v[176:179]
v_and_or_b32 v5, v2, 32, v5
v_mul_u32_u24 v5, 1280, v5
v_mfma_f32_16x16x32_bf16 v[176:179], v[92:95], v[120:123], v[176:179]
v_add_u32 v21, v3, v5
buffer_load_dwordx2 v[26:27], v21, s[8:11], s92 offen
s_add_u32 s60, s60, 512
v_mfma_f32_16x16x32_bf16 v[180:183], v[164:167], v[172:175], v[180:183]
v_mfma_f32_16x16x32_bf16 v[180:183], v[92:95], v[116:119], v[180:183]
v_mfma_f32_16x16x32_bf16 v[184:187], v[164:167], v[128:131], v[184:187]
v_mfma_f32_16x16x32_bf16 v[184:187], v[92:95], v[112:115], v[184:187]
v_mfma_f32_16x16x32_bf16 v[188:191], v[164:167], v[124:127], v[188:191]
v_mfma_f32_16x16x32_bf16 v[188:191], v[92:95], v[168:171], v[188:191]
v_mfma_f32_16x16x32_bf16 v[192:195], v[108:111], v[48:51], v[192:195]
ds_write_b128 v13, v[176:179] offset:0
v_mfma_f32_16x16x32_bf16 v[192:195], v[160:163], v[120:123], v[192:195]
v_mfma_f32_16x16x32_bf16 v[196:199], v[108:111], v[172:175], v[196:199]
ds_write_b128 v13, v[180:183] offset:4096
v_mfma_f32_16x16x32_bf16 v[196:199], v[160:163], v[116:119], v[196:199]
v_mfma_f32_16x16x32_bf16 v[200:203], v[108:111], v[128:131], v[200:203]
ds_write_b128 v13, v[184:187] offset:8192
v_mfma_f32_16x16x32_bf16 v[200:203], v[160:163], v[112:115], v[200:203]
v_mfma_f32_16x16x32_bf16 v[204:207], v[108:111], v[124:127], v[204:207]
ds_write_b128 v13, v[188:191] offset:12288
v_mfma_f32_16x16x32_bf16 v[204:207], v[160:163], v[168:171], v[204:207]
v_mfma_f32_16x16x32_bf16 v[208:211], v[104:107], v[48:51], v[208:211]
ds_write_b128 v7, v[192:195] offset:0
v_mfma_f32_16x16x32_bf16 v[208:211], v[156:159], v[120:123], v[208:211]
v_mfma_f32_16x16x32_bf16 v[212:215], v[104:107], v[172:175], v[212:215]
ds_write_b128 v7, v[196:199] offset:4096
v_mfma_f32_16x16x32_bf16 v[212:215], v[156:159], v[116:119], v[212:215]
v_mfma_f32_16x16x32_bf16 v[216:219], v[104:107], v[128:131], v[216:219]
ds_write_b128 v7, v[200:203] offset:8192
v_mfma_f32_16x16x32_bf16 v[216:219], v[156:159], v[112:115], v[216:219]
v_mfma_f32_16x16x32_bf16 v[220:223], v[104:107], v[124:127], v[220:223]
ds_write_b128 v7, v[204:207] offset:12288
v_mfma_f32_16x16x32_bf16 v[220:223], v[156:159], v[168:171], v[220:223]
v_mfma_f32_16x16x32_bf16 v[224:227], v[100:103], v[48:51], v[224:227]
ds_write_b128 v13, v[208:211] offset:128
v_mfma_f32_16x16x32_bf16 v[224:227], v[152:155], v[120:123], v[224:227]
v_mfma_f32_16x16x32_bf16 v[228:231], v[100:103], v[172:175], v[228:231]
ds_write_b128 v13, v[212:215] offset:4224
v_mfma_f32_16x16x32_bf16 v[228:231], v[152:155], v[116:119], v[228:231]
v_mfma_f32_16x16x32_bf16 v[232:235], v[100:103], v[128:131], v[232:235]
ds_write_b128 v13, v[216:219] offset:8320
v_mfma_f32_16x16x32_bf16 v[232:235], v[152:155], v[112:115], v[232:235]
v_mfma_f32_16x16x32_bf16 v[236:239], v[100:103], v[124:127], v[236:239]
ds_write_b128 v13, v[220:223] offset:12416
v_mfma_f32_16x16x32_bf16 v[236:239], v[152:155], v[168:171], v[236:239]
v_mfma_f32_16x16x32_bf16 v[240:243], v[96:99], v[48:51], v[240:243]
ds_write_b128 v7, v[224:227] offset:128
v_mfma_f32_16x16x32_bf16 v[240:243], v[32:35], v[120:123], v[240:243]
v_mfma_f32_16x16x32_bf16 v[244:247], v[96:99], v[172:175], v[244:247]
ds_write_b128 v7, v[228:231] offset:4224
v_mfma_f32_16x16x32_bf16 v[244:247], v[32:35], v[116:119], v[244:247]
v_mfma_f32_16x16x32_bf16 v[248:251], v[96:99], v[128:131], v[248:251]
ds_write_b128 v7, v[232:235] offset:8320
v_mfma_f32_16x16x32_bf16 v[248:251], v[32:35], v[112:115], v[248:251]
v_mfma_f32_16x16x32_bf16 v[252:255], v[96:99], v[124:127], v[252:255]
ds_write_b128 v7, v[236:239] offset:12416
v_mfma_f32_16x16x32_bf16 v[252:255], v[32:35], v[168:171], v[252:255]
s_branch L_FIN
L_P2S:
v_lshrrev_b32 v5, 4, v0
v_and_b32 v2, 15, v0
v_and_b32 v3, 7, v0
v_xor_b32 v3, v3, v5
v_lshlrev_b32 v4, 8, v2
v_lshl_add_u32 v4, v3, 4, v4
s_mul_i32 s61, s81, 24576
s_lshl_b32 s60, s81, 14
s_add_u32 s60, s60, 98304
s_add_u32 s61, s61, 20480
v_add_u32 v13, s60, v4
v_xor_b32 v7, 64, v13
v_add_u32 v12, s60, v14
v_bfe_u32 v3, v0, 1, 2
v_xor_b32 v3, v3, v5
v_lshlrev_b32 v4, 6, v2
v_lshl_add_u32 v4, v3, 4, v4
v_add_u32 v6, s61, v4
s_and_b32 s60, s2, 7
s_lshr_b32 s61, s2, 6
s_lshl_b32 s60, s60, 2
s_add_u32 s60, s60, s61
s_bfe_u32 s61, s2, 0x30003
s_lshl_b32 s89, s60, 7
s_add_u32 s89, s89, 286720
s_lshl_b32 s60, s60, 5
v_and_b32 v2, 15, v0
v_add_u32 v2, s60, v2
v_add_u32 v2, 0, v2
v_subrev_u32 v3, 7, v2
v_max_i32 v3, 0, v3
v_mul_u32_u24 v3, 898, v3
v_lshrrev_b32 v3, 16, v3
v_mul_u32_u24 v4, 73, v3
v_add_u32 v4, 7, v4
v_xor_b32 v4, v4, v2
v_cmp_gt_u32 vcc, 16, v4
v_min_u32 v3, 1, v3
v_mul_u32_u24 v3, 10485760, v3
v_cndmask_b32 v3, 0, v3, vcc
v_add_u32 v8, v3, v14
v_and_b32 v2, 15, v0
v_add_u32 v2, s60, v2
v_add_u32 v2, 16, v2
v_subrev_u32 v3, 7, v2
v_max_i32 v3, 0, v3
v_mul_u32_u24 v3, 898, v3
v_lshrrev_b32 v3, 16, v3
v_mul_u32_u24 v4, 73, v3
v_add_u32 v4, 7, v4
v_xor_b32 v4, v4, v2
v_cmp_gt_u32 vcc, 16, v4
v_min_u32 v3, 1, v3
v_mul_u32_u24 v3, 10485760, v3
v_cndmask_b32 v3, 0, v3, vcc
v_add_u32 v9, v3, v14
s_sub_u32 s61, s60, 7
s_max_i32 s61, s61, 0
s_add_u32 s60, s60, 24
s_mul_i32 s62, s61, 14365
s_lshr_b32 s62, s62, 20
s_mul_i32 s63, s60, 14365
s_lshr_b32 s63, s63, 20
s_sub_u32 s63, s63, s62
s_add_u32 s63, s63, 1
s_lshl_b32 s63, s63, 3
s_setprio 2
s_mov_b32 s78, 40000
s_branch L_sl44
L_sp41:
s_sleep 8
L_sl44:
s_load_dword s74, s[54:55], s89 glc
L_sc42:
s_waitcnt lgkmcnt(0)
s_cmp_eq_u32 s74, s63
s_cbranch_scc1 L_so43
s_sub_u32 s78, s78, 1
s_cmp_lg_u32 s78, 0
s_cbranch_scc1 L_sp41
L_so43:
s_add_u32 s87, s90, 0
buffer_load_dwordx4 v[16:19], v8, s[20:23], s87 offen offset:0 sc1
buffer_load_dwordx4 v[20:23], v8, s[20:23], s87 offen offset:1024 sc1
buffer_load_dwordx4 v[24:27], v9, s[20:23], s87 offen offset:2048 sc1
buffer_load_dwordx4 v[28:31], v9, s[20:23], s87 offen offset:3072 sc1
s_add_u32 s87, s90, 4096
buffer_load_dwordx4 v[32:35], v8, s[20:23], s87 offen offset:0 sc1
buffer_load_dwordx4 v[36:39], v8, s[20:23], s87 offen offset:1024 sc1
buffer_load_dwordx4 v[40:43], v9, s[20:23], s87 offen offset:2048 sc1
buffer_load_dwordx4 v[44:47], v9, s[20:23], s87 offen offset:3072 sc1
s_add_u32 s87, s90, 8192
buffer_load_dwordx4 v[48:51], v8, s[20:23], s87 offen offset:0 sc1
buffer_load_dwordx4 v[52:55], v8, s[20:23], s87 offen offset:1024 sc1
buffer_load_dwordx4 v[56:59], v9, s[20:23], s87 offen offset:2048 sc1
buffer_load_dwordx4 v[60:63], v9, s[20:23], s87 offen offset:3072 sc1
s_waitcnt vmcnt(8)
v_mfma_f32_16x16x32_bf16 v[176:179], v[240:243], v[16:19], 0
v_mfma_f32_16x16x32_bf16 v[180:183], v[240:243], v[20:23], 0
s_add_u32 s87, s90, 12288
buffer_load_dwordx4 v[64:67], v8, s[20:23], s87 offen offset:0 sc1
v_mfma_f32_16x16x32_bf16 v[184:187], v[240:243], v[24:27], 0
v_mfma_f32_16x16x32_bf16 v[188:191], v[240:243], v[28:31], 0
buffer_load_dwordx4 v[68:71], v8, s[20:23], s87 offen offset:1024 sc1
v_mfma_f32_16x16x32_bf16 v[204:207], v[244:247], v[28:31], 0
v_mfma_f32_16x16x32_bf16 v[200:203], v[244:247], v[24:27], 0
v_mfma_f32_16x16x32_bf16 v[196:199], v[244:247], v[20:23], 0
v_mfma_f32_16x16x32_bf16 v[192:195], v[244:247], v[16:19], 0
v_mfma_f32_16x16x32_bf16 v[208:211], v[248:251], v[16:19], 0
v_mfma_f32_16x16x32_bf16 v[212:215], v[248:251], v[20:23], 0
v_mfma_f32_16x16x32_bf16 v[216:219], v[248:251], v[24:27], 0
v_mfma_f32_16x16x32_bf16 v[220:223], v[248:251], v[28:31], 0
v_mfma_f32_16x16x32_bf16 v[236:239], v[252:255], v[28:31], 0
v_mfma_f32_16x16x32_bf16 v[232:235], v[252:255], v[24:27], 0
v_mfma_f32_16x16x32_bf16 v[228:231], v[252:255], v[20:23], 0
v_mfma_f32_16x16x32_bf16 v[224:227], v[252:255], v[16:19], 0
v_mfma_f32_16x16x32_bf16 v[240:243], v[172:175], v[16:19], 0
v_mfma_f32_16x16x32_bf16 v[244:247], v[172:175], v[20:23], 0
v_mfma_f32_16x16x32_bf16 v[248:251], v[172:175], v[24:27], 0
v_mfma_f32_16x16x32_bf16 v[252:255], v[172:175], v[28:31], 0
s_waitcnt vmcnt(6)
v_mfma_f32_16x16x32_bf16 v[176:179], v[168:171], v[32:35], v[176:179]
v_mfma_f32_16x16x32_bf16 v[180:183], v[168:171], v[36:39], v[180:183]
buffer_load_dwordx4 v[172:175], v9, s[20:23], s87 offen offset:2048 sc1
v_mfma_f32_16x16x32_bf16 v[184:187], v[168:171], v[40:43], v[184:187]
v_mfma_f32_16x16x32_bf16 v[188:191], v[168:171], v[44:47], v[188:191]
buffer_load_dwordx4 v[16:19], v9, s[20:23], s87 offen offset:3072 sc1
v_mfma_f32_16x16x32_bf16 v[204:207], v[164:167], v[44:47], v[204:207]
v_mfma_f32_16x16x32_bf16 v[200:203], v[164:167], v[40:43], v[200:203]
s_add_u32 s87, s90, 16384
buffer_load_dwordx4 v[20:23], v8, s[20:23], s87 offen offset:0 sc1
v_mfma_f32_16x16x32_bf16 v[196:199], v[164:167], v[36:39], v[196:199]
v_mfma_f32_16x16x32_bf16 v[192:195], v[164:167], v[32:35], v[192:195]
buffer_load_dwordx4 v[24:27], v8, s[20:23], s87 offen offset:1024 sc1
v_mfma_f32_16x16x32_bf16 v[208:211], v[160:163], v[32:35], v[208:211]
v_mfma_f32_16x16x32_bf16 v[212:215], v[160:163], v[36:39], v[212:215]
buffer_load_dwordx4 v[28:31], v9, s[20:23], s87 offen offset:2048 sc1
v_mfma_f32_16x16x32_bf16 v[216:219], v[160:163], v[40:43], v[216:219]
v_mfma_f32_16x16x32_bf16 v[220:223], v[160:163], v[44:47], v[220:223]
buffer_load_dwordx4 v[168:171], v9, s[20:23], s87 offen offset:3072 sc1
v_mfma_f32_16x16x32_bf16 v[236:239], v[156:159], v[44:47], v[236:239]
v_mfma_f32_16x16x32_bf16 v[232:235], v[156:159], v[40:43], v[232:235]
v_mfma_f32_16x16x32_bf16 v[228:231], v[156:159], v[36:39], v[228:231]
v_mfma_f32_16x16x32_bf16 v[224:227], v[156:159], v[32:35], v[224:227]
v_mfma_f32_16x16x32_bf16 v[240:243], v[152:155], v[32:35], v[240:243]
v_mfma_f32_16x16x32_bf16 v[244:247], v[152:155], v[36:39], v[244:247]
v_mfma_f32_16x16x32_bf16 v[248:251], v[152:155], v[40:43], v[248:251]
v_mfma_f32_16x16x32_bf16 v[252:255], v[152:155], v[44:47], v[252:255]
s_waitcnt vmcnt(8)
v_mfma_f32_16x16x32_bf16 v[176:179], v[148:151], v[48:51], v[176:179]
v_mfma_f32_16x16x32_bf16 v[180:183], v[148:151], v[52:55], v[180:183]
s_add_u32 s87, s90, 20480
buffer_load_dwordx4 v[164:167], v8, s[20:23], s87 offen offset:0 sc1
v_mfma_f32_16x16x32_bf16 v[184:187], v[148:151], v[56:59], v[184:187]
v_mfma_f32_16x16x32_bf16 v[188:191], v[148:151], v[60:63], v[188:191]
buffer_load_dwordx4 v[160:163], v8, s[20:23], s87 offen offset:1024 sc1
v_mfma_f32_16x16x32_bf16 v[204:207], v[144:147], v[60:63], v[204:207]
v_mfma_f32_16x16x32_bf16 v[200:203], v[144:147], v[56:59], v[200:203]
buffer_load_dwordx4 v[156:159], v9, s[20:23], s87 offen offset:2048 sc1
v_mfma_f32_16x16x32_bf16 v[196:199], v[144:147], v[52:55], v[196:199]
v_mfma_f32_16x16x32_bf16 v[192:195], v[144:147], v[48:51], v[192:195]
buffer_load_dwordx4 v[152:155], v9, s[20:23], s87 offen offset:3072 sc1
v_mfma_f32_16x16x32_bf16 v[208:211], v[140:143], v[48:51], v[208:211]
v_mfma_f32_16x16x32_bf16 v[212:215], v[140:143], v[52:55], v[212:215]
v_mfma_f32_16x16x32_bf16 v[216:219], v[140:143], v[56:59], v[216:219]
v_mfma_f32_16x16x32_bf16 v[220:223], v[140:143], v[60:63], v[220:223]
v_mfma_f32_16x16x32_bf16 v[236:239], v[136:139], v[60:63], v[236:239]
v_mfma_f32_16x16x32_bf16 v[232:235], v[136:139], v[56:59], v[232:235]
v_mfma_f32_16x16x32_bf16 v[228:231], v[136:139], v[52:55], v[228:231]
v_mfma_f32_16x16x32_bf16 v[224:227], v[136:139], v[48:51], v[224:227]
v_mfma_f32_16x16x32_bf16 v[240:243], v[132:135], v[48:51], v[240:243]
v_mfma_f32_16x16x32_bf16 v[244:247], v[132:135], v[52:55], v[244:247]
v_mfma_f32_16x16x32_bf16 v[248:251], v[132:135], v[56:59], v[248:251]
v_mfma_f32_16x16x32_bf16 v[252:255], v[132:135], v[60:63], v[252:255]
s_waitcnt vmcnt(8)
v_mfma_f32_16x16x32_bf16 v[176:179], v[128:131], v[64:67], v[176:179]
v_mfma_f32_16x16x32_bf16 v[180:183], v[128:131], v[68:71], v[180:183]
s_add_u32 s87, s90, 24576
buffer_load_dwordx4 v[32:35], v8, s[20:23], s87 offen offset:0 sc1
v_mfma_f32_16x16x32_bf16 v[184:187], v[128:131], v[172:175], v[184:187]
v_mfma_f32_16x16x32_bf16 v[188:191], v[128:131], v[16:19], v[188:191]
buffer_load_dwordx4 v[36:39], v8, s[20:23], s87 offen offset:1024 sc1
v_mfma_f32_16x16x32_bf16 v[204:207], v[124:127], v[16:19], v[204:207]
v_mfma_f32_16x16x32_bf16 v[200:203], v[124:127], v[172:175], v[200:203]
buffer_load_dwordx4 v[40:43], v9, s[20:23], s87 offen offset:2048 sc1
v_mfma_f32_16x16x32_bf16 v[196:199], v[124:127], v[68:71], v[196:199]
v_mfma_f32_16x16x32_bf16 v[192:195], v[124:127], v[64:67], v[192:195]
buffer_load_dwordx4 v[44:47], v9, s[20:23], s87 offen offset:3072 sc1
v_mfma_f32_16x16x32_bf16 v[208:211], v[120:123], v[64:67], v[208:211]
v_mfma_f32_16x16x32_bf16 v[212:215], v[120:123], v[68:71], v[212:215]
v_mfma_f32_16x16x32_bf16 v[216:219], v[120:123], v[172:175], v[216:219]
v_mfma_f32_16x16x32_bf16 v[220:223], v[120:123], v[16:19], v[220:223]
v_mfma_f32_16x16x32_bf16 v[236:239], v[116:119], v[16:19], v[236:239]
v_mfma_f32_16x16x32_bf16 v[232:235], v[116:119], v[172:175], v[232:235]
v_mfma_f32_16x16x32_bf16 v[228:231], v[116:119], v[68:71], v[228:231]
v_mfma_f32_16x16x32_bf16 v[224:227], v[116:119], v[64:67], v[224:227]
v_mfma_f32_16x16x32_bf16 v[240:243], v[112:115], v[64:67], v[240:243]
v_mfma_f32_16x16x32_bf16 v[244:247], v[112:115], v[68:71], v[244:247]
v_mfma_f32_16x16x32_bf16 v[248:251], v[112:115], v[172:175], v[248:251]
v_mfma_f32_16x16x32_bf16 v[252:255], v[112:115], v[16:19], v[252:255]
s_waitcnt vmcnt(8)
v_mfma_f32_16x16x32_bf16 v[176:179], v[108:111], v[20:23], v[176:179]
v_mfma_f32_16x16x32_bf16 v[180:183], v[108:111], v[24:27], v[180:183]
s_add_u32 s87, s90, 28672
buffer_load_dwordx4 v[148:151], v8, s[20:23], s87 offen offset:0 sc1
v_mfma_f32_16x16x32_bf16 v[184:187], v[108:111], v[28:31], v[184:187]
v_mfma_f32_16x16x32_bf16 v[188:191], v[108:111], v[168:171], v[188:191]
buffer_load_dwordx4 v[144:147], v8, s[20:23], s87 offen offset:1024 sc1
v_mfma_f32_16x16x32_bf16 v[204:207], v[104:107], v[168:171], v[204:207]
v_mfma_f32_16x16x32_bf16 v[200:203], v[104:107], v[28:31], v[200:203]
buffer_load_dwordx4 v[140:143], v9, s[20:23], s87 offen offset:2048 sc1
v_mfma_f32_16x16x32_bf16 v[196:199], v[104:107], v[24:27], v[196:199]
v_mfma_f32_16x16x32_bf16 v[192:195], v[104:107], v[20:23], v[192:195]
buffer_load_dwordx4 v[136:139], v9, s[20:23], s87 offen offset:3072 sc1
v_mfma_f32_16x16x32_bf16 v[208:211], v[100:103], v[20:23], v[208:211]
v_mfma_f32_16x16x32_bf16 v[212:215], v[100:103], v[24:27], v[212:215]
v_mfma_f32_16x16x32_bf16 v[216:219], v[100:103], v[28:31], v[216:219]
v_mfma_f32_16x16x32_bf16 v[220:223], v[100:103], v[168:171], v[220:223]
v_mfma_f32_16x16x32_bf16 v[236:239], v[96:99], v[168:171], v[236:239]
v_mfma_f32_16x16x32_bf16 v[232:235], v[96:99], v[28:31], v[232:235]
v_mfma_f32_16x16x32_bf16 v[228:231], v[96:99], v[24:27], v[228:231]
v_mfma_f32_16x16x32_bf16 v[224:227], v[96:99], v[20:23], v[224:227]
v_mfma_f32_16x16x32_bf16 v[240:243], v[92:95], v[20:23], v[240:243]
v_mfma_f32_16x16x32_bf16 v[244:247], v[92:95], v[24:27], v[244:247]
v_mfma_f32_16x16x32_bf16 v[248:251], v[92:95], v[28:31], v[248:251]
v_mfma_f32_16x16x32_bf16 v[252:255], v[92:95], v[168:171], v[252:255]
s_waitcnt vmcnt(8)
v_mfma_f32_16x16x32_bf16 v[176:179], v[88:91], v[164:167], v[176:179]
ds_read_b128 v[132:135], v12 offset:0
v_mfma_f32_16x16x32_bf16 v[180:183], v[88:91], v[160:163], v[180:183]
s_add_u32 s87, s90, 32768
buffer_load_dwordx4 v[48:51], v8, s[20:23], s87 offen offset:0 sc1
v_mfma_f32_16x16x32_bf16 v[184:187], v[88:91], v[156:159], v[184:187]
ds_read_b128 v[52:55], v12 offset:1024
v_mfma_f32_16x16x32_bf16 v[188:191], v[88:91], v[152:155], v[188:191]
buffer_load_dwordx4 v[56:59], v8, s[20:23], s87 offen offset:1024 sc1
v_mfma_f32_16x16x32_bf16 v[204:207], v[84:87], v[152:155], v[204:207]
ds_read_b128 v[60:63], v12 offset:2048
v_mfma_f32_16x16x32_bf16 v[200:203], v[84:87], v[156:159], v[200:203]
buffer_load_dwordx4 v[128:131], v9, s[20:23], s87 offen offset:2048 sc1
v_mfma_f32_16x16x32_bf16 v[196:199], v[84:87], v[160:163], v[196:199]
ds_read_b128 v[124:127], v12 offset:3072
v_mfma_f32_16x16x32_bf16 v[192:195], v[84:87], v[164:167], v[192:195]
buffer_load_dwordx4 v[120:123], v9, s[20:23], s87 offen offset:3072 sc1
v_mfma_f32_16x16x32_bf16 v[208:211], v[80:83], v[164:167], v[208:211]
ds_read_b128 v[116:119], v12 offset:4096
v_mfma_f32_16x16x32_bf16 v[212:215], v[80:83], v[160:163], v[212:215]
s_add_u32 s87, s90, 36864
buffer_load_dwordx4 v[112:115], v8, s[20:23], s87 offen offset:0 sc1
v_mfma_f32_16x16x32_bf16 v[216:219], v[80:83], v[156:159], v[216:219]
v_mfma_f32_16x16x32_bf16 v[220:223], v[80:83], v[152:155], v[220:223]
buffer_load_dwordx4 v[64:67], v8, s[20:23], s87 offen offset:1024 sc1
v_mfma_f32_16x16x32_bf16 v[236:239], v[76:79], v[152:155], v[236:239]
v_mfma_f32_16x16x32_bf16 v[232:235], v[76:79], v[156:159], v[232:235]
buffer_load_dwordx4 v[68:71], v9, s[20:23], s87 offen offset:2048 sc1
v_mfma_f32_16x16x32_bf16 v[228:231], v[76:79], v[160:163], v[228:231]
v_mfma_f32_16x16x32_bf16 v[224:227], v[76:79], v[164:167], v[224:227]
buffer_load_dwordx4 v[172:175], v9, s[20:23], s87 offen offset:3072 sc1
v_mfma_f32_16x16x32_bf16 v[240:243], v[72:75], v[164:167], v[240:243]
v_mfma_f32_16x16x32_bf16 v[244:247], v[72:75], v[160:163], v[244:247]
v_mfma_f32_16x16x32_bf16 v[248:251], v[72:75], v[156:159], v[248:251]
v_mfma_f32_16x16x32_bf16 v[252:255], v[72:75], v[152:155], v[252:255]
s_waitcnt vmcnt(12)
s_waitcnt lgkmcnt(0)
v_mfma_f32_16x16x32_bf16 v[176:179], v[132:135], v[32:35], v[176:179]
ds_read_b128 v[108:111], v12 offset:5120
v_mfma_f32_16x16x32_bf16 v[180:183], v[132:135], v[36:39], v[180:183]
ds_read_b128 v[104:107], v12 offset:6144
v_mfma_f32_16x16x32_bf16 v[184:187], v[132:135], v[40:43], v[184:187]
ds_read_b128 v[100:103], v12 offset:7168
v_mfma_f32_16x16x32_bf16 v[188:191], v[132:135], v[44:47], v[188:191]
ds_read_b128 v[96:99], v12 offset:8192
v_mfma_f32_16x16x32_bf16 v[204:207], v[52:55], v[44:47], v[204:207]
ds_read_b128 v[92:95], v12 offset:9216
v_mfma_f32_16x16x32_bf16 v[200:203], v[52:55], v[40:43], v[200:203]
v_mfma_f32_16x16x32_bf16 v[196:199], v[52:55], v[36:39], v[196:199]
v_mfma_f32_16x16x32_bf16 v[192:195], v[52:55], v[32:35], v[192:195]
v_mfma_f32_16x16x32_bf16 v[208:211], v[60:63], v[32:35], v[208:211]
v_mfma_f32_16x16x32_bf16 v[212:215], v[60:63], v[36:39], v[212:215]
v_mfma_f32_16x16x32_bf16 v[216:219], v[60:63], v[40:43], v[216:219]
v_mfma_f32_16x16x32_bf16 v[220:223], v[60:63], v[44:47], v[220:223]
v_mfma_f32_16x16x32_bf16 v[236:239], v[124:127], v[44:47], v[236:239]
v_mfma_f32_16x16x32_bf16 v[232:235], v[124:127], v[40:43], v[232:235]
v_mfma_f32_16x16x32_bf16 v[228:231], v[124:127], v[36:39], v[228:231]
v_mfma_f32_16x16x32_bf16 v[224:227], v[124:127], v[32:35], v[224:227]
v_mfma_f32_16x16x32_bf16 v[240:243], v[116:119], v[32:35], v[240:243]
v_mfma_f32_16x16x32_bf16 v[244:247], v[116:119], v[36:39], v[244:247]
v_mfma_f32_16x16x32_bf16 v[248:251], v[116:119], v[40:43], v[248:251]
v_mfma_f32_16x16x32_bf16 v[252:255], v[116:119], v[44:47], v[252:255]
s_waitcnt vmcnt(8)
s_waitcnt lgkmcnt(0)
v_mfma_f32_16x16x32_bf16 v[176:179], v[108:111], v[148:151], v[176:179]
ds_read_b128 v[168:171], v12 offset:10240
s_mov_b64 s[24:25], s[50:51]
s_mov_b32 s26, 2621440
v_mfma_f32_16x16x32_bf16 v[180:183], v[108:111], v[144:147], v[180:183]
ds_read_b128 v[88:91], v12 offset:11264
s_mov_b32 s27, 0x20000
s_lshl_b32 s60, s56, 6
v_mfma_f32_16x16x32_bf16 v[184:187], v[108:111], v[140:143], v[184:187]
ds_read_b128 v[84:87], v12 offset:12288
v_mov_b32 v30, 0xbfb8aa3b
v_mfma_f32_16x16x32_bf16 v[188:191], v[108:111], v[136:139], v[188:191]
ds_read_b128 v[80:83], v12 offset:13312
v_mov_b32 v31, 1.0
v_mfma_f32_16x16x32_bf16 v[204:207], v[104:107], v[136:139], v[204:207]
ds_read_b128 v[76:79], v12 offset:14336
s_bfe_u32 s61, s92, 0x10005
s_lshl_b32 s62, s61, 5
v_mfma_f32_16x16x32_bf16 v[200:203], v[104:107], v[140:143], v[200:203]
ds_read_b128 v[72:75], v12 offset:15360
s_lshl_b32 s61, s61, 7
s_sub_u32 s61, 128, s61
v_mfma_f32_16x16x32_bf16 v[196:199], v[104:107], v[144:147], v[196:199]
ds_read_b128 v[164:167], v15 offset:16384
v_add_u32 v5, s60, v0
v_mfma_f32_16x16x32_bf16 v[192:195], v[104:107], v[148:151], v[192:195]
ds_read_b128 v[160:163], v15 offset:17408
v_lshrrev_b32 v2, 4, v5
v_mfma_f32_16x16x32_bf16 v[208:211], v[100:103], v[148:151], v[208:211]
ds_read_b128 v[156:159], v15 offset:18432
v_and_b32 v4, 7, v2
v_mfma_f32_16x16x32_bf16 v[212:215], v[100:103], v[144:147], v[212:215]
ds_read_b128 v[152:155], v15 offset:19456
v_xor_b32 v4, v4, v5
v_mfma_f32_16x16x32_bf16 v[216:219], v[100:103], v[140:143], v[216:219]
v_lshlrev_b32 v16, 4, v4
v_and_b32 v3, 15, v5
v_mfma_f32_16x16x32_bf16 v[220:223], v[100:103], v[136:139], v[220:223]
v_lshl_add_u32 v3, v3, 3, s62
v_and_b32 v5, 15, v2
v_mfma_f32_16x16x32_bf16 v[236:239], v[96:99], v[136:139], v[236:239]
v_bfe_u32 v4, v2, 4, 1
v_lshl_add_u32 v5, v5, 1, v4
v_mfma_f32_16x16x32_bf16 v[232:235], v[96:99], v[140:143], v[232:235]
v_and_or_b32 v5, v2, 32, v5
v_mul_u32_u24 v5, 1280, v5
v_mfma_f32_16x16x32_bf16 v[228:231], v[96:99], v[144:147], v[228:231]
v_add_u32 v20, v3, v5
buffer_load_dwordx2 v[24:25], v20, s[8:11], s92 offen
s_add_u32 s60, s60, 512
v_mfma_f32_16x16x32_bf16 v[224:227], v[96:99], v[148:151], v[224:227]
v_add_u32 v5, s60, v0
v_lshrrev_b32 v2, 4, v5
v_mfma_f32_16x16x32_bf16 v[240:243], v[92:95], v[148:151], v[240:243]
v_and_b32 v4, 7, v2
v_xor_b32 v4, v4, v5
v_mfma_f32_16x16x32_bf16 v[244:247], v[92:95], v[144:147], v[244:247]
v_lshlrev_b32 v17, 4, v4
v_and_b32 v3, 15, v5
v_mfma_f32_16x16x32_bf16 v[248:251], v[92:95], v[140:143], v[248:251]
v_lshl_add_u32 v3, v3, 3, s62
v_and_b32 v5, 15, v2
v_mfma_f32_16x16x32_bf16 v[252:255], v[92:95], v[136:139], v[252:255]
v_bfe_u32 v4, v2, 4, 1
v_lshl_add_u32 v5, v5, 1, v4
s_waitcnt vmcnt(1)
s_waitcnt lgkmcnt(0)
v_mfma_f32_16x16x32_bf16 v[176:179], v[168:171], v[48:51], v[176:179]
v_and_or_b32 v5, v2, 32, v5
v_mul_u32_u24 v5, 1280, v5
v_mfma_f32_16x16x32_bf16 v[176:179], v[72:75], v[112:115], v[176:179]
v_add_u32 v21, v3, v5
buffer_load_dwordx2 v[26:27], v21, s[8:11], s92 offen
s_add_u32 s60, s60, 512
v_mfma_f32_16x16x32_bf16 v[180:183], v[168:171], v[56:59], v[180:183]
v_mfma_f32_16x16x32_bf16 v[180:183], v[72:75], v[64:67], v[180:183]
v_mfma_f32_16x16x32_bf16 v[184:187], v[168:171], v[128:131], v[184:187]
v_mfma_f32_16x16x32_bf16 v[184:187], v[72:75], v[68:71], v[184:187]
v_mfma_f32_16x16x32_bf16 v[188:191], v[168:171], v[120:123], v[188:191]
v_mfma_f32_16x16x32_bf16 v[188:191], v[72:75], v[172:175], v[188:191]
v_mfma_f32_16x16x32_bf16 v[192:195], v[88:91], v[48:51], v[192:195]
ds_write_b128 v13, v[176:179] offset:0
v_mfma_f32_16x16x32_bf16 v[192:195], v[164:167], v[112:115], v[192:195]
v_mfma_f32_16x16x32_bf16 v[196:199], v[88:91], v[56:59], v[196:199]
ds_write_b128 v13, v[180:183] offset:4096
v_mfma_f32_16x16x32_bf16 v[196:199], v[164:167], v[64:67], v[196:199]
v_mfma_f32_16x16x32_bf16 v[200:203], v[88:91], v[128:131], v[200:203]
ds_write_b128 v13, v[184:187] offset:8192
v_mfma_f32_16x16x32_bf16 v[200:203], v[164:167], v[68:71], v[200:203]
v_mfma_f32_16x16x32_bf16 v[204:207], v[88:91], v[120:123], v[204:207]
ds_write_b128 v13, v[188:191] offset:12288
v_mfma_f32_16x16x32_bf16 v[204:207], v[164:167], v[172:175], v[204:207]
v_mfma_f32_16x16x32_bf16 v[208:211], v[84:87], v[48:51], v[208:211]
ds_write_b128 v7, v[192:195] offset:0
v_mfma_f32_16x16x32_bf16 v[208:211], v[160:163], v[112:115], v[208:211]
v_mfma_f32_16x16x32_bf16 v[212:215], v[84:87], v[56:59], v[212:215]
ds_write_b128 v7, v[196:199] offset:4096
v_mfma_f32_16x16x32_bf16 v[212:215], v[160:163], v[64:67], v[212:215]
v_mfma_f32_16x16x32_bf16 v[216:219], v[84:87], v[128:131], v[216:219]
ds_write_b128 v7, v[200:203] offset:8192
v_mfma_f32_16x16x32_bf16 v[216:219], v[160:163], v[68:71], v[216:219]
v_mfma_f32_16x16x32_bf16 v[220:223], v[84:87], v[120:123], v[220:223]
ds_write_b128 v7, v[204:207] offset:12288
v_mfma_f32_16x16x32_bf16 v[220:223], v[160:163], v[172:175], v[220:223]
v_mfma_f32_16x16x32_bf16 v[224:227], v[80:83], v[48:51], v[224:227]
ds_write_b128 v13, v[208:211] offset:128
v_mfma_f32_16x16x32_bf16 v[224:227], v[156:159], v[112:115], v[224:227]
v_mfma_f32_16x16x32_bf16 v[228:231], v[80:83], v[56:59], v[228:231]
ds_write_b128 v13, v[212:215] offset:4224
v_mfma_f32_16x16x32_bf16 v[228:231], v[156:159], v[64:67], v[228:231]
v_mfma_f32_16x16x32_bf16 v[232:235], v[80:83], v[128:131], v[232:235]
ds_write_b128 v13, v[216:219] offset:8320
v_mfma_f32_16x16x32_bf16 v[232:235], v[156:159], v[68:71], v[232:235]
v_mfma_f32_16x16x32_bf16 v[236:239], v[80:83], v[120:123], v[236:239]
ds_write_b128 v13, v[220:223] offset:12416
v_mfma_f32_16x16x32_bf16 v[236:239], v[156:159], v[172:175], v[236:239]
v_mfma_f32_16x16x32_bf16 v[240:243], v[76:79], v[48:51], v[240:243]
ds_write_b128 v7, v[224:227] offset:128
v_mfma_f32_16x16x32_bf16 v[240:243], v[152:155], v[112:115], v[240:243]
v_mfma_f32_16x16x32_bf16 v[244:247], v[76:79], v[56:59], v[244:247]
ds_write_b128 v7, v[228:231] offset:4224
v_mfma_f32_16x16x32_bf16 v[244:247], v[152:155], v[64:67], v[244:247]
v_mfma_f32_16x16x32_bf16 v[248:251], v[76:79], v[128:131], v[248:251]
ds_write_b128 v7, v[232:235] offset:8320
v_mfma_f32_16x16x32_bf16 v[248:251], v[152:155], v[68:71], v[248:251]
v_mfma_f32_16x16x32_bf16 v[252:255], v[76:79], v[120:123], v[252:255]
ds_write_b128 v7, v[236:239] offset:12416
v_mfma_f32_16x16x32_bf16 v[252:255], v[152:155], v[172:175], v[252:255]
s_branch L_FIN
L_G0:
v_lshrrev_b32 v1, 4, v0
v_and_b32 v2, 15, v0
v_bfe_u32 v3, v0, 2, 2
v_and_b32 v4, 3, v0
v_lshrrev_b32 v5, 1, v3
v_and_b32 v6, 1, v1
v_lshl_or_b32 v5, v6, 1, v5
s_and_b32 s60, s2, 7
s_lshr_b32 s61, s2, 6
s_lshl_b32 s60, s60, 2
s_add_u32 s60, s60, s61
s_bfe_u32 s61, s2, 0x30003
s_sub_u32 s62, s56, 2
s_cmp_lt_u32 s56, 4
s_cselect_b32 s62, s56, s62
s_mul_i32 s62, s62, 9
s_add_u32 s62, s62, 20
s_sub_u32 s63, s56, 4
s_mul_i32 s67, s63, 10
s_cmp_lt_u32 s63, 2
s_cselect_b32 s62, s67, s62
s_mul_i32 s67, s60, 74
s_add_u32 s67, s67, s62
s_lshl_b32 s67, s67, 12
s_add_u32 s90, s67, 4194304
s_mul_i32 s67, s61, 74
s_add_u32 s67, s67, s62
s_mul_i32 s67, s67, 5120
s_add_u32 s91, s67, 1048576
s_mul_i32 s67, s61, 378880
s_add_u32 s77, s67, 1150976
s_mul_i32 s92, s60, 81920
s_mul_i32 s67, s61, 160
s_add_u32 s92, s92, s67
s_sub_u32 s62, s56, 2
s_cmp_lt_u32 s56, 4
s_cselect_b32 s62, s56, s62
s_mul_i32 s89, s60, 6
s_add_u32 s89, s89, s62
s_lshl_b32 s89, s89, 7
s_add_u32 s89, s89, 262144
v_lshlrev_b32 v14, 4, v0
s_waitcnt lgkmcnt(0)
s_mov_b64 s[20:21], s[54:55]
s_mov_b32 s22, 25165824
s_mov_b32 s23, 0x20000
s_mov_b64 s[8:9], s[36:37]
s_mov_b32 s10, 2621440
s_mov_b32 s11, 0x20000
s_mov_b32 s5, 1
s_movk_i32 s6, 256
s_mov_b32 s7, 65536
s_cmp_eq_u32 s82, 1
s_cbranch_scc1 L_G0A
s_lshr_b32 s86, s81, 1
s_and_b32 s87, s81, 1
v_lshrrev_b32 v6, 1, v2
v_xor_b32 v6, v6, v1
v_lshlrev_b32 v6, 4, v6
v_lshl_add_u32 v6, v2, 7, v6
v_lshrrev_b32 v7, 3, v2
v_mul_u32_u24 v7, 9216, v7
s_mul_i32 s60, s86, 2048
s_add_u32 s60, s60, 98304
v_add3_u32 v10, s60, v6, v7
v_xor_b32 v11, 64, v10
s_lshl_b32 s61, s87, 6
s_add_u32 s61, s61, 0
v_lshl_add_u32 v12, v4, 3, s61
v_lshrrev_b32 v6, 7, v12
v_mad_u32_u24 v6, v1, 24, v6
v_lshlrev_b32 v6, 10, v6
v_lshl_add_u32 v6, v3, 7, v6
v_bfe_u32 v7, v12, 5, 2
v_xor_b32 v7, v7, v5
v_lshl_add_u32 v6, v7, 5, v6
v_and_b32 v7, 31, v12
v_add_u32 v8, v6, v7
s_lshl_b32 s61, s87, 6
s_add_u32 s61, s61, 32
v_lshl_add_u32 v12, v4, 3, s61
v_lshrrev_b32 v6, 7, v12
v_mad_u32_u24 v6, v1, 24, v6
v_lshlrev_b32 v6, 10, v6
v_lshl_add_u32 v6, v3, 7, v6
v_bfe_u32 v7, v12, 5, 2
v_xor_b32 v7, v7, v5
v_lshl_add_u32 v6, v7, 5, v6
v_and_b32 v7, 31, v12
v_add_u32 v9, v6, v7
s_lshl_b32 s61, s86, 10
s_add_u32 s61, s61, 142848
v_lshl_add_u32 v12, v2, 4, s61
s_lshl_b32 s61, s87, 7
s_add_u32 s61, s61, 141312
v_lshl_add_u32 v13, v1, 4, s61
s_lshl_b32 s61, s58, 1
s_add_u32 s61, s61, s87
s_lshl_b32 s65, s80, 1
s_add_u32 s65, s65, s86
s_mov_b32 s76, 1
s_mul_i32 s63, s61, 209716
s_lshr_b32 s63, s63, 20
s_mul_i32 s64, s63, 5
s_sub_u32 s64, s61, s64
s_mov_b32 s62, 0x12289040
s_cmp_eq_u32 s63, 1
s_cmov_b32 s62, 0x2591c6d3
s_cmp_eq_u32 s63, 2
s_cmov_b32 s62, 0x2eb689e6
s_cmp_eq_u32 s63, 3
s_cmov_b32 s62, 0x31c2f
s_mul_i32 s64, s64, 6
s_lshr_b32 s62, s62, s64
s_and_b32 s62, s62, 63
s_mul_i32 s63, s62, 116509
s_lshr_b32 s63, s63, 20
s_mul_i32 s64, s63, 9
s_sub_u32 s64, s62, s64
s_mul_i32 s66, s65, 74
s_add_u32 s66, s66, s62
s_lshl_b32 s66, s66, 12
s_add_u32 s68, s66, 4276224
s_mul_i32 s66, s65, 6
s_add_u32 s66, s66, s63
s_lshl_b32 s66, s66, 7
s_add_u32 s71, s66, 262144
s_mov_b32 s66, 0x15400
s_cmp_lt_u32 s63, 4
s_cmov_b32 s66, 0x2aa50
s_lshl_b32 s64, s64, 1
s_lshr_b32 s66, s66, s64
s_and_b32 s66, s66, 3
s_lshl_b32 s66, s66, 3
s_lshl_b32 s5, 1, s66
s_mul_i32 s63, s61, 209716
s_lshr_b32 s63, s63, 20
s_mul_i32 s64, s63, 5
s_sub_u32 s64, s61, s64
s_mov_b32 s62, 0xc2c40c2
s_cmp_eq_u32 s63, 1
s_cmov_b32 s62, 0x1e75550d
s_cmp_eq_u32 s63, 2
s_cmov_b32 s62, 0x32b2baa9
s_cmp_eq_u32 s63, 3
s_cmov_b32 s62, 0x35d33
s_mul_i32 s64, s64, 6
s_lshr_b32 s62, s62, s64
s_and_b32 s62, s62, 63
s_mul_i32 s63, s62, 116509
s_lshr_b32 s63, s63, 20
s_mul_i32 s64, s63, 9
s_sub_u32 s64, s62, s64
s_mul_i32 s66, s65, 74
s_add_u32 s66, s66, s62
s_lshl_b32 s66, s66, 12
s_add_u32 s69, s66, 4276224
s_mul_i32 s66, s65, 6
s_add_u32 s66, s66, s63
s_lshl_b32 s66, s66, 7
s_add_u32 s72, s66, 262144
s_mov_b32 s66, 0x15400
s_cmp_lt_u32 s63, 4
s_cmov_b32 s66, 0x2aa50
s_lshl_b32 s64, s64, 1
s_lshr_b32 s66, s66, s64
s_and_b32 s66, s66, 3
s_lshl_b32 s66, s66, 3
s_lshl_b32 s6, 1, s66
s_mul_i32 s63, s61, 209716
s_lshr_b32 s63, s63, 20
s_mul_i32 s64, s63, 5
s_sub_u32 s64, s61, s64
s_mov_b32 s62, 0xe207185
s_cmp_eq_u32 s63, 1
s_cmov_b32 s62, 0x1759140f
s_cmp_eq_u32 s63, 2
s_cmov_b32 s62, 0x207da658
s_cmp_eq_u32 s63, 3
s_cmov_b32 s62, 0x238a1
s_mul_i32 s64, s64, 6
s_lshr_b32 s62, s62, s64
s_and_b32 s62, s62, 63
s_mul_i32 s63, s62, 116509
s_lshr_b32 s63, s63, 20
s_mul_i32 s64, s63, 9
s_sub_u32 s64, s62, s64
s_mul_i32 s66, s65, 74
s_add_u32 s66, s66, s62
s_lshl_b32 s66, s66, 12
s_add_u32 s70, s66, 4276224
s_mul_i32 s66, s65, 6
s_add_u32 s66, s66, s63
s_lshl_b32 s66, s66, 7
s_add_u32 s79, s66, 262144
s_mov_b32 s66, 0x15400
s_cmp_lt_u32 s63, 4
s_cmov_b32 s66, 0x2aa50
s_lshl_b32 s64, s64, 1
s_lshr_b32 s66, s66, s64
s_and_b32 s66, s66, 3
s_lshl_b32 s66, s66, 3
s_lshl_b32 s7, 1, s66
v_mov_b64 v[64:65], 0
v_mov_b64 v[66:67], 0
v_mov_b64 v[68:69], 0
v_mov_b64 v[70:71], 0
v_mov_b64 v[72:73], 0
v_mov_b64 v[74:75], 0
v_mov_b64 v[76:77], 0
v_mov_b64 v[78:79], 0
v_mov_b64 v[80:81], 0
v_mov_b64 v[82:83], 0
v_mov_b64 v[84:85], 0
v_mov_b64 v[86:87], 0
v_mov_b64 v[88:89], 0
v_mov_b64 v[90:91], 0
v_mov_b64 v[92:93], 0
v_mov_b64 v[94:95], 0
v_mov_b64 v[96:97], 0
v_mov_b64 v[98:99], 0
v_mov_b64 v[100:101], 0
v_mov_b64 v[102:103], 0
v_mov_b64 v[104:105], 0
v_mov_b64 v[106:107], 0
v_mov_b64 v[108:109], 0
v_mov_b64 v[110:111], 0
v_mov_b64 v[112:113], 0
v_mov_b64 v[114:115], 0
v_mov_b64 v[116:117], 0
v_mov_b64 v[118:119], 0
v_mov_b64 v[120:121], 0
v_mov_b64 v[122:123], 0
v_mov_b64 v[124:125], 0
v_mov_b64 v[126:127], 0
v_mov_b64 v[128:129], 0
v_mov_b64 v[130:131], 0
v_mov_b64 v[132:133], 0
v_mov_b64 v[134:135], 0
v_mov_b64 v[136:137], 0
v_mov_b64 v[138:139], 0
v_mov_b64 v[140:141], 0
v_mov_b64 v[142:143], 0
v_mov_b64 v[144:145], 0
v_mov_b64 v[146:147], 0
v_mov_b64 v[148:149], 0
v_mov_b64 v[150:151], 0
v_mov_b64 v[152:153], 0
v_mov_b64 v[154:155], 0
v_mov_b64 v[156:157], 0
v_mov_b64 v[158:159], 0
v_mov_b64 v[160:161], 0
v_mov_b64 v[162:163], 0
v_mov_b64 v[164:165], 0
v_mov_b64 v[166:167], 0
v_mov_b64 v[168:169], 0
v_mov_b64 v[170:171], 0
v_mov_b64 v[172:173], 0
v_mov_b64 v[174:175], 0
v_mov_b64 v[176:177], 0
v_mov_b64 v[178:179], 0
v_mov_b64 v[180:181], 0
v_mov_b64 v[182:183], 0
v_mov_b64 v[184:185], 0
v_mov_b64 v[186:187], 0
v_mov_b64 v[188:189], 0
v_mov_b64 v[190:191], 0
v_mov_b64 v[192:193], 0
v_mov_b64 v[194:195], 0
v_mov_b64 v[196:197], 0
v_mov_b64 v[198:199], 0
v_mov_b64 v[200:201], 0
v_mov_b64 v[202:203], 0
v_mov_b64 v[204:205], 0
v_mov_b64 v[206:207], 0
v_mov_b64 v[208:209], 0
v_mov_b64 v[210:211], 0
v_mov_b64 v[212:213], 0
v_mov_b64 v[214:215], 0
v_mov_b64 v[216:217], 0
v_mov_b64 v[218:219], 0
v_mov_b64 v[220:221], 0
v_mov_b64 v[222:223], 0
v_mov_b64 v[224:225], 0
v_mov_b64 v[226:227], 0
v_mov_b64 v[228:229], 0
v_mov_b64 v[230:231], 0
v_mov_b64 v[232:233], 0
v_mov_b64 v[234:235], 0
v_mov_b64 v[236:237], 0
v_mov_b64 v[238:239], 0
v_mov_b64 v[240:241], 0
v_mov_b64 v[242:243], 0
v_mov_b64 v[244:245], 0
v_mov_b64 v[246:247], 0
v_mov_b64 v[248:249], 0
v_mov_b64 v[250:251], 0
v_mov_b64 v[252:253], 0
v_mov_b64 v[254:255], 0
s_waitcnt vmcnt(0)
s_barrier
ds_read_b128 v[16:19], v10 offset:0
ds_read_b128 v[20:23], v10 offset:5120
ds_read_b128 v[24:27], v10 offset:1024
ds_read_b128 v[28:31], v10 offset:6144
ds_read_b64_tr_b16 v[48:49], v8 offset:0
ds_read_b64_tr_b16 v[50:51], v8 offset:512
ds_read_b64_tr_b16 v[52:53], v8 offset:1024
ds_read_b64_tr_b16 v[54:55], v8 offset:1536
s_mov_b32 s60, 5
.p2align 6
L_loopB:
s_waitcnt lgkmcnt(2)
v_mfma_f32_16x16x32_bf16 v[64:67], v[48:51], v[16:19], v[64:67]
ds_read_b64_tr_b16 v[56:57], v9 offset:0
v_mfma_f32_16x16x32_bf16 v[68:71], v[48:51], v[20:23], v[68:71]
ds_read_b64_tr_b16 v[58:59], v9 offset:512
v_mfma_f32_16x16x32_bf16 v[72:75], v[48:51], v[24:27], v[72:75]
v_mfma_f32_16x16x32_bf16 v[76:79], v[48:51], v[28:31], v[76:79]
s_waitcnt lgkmcnt(2)
v_mfma_f32_16x16x32_bf16 v[92:95], v[52:55], v[28:31], v[92:95]
ds_read_b64_tr_b16 v[60:61], v9 offset:1024
v_mfma_f32_16x16x32_bf16 v[88:91], v[52:55], v[24:27], v[88:91]
ds_read_b64_tr_b16 v[62:63], v9 offset:1536
v_mfma_f32_16x16x32_bf16 v[84:87], v[52:55], v[20:23], v[84:87]
v_mfma_f32_16x16x32_bf16 v[80:83], v[52:55], v[16:19], v[80:83]
s_waitcnt lgkmcnt(2)
v_mfma_f32_16x16x32_bf16 v[96:99], v[56:59], v[16:19], v[96:99]
ds_read_b64_tr_b16 v[48:49], v8 offset:2048
v_mfma_f32_16x16x32_bf16 v[100:103], v[56:59], v[20:23], v[100:103]
ds_read_b64_tr_b16 v[50:51], v8 offset:2560
v_mfma_f32_16x16x32_bf16 v[104:107], v[56:59], v[24:27], v[104:107]
v_mfma_f32_16x16x32_bf16 v[108:111], v[56:59], v[28:31], v[108:111]
s_waitcnt lgkmcnt(2)
v_mfma_f32_16x16x32_bf16 v[124:127], v[60:63], v[28:31], v[124:127]
ds_read_b64_tr_b16 v[52:53], v8 offset:3072
v_mfma_f32_16x16x32_bf16 v[120:123], v[60:63], v[24:27], v[120:123]
ds_read_b64_tr_b16 v[54:55], v8 offset:3584
v_mfma_f32_16x16x32_bf16 v[116:119], v[60:63], v[20:23], v[116:119]
v_mfma_f32_16x16x32_bf16 v[112:115], v[60:63], v[16:19], v[112:115]
s_waitcnt lgkmcnt(2)
v_mfma_f32_16x16x32_bf16 v[128:131], v[48:51], v[16:19], v[128:131]
ds_read_b64_tr_b16 v[56:57], v9 offset:2048
v_mfma_f32_16x16x32_bf16 v[132:135], v[48:51], v[20:23], v[132:135]
ds_read_b64_tr_b16 v[58:59], v9 offset:2560
v_mfma_f32_16x16x32_bf16 v[136:139], v[48:51], v[24:27], v[136:139]
v_mfma_f32_16x16x32_bf16 v[140:143], v[48:51], v[28:31], v[140:143]
s_waitcnt lgkmcnt(2)
v_mfma_f32_16x16x32_bf16 v[156:159], v[52:55], v[28:31], v[156:159]
ds_read_b64_tr_b16 v[60:61], v9 offset:3072
v_mfma_f32_16x16x32_bf16 v[152:155], v[52:55], v[24:27], v[152:155]
ds_read_b64_tr_b16 v[62:63], v9 offset:3584
v_mfma_f32_16x16x32_bf16 v[148:151], v[52:55], v[20:23], v[148:151]
v_mfma_f32_16x16x32_bf16 v[144:147], v[52:55], v[16:19], v[144:147]
s_waitcnt lgkmcnt(2)
v_mfma_f32_16x16x32_bf16 v[160:163], v[56:59], v[16:19], v[160:163]
s_barrier
v_mfma_f32_16x16x32_bf16 v[164:167], v[56:59], v[20:23], v[164:167]
ds_read_b64_tr_b16 v[48:49], v8 offset:4096
v_mfma_f32_16x16x32_bf16 v[168:171], v[56:59], v[24:27], v[168:171]
ds_read_b64_tr_b16 v[50:51], v8 offset:4608
v_mfma_f32_16x16x32_bf16 v[172:175], v[56:59], v[28:31], v[172:175]
s_waitcnt lgkmcnt(2)
v_mfma_f32_16x16x32_bf16 v[188:191], v[60:63], v[28:31], v[188:191]
ds_read_b64_tr_b16 v[52:53], v8 offset:5120
v_mfma_f32_16x16x32_bf16 v[184:187], v[60:63], v[24:27], v[184:187]
ds_read_b64_tr_b16 v[54:55], v8 offset:5632
v_mfma_f32_16x16x32_bf16 v[180:183], v[60:63], v[20:23], v[180:183]
ds_read_b128 v[32:35], v11 offset:0
v_mfma_f32_16x16x32_bf16 v[176:179], v[60:63], v[16:19], v[176:179]
s_waitcnt lgkmcnt(3)
v_mfma_f32_16x16x32_bf16 v[192:195], v[48:51], v[16:19], v[192:195]
ds_read_b64_tr_b16 v[56:57], v9 offset:4096
v_mfma_f32_16x16x32_bf16 v[196:199], v[48:51], v[20:23], v[196:199]
ds_read_b64_tr_b16 v[58:59], v9 offset:4608
v_mfma_f32_16x16x32_bf16 v[200:203], v[48:51], v[24:27], v[200:203]
ds_read_b128 v[36:39], v11 offset:5120
v_mfma_f32_16x16x32_bf16 v[204:207], v[48:51], v[28:31], v[204:207]
s_waitcnt lgkmcnt(4)
v_mfma_f32_16x16x32_bf16 v[220:223], v[52:55], v[28:31], v[220:223]
ds_read_b64_tr_b16 v[60:61], v9 offset:5120
v_mfma_f32_16x16x32_bf16 v[216:219], v[52:55], v[24:27], v[216:219]
ds_read_b64_tr_b16 v[62:63], v9 offset:5632
v_mfma_f32_16x16x32_bf16 v[212:215], v[52:55], v[20:23], v[212:215]
ds_read_b128 v[40:43], v11 offset:1024
v_mfma_f32_16x16x32_bf16 v[208:211], v[52:55], v[16:19], v[208:211]
s_waitcnt lgkmcnt(4)
v_mfma_f32_16x16x32_bf16 v[224:227], v[56:59], v[16:19], v[224:227]
ds_read_b64_tr_b16 v[48:49], v8 offset:6144
v_mfma_f32_16x16x32_bf16 v[228:231], v[56:59], v[20:23], v[228:231]
ds_read_b64_tr_b16 v[50:51], v8 offset:6656
v_mfma_f32_16x16x32_bf16 v[232:235], v[56:59], v[24:27], v[232:235]
ds_read_b128 v[44:47], v11 offset:6144
v_mfma_f32_16x16x32_bf16 v[236:239], v[56:59], v[28:31], v[236:239]
s_waitcnt lgkmcnt(4)
v_mfma_f32_16x16x32_bf16 v[252:255], v[60:63], v[28:31], v[252:255]
ds_read_b64_tr_b16 v[52:53], v8 offset:7168
v_mfma_f32_16x16x32_bf16 v[248:251], v[60:63], v[24:27], v[248:251]
ds_read_b64_tr_b16 v[54:55], v8 offset:7680
v_mfma_f32_16x16x32_bf16 v[244:247], v[60:63], v[20:23], v[244:247]
v_mfma_f32_16x16x32_bf16 v[240:243], v[60:63], v[16:19], v[240:243]
s_waitcnt lgkmcnt(2)
v_mfma_f32_16x16x32_bf16 v[64:67], v[48:51], v[32:35], v[64:67]
ds_read_b64_tr_b16 v[56:57], v9 offset:6144
v_mfma_f32_16x16x32_bf16 v[68:71], v[48:51], v[36:39], v[68:71]
ds_read_b64_tr_b16 v[58:59], v9 offset:6656
v_mfma_f32_16x16x32_bf16 v[72:75], v[48:51], v[40:43], v[72:75]
v_mfma_f32_16x16x32_bf16 v[76:79], v[48:51], v[44:47], v[76:79]
s_waitcnt lgkmcnt(2)
v_mfma_f32_16x16x32_bf16 v[92:95], v[52:55], v[44:47], v[92:95]
ds_read_b64_tr_b16 v[60:61], v9 offset:7168
v_mfma_f32_16x16x32_bf16 v[88:91], v[52:55], v[40:43], v[88:91]
ds_read_b64_tr_b16 v[62:63], v9 offset:7680
v_mfma_f32_16x16x32_bf16 v[84:87], v[52:55], v[36:39], v[84:87]
v_mfma_f32_16x16x32_bf16 v[80:83], v[52:55], v[32:35], v[80:83]
s_waitcnt lgkmcnt(2)
v_mfma_f32_16x16x32_bf16 v[96:99], v[56:59], v[32:35], v[96:99]
ds_read_b64_tr_b16 v[48:49], v8 offset:8192
v_mfma_f32_16x16x32_bf16 v[100:103], v[56:59], v[36:39], v[100:103]
ds_read_b64_tr_b16 v[50:51], v8 offset:8704
v_mfma_f32_16x16x32_bf16 v[104:107], v[56:59], v[40:43], v[104:107]
v_mfma_f32_16x16x32_bf16 v[108:111], v[56:59], v[44:47], v[108:111]
s_waitcnt lgkmcnt(2)
v_mfma_f32_16x16x32_bf16 v[124:127], v[60:63], v[44:47], v[124:127]
ds_read_b64_tr_b16 v[52:53], v8 offset:9216
v_mfma_f32_16x16x32_bf16 v[120:123], v[60:63], v[40:43], v[120:123]
ds_read_b64_tr_b16 v[54:55], v8 offset:9728
v_mfma_f32_16x16x32_bf16 v[116:119], v[60:63], v[36:39], v[116:119]
v_mfma_f32_16x16x32_bf16 v[112:115], v[60:63], v[32:35], v[112:115]
s_waitcnt lgkmcnt(2)
v_mfma_f32_16x16x32_bf16 v[128:131], v[48:51], v[32:35], v[128:131]
ds_read_b64_tr_b16 v[56:57], v9 offset:8192
v_mfma_f32_16x16x32_bf16 v[132:135], v[48:51], v[36:39], v[132:135]
ds_read_b64_tr_b16 v[58:59], v9 offset:8704
v_mfma_f32_16x16x32_bf16 v[136:139], v[48:51], v[40:43], v[136:139]
v_mfma_f32_16x16x32_bf16 v[140:143], v[48:51], v[44:47], v[140:143]
s_waitcnt lgkmcnt(2)
v_mfma_f32_16x16x32_bf16 v[156:159], v[52:55], v[44:47], v[156:159]
ds_read_b64_tr_b16 v[60:61], v9 offset:9216
v_mfma_f32_16x16x32_bf16 v[152:155], v[52:55], v[40:43], v[152:155]
ds_read_b64_tr_b16 v[62:63], v9 offset:9728
v_mfma_f32_16x16x32_bf16 v[148:151], v[52:55], v[36:39], v[148:151]
v_mfma_f32_16x16x32_bf16 v[144:147], v[52:55], v[32:35], v[144:147]
s_waitcnt lgkmcnt(2)
v_mfma_f32_16x16x32_bf16 v[160:163], v[56:59], v[32:35], v[160:163]
s_barrier
v_mfma_f32_16x16x32_bf16 v[164:167], v[56:59], v[36:39], v[164:167]
ds_read_b64_tr_b16 v[48:49], v8 offset:10240
v_mfma_f32_16x16x32_bf16 v[168:171], v[56:59], v[40:43], v[168:171]
ds_read_b64_tr_b16 v[50:51], v8 offset:10752
v_mfma_f32_16x16x32_bf16 v[172:175], v[56:59], v[44:47], v[172:175]
s_waitcnt lgkmcnt(2)
v_mfma_f32_16x16x32_bf16 v[188:191], v[60:63], v[44:47], v[188:191]
ds_read_b64_tr_b16 v[52:53], v8 offset:11264
v_mfma_f32_16x16x32_bf16 v[184:187], v[60:63], v[40:43], v[184:187]
ds_read_b64_tr_b16 v[54:55], v8 offset:11776
v_mfma_f32_16x16x32_bf16 v[180:183], v[60:63], v[36:39], v[180:183]
ds_read_b128 v[16:19], v10 offset:20480
v_mfma_f32_16x16x32_bf16 v[176:179], v[60:63], v[32:35], v[176:179]
s_waitcnt lgkmcnt(3)
v_mfma_f32_16x16x32_bf16 v[192:195], v[48:51], v[32:35], v[192:195]
ds_read_b64_tr_b16 v[56:57], v9 offset:10240
v_mfma_f32_16x16x32_bf16 v[196:199], v[48:51], v[36:39], v[196:199]
ds_read_b64_tr_b16 v[58:59], v9 offset:10752
v_mfma_f32_16x16x32_bf16 v[200:203], v[48:51], v[40:43], v[200:203]
ds_read_b128 v[20:23], v10 offset:25600
v_mfma_f32_16x16x32_bf16 v[204:207], v[48:51], v[44:47], v[204:207]
s_waitcnt lgkmcnt(4)
v_mfma_f32_16x16x32_bf16 v[220:223], v[52:55], v[44:47], v[220:223]
ds_read_b64_tr_b16 v[60:61], v9 offset:11264
v_mfma_f32_16x16x32_bf16 v[216:219], v[52:55], v[40:43], v[216:219]
ds_read_b64_tr_b16 v[62:63], v9 offset:11776
v_mfma_f32_16x16x32_bf16 v[212:215], v[52:55], v[36:39], v[212:215]
ds_read_b128 v[24:27], v10 offset:21504
v_mfma_f32_16x16x32_bf16 v[208:211], v[52:55], v[32:35], v[208:211]
s_waitcnt lgkmcnt(4)
v_mfma_f32_16x16x32_bf16 v[224:227], v[56:59], v[32:35], v[224:227]
ds_read_b64_tr_b16 v[48:49], v8 offset:12288
v_mfma_f32_16x16x32_bf16 v[228:231], v[56:59], v[36:39], v[228:231]
ds_read_b64_tr_b16 v[50:51], v8 offset:12800
v_mfma_f32_16x16x32_bf16 v[232:235], v[56:59], v[40:43], v[232:235]
ds_read_b128 v[28:31], v10 offset:26624
v_mfma_f32_16x16x32_bf16 v[236:239], v[56:59], v[44:47], v[236:239]
s_waitcnt lgkmcnt(4)
v_mfma_f32_16x16x32_bf16 v[252:255], v[60:63], v[44:47], v[252:255]
ds_read_b64_tr_b16 v[52:53], v8 offset:13312
v_mfma_f32_16x16x32_bf16 v[248:251], v[60:63], v[40:43], v[248:251]
ds_read_b64_tr_b16 v[54:55], v8 offset:13824
v_mfma_f32_16x16x32_bf16 v[244:247], v[60:63], v[36:39], v[244:247]
v_mfma_f32_16x16x32_bf16 v[240:243], v[60:63], v[32:35], v[240:243]
s_sub_u32 s60, s60, 1
s_cmp_eq_u32 s60, 0
s_cbranch_scc1 L_outB
s_waitcnt lgkmcnt(2)
v_mfma_f32_16x16x32_bf16 v[64:67], v[48:51], v[16:19], v[64:67]
ds_read_b64_tr_b16 v[56:57], v9 offset:12288
v_mfma_f32_16x16x32_bf16 v[68:71], v[48:51], v[20:23], v[68:71]
ds_read_b64_tr_b16 v[58:59], v9 offset:12800
v_mfma_f32_16x16x32_bf16 v[72:75], v[48:51], v[24:27], v[72:75]
v_mfma_f32_16x16x32_bf16 v[76:79], v[48:51], v[28:31], v[76:79]
s_waitcnt lgkmcnt(2)
v_mfma_f32_16x16x32_bf16 v[92:95], v[52:55], v[28:31], v[92:95]
ds_read_b64_tr_b16 v[60:61], v9 offset:13312
v_mfma_f32_16x16x32_bf16 v[88:91], v[52:55], v[24:27], v[88:91]
ds_read_b64_tr_b16 v[62:63], v9 offset:13824
v_mfma_f32_16x16x32_bf16 v[84:87], v[52:55], v[20:23], v[84:87]
v_mfma_f32_16x16x32_bf16 v[80:83], v[52:55], v[16:19], v[80:83]
s_waitcnt lgkmcnt(2)
v_mfma_f32_16x16x32_bf16 v[96:99], v[56:59], v[16:19], v[96:99]
ds_read_b64_tr_b16 v[48:49], v8 offset:14336
v_mfma_f32_16x16x32_bf16 v[100:103], v[56:59], v[20:23], v[100:103]
ds_read_b64_tr_b16 v[50:51], v8 offset:14848
v_mfma_f32_16x16x32_bf16 v[104:107], v[56:59], v[24:27], v[104:107]
v_mfma_f32_16x16x32_bf16 v[108:111], v[56:59], v[28:31], v[108:111]
s_waitcnt lgkmcnt(2)
v_mfma_f32_16x16x32_bf16 v[124:127], v[60:63], v[28:31], v[124:127]
ds_read_b64_tr_b16 v[52:53], v8 offset:15360
v_mfma_f32_16x16x32_bf16 v[120:123], v[60:63], v[24:27], v[120:123]
ds_read_b64_tr_b16 v[54:55], v8 offset:15872
v_mfma_f32_16x16x32_bf16 v[116:119], v[60:63], v[20:23], v[116:119]
v_mfma_f32_16x16x32_bf16 v[112:115], v[60:63], v[16:19], v[112:115]
s_waitcnt lgkmcnt(2)
v_mfma_f32_16x16x32_bf16 v[128:131], v[48:51], v[16:19], v[128:131]
ds_read_b64_tr_b16 v[56:57], v9 offset:14336
v_mfma_f32_16x16x32_bf16 v[132:135], v[48:51], v[20:23], v[132:135]
ds_read_b64_tr_b16 v[58:59], v9 offset:14848
v_mfma_f32_16x16x32_bf16 v[136:139], v[48:51], v[24:27], v[136:139]
v_mfma_f32_16x16x32_bf16 v[140:143], v[48:51], v[28:31], v[140:143]
s_waitcnt lgkmcnt(2)
v_mfma_f32_16x16x32_bf16 v[156:159], v[52:55], v[28:31], v[156:159]
ds_read_b64_tr_b16 v[60:61], v9 offset:15360
v_mfma_f32_16x16x32_bf16 v[152:155], v[52:55], v[24:27], v[152:155]
ds_read_b64_tr_b16 v[62:63], v9 offset:15872
v_mfma_f32_16x16x32_bf16 v[148:151], v[52:55], v[20:23], v[148:151]
v_mfma_f32_16x16x32_bf16 v[144:147], v[52:55], v[16:19], v[144:147]
s_waitcnt lgkmcnt(2)
v_mfma_f32_16x16x32_bf16 v[160:163], v[56:59], v[16:19], v[160:163]
s_barrier
v_mfma_f32_16x16x32_bf16 v[164:167], v[56:59], v[20:23], v[164:167]
ds_read_b64_tr_b16 v[48:49], v8 offset:16384
v_mfma_f32_16x16x32_bf16 v[168:171], v[56:59], v[24:27], v[168:171]
ds_read_b64_tr_b16 v[50:51], v8 offset:16896
v_mfma_f32_16x16x32_bf16 v[172:175], v[56:59], v[28:31], v[172:175]
s_waitcnt lgkmcnt(2)
v_mfma_f32_16x16x32_bf16 v[188:191], v[60:63], v[28:31], v[188:191]
ds_read_b64_tr_b16 v[52:53], v8 offset:17408
v_mfma_f32_16x16x32_bf16 v[184:187], v[60:63], v[24:27], v[184:187]
ds_read_b64_tr_b16 v[54:55], v8 offset:17920
v_mfma_f32_16x16x32_bf16 v[180:183], v[60:63], v[20:23], v[180:183]
ds_read_b128 v[32:35], v11 offset:20480
v_mfma_f32_16x16x32_bf16 v[176:179], v[60:63], v[16:19], v[176:179]
s_waitcnt lgkmcnt(3)
v_mfma_f32_16x16x32_bf16 v[192:195], v[48:51], v[16:19], v[192:195]
ds_read_b64_tr_b16 v[56:57], v9 offset:16384
v_mfma_f32_16x16x32_bf16 v[196:199], v[48:51], v[20:23], v[196:199]
ds_read_b64_tr_b16 v[58:59], v9 offset:16896
v_mfma_f32_16x16x32_bf16 v[200:203], v[48:51], v[24:27], v[200:203]
ds_read_b128 v[36:39], v11 offset:25600
v_mfma_f32_16x16x32_bf16 v[204:207], v[48:51], v[28:31], v[204:207]
s_waitcnt lgkmcnt(4)
v_mfma_f32_16x16x32_bf16 v[220:223], v[52:55], v[28:31], v[220:223]
ds_read_b64_tr_b16 v[60:61], v9 offset:17408
v_mfma_f32_16x16x32_bf16 v[216:219], v[52:55], v[24:27], v[216:219]
ds_read_b64_tr_b16 v[62:63], v9 offset:17920
v_mfma_f32_16x16x32_bf16 v[212:215], v[52:55], v[20:23], v[212:215]
ds_read_b128 v[40:43], v11 offset:21504
v_mfma_f32_16x16x32_bf16 v[208:211], v[52:55], v[16:19], v[208:211]
s_waitcnt lgkmcnt(4)
v_mfma_f32_16x16x32_bf16 v[224:227], v[56:59], v[16:19], v[224:227]
ds_read_b64_tr_b16 v[48:49], v8 offset:18432
v_mfma_f32_16x16x32_bf16 v[228:231], v[56:59], v[20:23], v[228:231]
ds_read_b64_tr_b16 v[50:51], v8 offset:18944
v_mfma_f32_16x16x32_bf16 v[232:235], v[56:59], v[24:27], v[232:235]
ds_read_b128 v[44:47], v11 offset:26624
v_mfma_f32_16x16x32_bf16 v[236:239], v[56:59], v[28:31], v[236:239]
s_waitcnt lgkmcnt(4)
v_mfma_f32_16x16x32_bf16 v[252:255], v[60:63], v[28:31], v[252:255]
ds_read_b64_tr_b16 v[52:53], v8 offset:19456
v_mfma_f32_16x16x32_bf16 v[248:251], v[60:63], v[24:27], v[248:251]
ds_read_b64_tr_b16 v[54:55], v8 offset:19968
v_mfma_f32_16x16x32_bf16 v[244:247], v[60:63], v[20:23], v[244:247]
v_mfma_f32_16x16x32_bf16 v[240:243], v[60:63], v[16:19], v[240:243]
s_waitcnt lgkmcnt(2)
v_mfma_f32_16x16x32_bf16 v[64:67], v[48:51], v[32:35], v[64:67]
ds_read_b64_tr_b16 v[56:57], v9 offset:18432
v_mfma_f32_16x16x32_bf16 v[68:71], v[48:51], v[36:39], v[68:71]
ds_read_b64_tr_b16 v[58:59], v9 offset:18944
v_mfma_f32_16x16x32_bf16 v[72:75], v[48:51], v[40:43], v[72:75]
v_mfma_f32_16x16x32_bf16 v[76:79], v[48:51], v[44:47], v[76:79]
s_waitcnt lgkmcnt(2)
v_mfma_f32_16x16x32_bf16 v[92:95], v[52:55], v[44:47], v[92:95]
ds_read_b64_tr_b16 v[60:61], v9 offset:19456
v_mfma_f32_16x16x32_bf16 v[88:91], v[52:55], v[40:43], v[88:91]
ds_read_b64_tr_b16 v[62:63], v9 offset:19968
v_mfma_f32_16x16x32_bf16 v[84:87], v[52:55], v[36:39], v[84:87]
v_mfma_f32_16x16x32_bf16 v[80:83], v[52:55], v[32:35], v[80:83]
s_waitcnt lgkmcnt(2)
v_mfma_f32_16x16x32_bf16 v[96:99], v[56:59], v[32:35], v[96:99]
ds_read_b64_tr_b16 v[48:49], v8 offset:20480
v_mfma_f32_16x16x32_bf16 v[100:103], v[56:59], v[36:39], v[100:103]
ds_read_b64_tr_b16 v[50:51], v8 offset:20992
v_mfma_f32_16x16x32_bf16 v[104:107], v[56:59], v[40:43], v[104:107]
v_mfma_f32_16x16x32_bf16 v[108:111], v[56:59], v[44:47], v[108:111]
s_waitcnt lgkmcnt(2)
v_mfma_f32_16x16x32_bf16 v[124:127], v[60:63], v[44:47], v[124:127]
ds_read_b64_tr_b16 v[52:53], v8 offset:21504
v_mfma_f32_16x16x32_bf16 v[120:123], v[60:63], v[40:43], v[120:123]
ds_read_b64_tr_b16 v[54:55], v8 offset:22016
v_mfma_f32_16x16x32_bf16 v[116:119], v[60:63], v[36:39], v[116:119]
v_mfma_f32_16x16x32_bf16 v[112:115], v[60:63], v[32:35], v[112:115]
s_waitcnt lgkmcnt(2)
v_mfma_f32_16x16x32_bf16 v[128:131], v[48:51], v[32:35], v[128:131]
ds_read_b64_tr_b16 v[56:57], v9 offset:20480
v_mfma_f32_16x16x32_bf16 v[132:135], v[48:51], v[36:39], v[132:135]
ds_read_b64_tr_b16 v[58:59], v9 offset:20992
v_mfma_f32_16x16x32_bf16 v[136:139], v[48:51], v[40:43], v[136:139]
v_mfma_f32_16x16x32_bf16 v[140:143], v[48:51], v[44:47], v[140:143]
s_waitcnt lgkmcnt(2)
v_mfma_f32_16x16x32_bf16 v[156:159], v[52:55], v[44:47], v[156:159]
ds_read_b64_tr_b16 v[60:61], v9 offset:21504
v_mfma_f32_16x16x32_bf16 v[152:155], v[52:55], v[40:43], v[152:155]
ds_read_b64_tr_b16 v[62:63], v9 offset:22016
v_mfma_f32_16x16x32_bf16 v[148:151], v[52:55], v[36:39], v[148:151]
v_mfma_f32_16x16x32_bf16 v[144:147], v[52:55], v[32:35], v[144:147]
s_waitcnt lgkmcnt(2)
v_mfma_f32_16x16x32_bf16 v[160:163], v[56:59], v[32:35], v[160:163]
s_barrier
v_mfma_f32_16x16x32_bf16 v[164:167], v[56:59], v[36:39], v[164:167]
ds_read_b64_tr_b16 v[48:49], v8 offset:22528
v_mfma_f32_16x16x32_bf16 v[168:171], v[56:59], v[40:43], v[168:171]
ds_read_b64_tr_b16 v[50:51], v8 offset:23040
v_mfma_f32_16x16x32_bf16 v[172:175], v[56:59], v[44:47], v[172:175]
s_waitcnt lgkmcnt(2)
v_mfma_f32_16x16x32_bf16 v[188:191], v[60:63], v[44:47], v[188:191]
ds_read_b64_tr_b16 v[52:53], v8 offset:23552
v_mfma_f32_16x16x32_bf16 v[184:187], v[60:63], v[40:43], v[184:187]
ds_read_b64_tr_b16 v[54:55], v8 offset:24064
v_mfma_f32_16x16x32_bf16 v[180:183], v[60:63], v[36:39], v[180:183]
ds_read_b128 v[16:19], v10 offset:0
v_mfma_f32_16x16x32_bf16 v[176:179], v[60:63], v[32:35], v[176:179]
s_waitcnt lgkmcnt(3)
v_mfma_f32_16x16x32_bf16 v[192:195], v[48:51], v[32:35], v[192:195]
ds_read_b64_tr_b16 v[56:57], v9 offset:22528
v_mfma_f32_16x16x32_bf16 v[196:199], v[48:51], v[36:39], v[196:199]
ds_read_b64_tr_b16 v[58:59], v9 offset:23040
v_mfma_f32_16x16x32_bf16 v[200:203], v[48:51], v[40:43], v[200:203]
ds_read_b128 v[20:23], v10 offset:5120
v_mfma_f32_16x16x32_bf16 v[204:207], v[48:51], v[44:47], v[204:207]
s_waitcnt lgkmcnt(4)
v_mfma_f32_16x16x32_bf16 v[220:223], v[52:55], v[44:47], v[220:223]
ds_read_b64_tr_b16 v[60:61], v9 offset:23552
v_mfma_f32_16x16x32_bf16 v[216:219], v[52:55], v[40:43], v[216:219]
ds_read_b64_tr_b16 v[62:63], v9 offset:24064
v_mfma_f32_16x16x32_bf16 v[212:215], v[52:55], v[36:39], v[212:215]
ds_read_b128 v[24:27], v10 offset:1024
v_mfma_f32_16x16x32_bf16 v[208:211], v[52:55], v[32:35], v[208:211]
s_waitcnt lgkmcnt(4)
v_mfma_f32_16x16x32_bf16 v[224:227], v[56:59], v[32:35], v[224:227]
ds_read_b64_tr_b16 v[48:49], v8 offset:0
v_mfma_f32_16x16x32_bf16 v[228:231], v[56:59], v[36:39], v[228:231]
ds_read_b64_tr_b16 v[50:51], v8 offset:512
v_mfma_f32_16x16x32_bf16 v[232:235], v[56:59], v[40:43], v[232:235]
ds_read_b128 v[28:31], v10 offset:6144
v_mfma_f32_16x16x32_bf16 v[236:239], v[56:59], v[44:47], v[236:239]
s_waitcnt lgkmcnt(4)
v_mfma_f32_16x16x32_bf16 v[252:255], v[60:63], v[44:47], v[252:255]
ds_read_b64_tr_b16 v[52:53], v8 offset:1024
v_mfma_f32_16x16x32_bf16 v[248:251], v[60:63], v[40:43], v[248:251]
ds_read_b64_tr_b16 v[54:55], v8 offset:1536
v_mfma_f32_16x16x32_bf16 v[244:247], v[60:63], v[36:39], v[244:247]
v_mfma_f32_16x16x32_bf16 v[240:243], v[60:63], v[32:35], v[240:243]
s_branch L_loopB
.p2align 3
L_outB:
v_mov_b32 v1, 1
s_waitcnt lgkmcnt(2)
v_mfma_f32_16x16x32_bf16 v[64:67], v[48:51], v[16:19], v[64:67]
ds_read_b64_tr_b16 v[56:57], v9 offset:12288
v_mfma_f32_16x16x32_bf16 v[68:71], v[48:51], v[20:23], v[68:71]
ds_read_b64_tr_b16 v[58:59], v9 offset:12800
v_mfma_f32_16x16x32_bf16 v[72:75], v[48:51], v[24:27], v[72:75]
ds_read_b128 v[32:35], v11 offset:20480
v_mfma_f32_16x16x32_bf16 v[76:79], v[48:51], v[28:31], v[76:79]
ds_read_b128 v[36:39], v11 offset:25600
s_waitcnt lgkmcnt(4)
v_mfma_f32_16x16x32_bf16 v[80:83], v[52:55], v[16:19], v[80:83]
s_barrier
v_mfma_f32_16x16x32_bf16 v[84:87], v[52:55], v[20:23], v[84:87]
ds_read_b64_tr_b16 v[60:61], v9 offset:13312
v_mfma_f32_16x16x32_bf16 v[88:91], v[52:55], v[24:27], v[88:91]
ds_read_b64_tr_b16 v[62:63], v9 offset:13824
v_mfma_f32_16x16x32_bf16 v[92:95], v[52:55], v[28:31], v[92:95]
ds_read_b128 v[40:43], v11 offset:21504
s_waitcnt lgkmcnt(5)
v_mfma_f32_16x16x32_bf16 v[96:99], v[56:59], v[16:19], v[96:99]
ds_read_b64_tr_b16 v[48:49], v8 offset:18432
v_mfma_f32_16x16x32_bf16 v[100:103], v[56:59], v[20:23], v[100:103]
ds_read_b64_tr_b16 v[50:51], v8 offset:18944
v_mfma_f32_16x16x32_bf16 v[104:107], v[56:59], v[24:27], v[104:107]
ds_read_b128 v[44:47], v11 offset:26624
v_mfma_f32_16x16x32_bf16 v[108:111], v[56:59], v[28:31], v[108:111]
s_waitcnt lgkmcnt(4)
v_mfma_f32_16x16x32_bf16 v[112:115], v[60:63], v[16:19], v[112:115]
ds_read_b64_tr_b16 v[52:53], v8 offset:19456
v_mfma_f32_16x16x32_bf16 v[116:119], v[60:63], v[20:23], v[116:119]
ds_read_b64_tr_b16 v[54:55], v8 offset:19968
v_mfma_f32_16x16x32_bf16 v[120:123], v[60:63], v[24:27], v[120:123]
v_mfma_f32_16x16x32_bf16 v[124:127], v[60:63], v[28:31], v[124:127]
s_waitcnt lgkmcnt(2)
v_mfma_f32_16x16x32_bf16 v[64:67], v[48:51], v[32:35], v[64:67]
ds_read_b64_tr_b16 v[56:57], v9 offset:18432
v_mfma_f32_16x16x32_bf16 v[68:71], v[48:51], v[36:39], v[68:71]
ds_read_b64_tr_b16 v[58:59], v9 offset:18944
v_mfma_f32_16x16x32_bf16 v[72:75], v[48:51], v[40:43], v[72:75]
ds_read_b128 v[16:19], v13 offset:0
v_mfma_f32_16x16x32_bf16 v[76:79], v[48:51], v[44:47], v[76:79]
s_waitcnt lgkmcnt(3)
v_mfma_f32_16x16x32_bf16 v[80:83], v[52:55], v[32:35], v[80:83]
ds_read_b64_tr_b16 v[60:61], v9 offset:19456
v_mfma_f32_16x16x32_bf16 v[84:87], v[52:55], v[36:39], v[84:87]
ds_read_b64_tr_b16 v[62:63], v9 offset:19968
v_mfma_f32_16x16x32_bf16 v[88:91], v[52:55], v[40:43], v[88:91]
ds_read_b128 v[24:27], v13 offset:64
v_mfma_f32_16x16x32_bf16 v[92:95], v[52:55], v[44:47], v[92:95]
s_waitcnt lgkmcnt(4)
v_mfma_f32_16x16x32_bf16 v[96:99], v[56:59], v[32:35], v[96:99]
ds_read_b128 v[20:23], v13 offset:768
v_mfma_f32_16x16x32_bf16 v[100:103], v[56:59], v[36:39], v[100:103]
ds_read_b128 v[4:7], v12 offset:0
v_mfma_f32_16x16x32_bf16 v[104:107], v[56:59], v[40:43], v[104:107]
v_mfma_f32_16x16x32_bf16 v[108:111], v[56:59], v[44:47], v[108:111]
s_waitcnt lgkmcnt(3)
v_mfma_f32_16x16x32_bf16 v[112:115], v[60:63], v[32:35], v[112:115]
ds_read_b128 v[28:31], v13 offset:832
v_mfma_f32_16x16x32_bf16 v[116:119], v[60:63], v[36:39], v[116:119]
v_mfma_f32_16x16x32_bf16 v[120:123], v[60:63], v[40:43], v[120:123]
v_mfma_f32_16x16x32_bf16 v[124:127], v[60:63], v[44:47], v[124:127]
ds_read_b128 v[36:39], v12 offset:256
ds_read_b128 v[40:43], v12 offset:512
ds_read_b128 v[44:47], v12 offset:768
s_setprio 3
s_waitcnt lgkmcnt(3)
v_pk_fma_f32 v[64:65], v[4:5], v[16:17], v[64:65] op_sel_hi:[0,1,1]
v_pk_fma_f32 v[66:67], v[4:5], v[18:19], v[66:67] op_sel_hi:[0,1,1]
v_pk_fma_f32 v[96:97], v[4:5], v[24:25], v[96:97] op_sel_hi:[0,1,1]
v_pk_fma_f32 v[98:99], v[4:5], v[26:27], v[98:99] op_sel_hi:[0,1,1]
v_pk_fma_f32 v[80:81], v[4:5], v[20:21], v[80:81] op_sel_hi:[0,1,1]
v_pk_fma_f32 v[82:83], v[4:5], v[22:23], v[82:83] op_sel_hi:[0,1,1]
v_pk_fma_f32 v[112:113], v[4:5], v[28:29], v[112:113] op_sel_hi:[0,1,1]
v_pk_fma_f32 v[114:115], v[4:5], v[30:31], v[114:115] op_sel_hi:[0,1,1]
v_pk_mul_f32 v[48:49], v[64:65], v[64:65]
v_pk_mul_f32 v[50:51], v[66:67], v[66:67]
v_pk_mul_f32 v[52:53], v[96:97], v[96:97]
v_pk_mul_f32 v[54:55], v[98:99], v[98:99]
v_pk_fma_f32 v[48:49], v[6:7], v[48:49], v[4:5] op_sel:[0,0,1] op_sel_hi:[0,1,1]
v_pk_fma_f32 v[50:51], v[6:7], v[50:51], v[4:5] op_sel:[0,0,1] op_sel_hi:[0,1,1]
v_pk_fma_f32 v[52:53], v[6:7], v[52:53], v[4:5] op_sel:[0,0,1] op_sel_hi:[0,1,1]
v_pk_fma_f32 v[54:55], v[6:7], v[54:55], v[4:5] op_sel:[0,0,1] op_sel_hi:[0,1,1]
v_pk_mul_f32 v[48:49], v[48:49], v[64:65]
v_pk_mul_f32 v[50:51], v[50:51], v[66:67]
v_pk_mul_f32 v[52:53], v[52:53], v[96:97]
v_pk_mul_f32 v[54:55], v[54:55], v[98:99]
v_exp_f32 v48, v48
v_exp_f32 v49, v49
v_exp_f32 v50, v50
v_exp_f32 v51, v51
v_exp_f32 v52, v52
v_exp_f32 v53, v53
v_exp_f32 v54, v54
v_exp_f32 v55, v55
v_pk_fma_f32 v[48:49], v[6:7], v[48:49], v[6:7] op_sel:[1,0,1]
v_pk_fma_f32 v[50:51], v[6:7], v[50:51], v[6:7] op_sel:[1,0,1]
v_pk_fma_f32 v[52:53], v[6:7], v[52:53], v[6:7] op_sel:[1,0,1]
v_pk_fma_f32 v[54:55], v[6:7], v[54:55], v[6:7] op_sel:[1,0,1]
v_rcp_f32 v48, v48
v_rcp_f32 v49, v49
v_pk_mul_f32 v[80:81], v[80:81], v[64:65]
v_rcp_f32 v50, v50
v_rcp_f32 v51, v51
v_pk_mul_f32 v[82:83], v[82:83], v[66:67]
v_rcp_f32 v52, v52
v_rcp_f32 v53, v53
v_pk_mul_f32 v[112:113], v[112:113], v[96:97]
v_rcp_f32 v54, v54
v_rcp_f32 v55, v55
v_pk_mul_f32 v[114:115], v[114:115], v[98:99]
v_pk_mul_f32 v[80:81], v[80:81], v[48:49]
v_pk_mul_f32 v[82:83], v[82:83], v[50:51]
v_pk_mul_f32 v[112:113], v[112:113], v[52:53]
v_pk_mul_f32 v[114:115], v[114:115], v[54:55]
v_cvt_pk_bf16_f32 v64, v80, v81
v_cvt_pk_bf16_f32 v65, v82, v83
v_cvt_pk_bf16_f32 v66, v112, v113
v_cvt_pk_bf16_f32 v67, v114, v115
buffer_store_dwordx4 v[64:67], v14, s[20:23], s68 offen offset:0 sc1
s_waitcnt lgkmcnt(2)
ds_read_b64_tr_b16 v[80:81], v8 offset:14336
v_pk_fma_f32 v[68:69], v[36:37], v[16:17], v[68:69] op_sel_hi:[0,1,1]
v_pk_fma_f32 v[70:71], v[36:37], v[18:19], v[70:71] op_sel_hi:[0,1,1]
v_pk_fma_f32 v[100:101], v[36:37], v[24:25], v[100:101] op_sel_hi:[0,1,1]
v_pk_fma_f32 v[102:103], v[36:37], v[26:27], v[102:103] op_sel_hi:[0,1,1]
v_pk_fma_f32 v[84:85], v[36:37], v[20:21], v[84:85] op_sel_hi:[0,1,1]
v_pk_fma_f32 v[86:87], v[36:37], v[22:23], v[86:87] op_sel_hi:[0,1,1]
v_pk_fma_f32 v[116:117], v[36:37], v[28:29], v[116:117] op_sel_hi:[0,1,1]
v_pk_fma_f32 v[118:119], v[36:37], v[30:31], v[118:119] op_sel_hi:[0,1,1]
ds_read_b64_tr_b16 v[82:83], v8 offset:14848
v_pk_mul_f32 v[48:49], v[68:69], v[68:69]
v_pk_mul_f32 v[50:51], v[70:71], v[70:71]
v_pk_mul_f32 v[52:53], v[100:101], v[100:101]
v_pk_mul_f32 v[54:55], v[102:103], v[102:103]
v_pk_fma_f32 v[48:49], v[38:39], v[48:49], v[36:37] op_sel:[0,0,1] op_sel_hi:[0,1,1]
v_pk_fma_f32 v[50:51], v[38:39], v[50:51], v[36:37] op_sel:[0,0,1] op_sel_hi:[0,1,1]
v_pk_fma_f32 v[52:53], v[38:39], v[52:53], v[36:37] op_sel:[0,0,1] op_sel_hi:[0,1,1]
v_pk_fma_f32 v[54:55], v[38:39], v[54:55], v[36:37] op_sel:[0,0,1] op_sel_hi:[0,1,1]
v_pk_mul_f32 v[48:49], v[48:49], v[68:69]
v_pk_mul_f32 v[50:51], v[50:51], v[70:71]
v_pk_mul_f32 v[52:53], v[52:53], v[100:101]
v_pk_mul_f32 v[54:55], v[54:55], v[102:103]
v_exp_f32 v48, v48
v_exp_f32 v49, v49
v_exp_f32 v50, v50
v_exp_f32 v51, v51
ds_read_b64_tr_b16 v[96:97], v8 offset:15360
v_exp_f32 v52, v52
v_exp_f32 v53, v53
v_exp_f32 v54, v54
v_exp_f32 v55, v55
v_pk_fma_f32 v[48:49], v[38:39], v[48:49], v[38:39] op_sel:[1,0,1]
v_pk_fma_f32 v[50:51], v[38:39], v[50:51], v[38:39] op_sel:[1,0,1]
v_pk_fma_f32 v[52:53], v[38:39], v[52:53], v[38:39] op_sel:[1,0,1]
v_pk_fma_f32 v[54:55], v[38:39], v[54:55], v[38:39] op_sel:[1,0,1]
v_rcp_f32 v48, v48
v_rcp_f32 v49, v49
v_pk_mul_f32 v[84:85], v[84:85], v[68:69]
ds_read_b64_tr_b16 v[98:99], v8 offset:15872
v_rcp_f32 v50, v50
v_rcp_f32 v51, v51
v_pk_mul_f32 v[86:87], v[86:87], v[70:71]
v_rcp_f32 v52, v52
v_rcp_f32 v53, v53
v_pk_mul_f32 v[116:117], v[116:117], v[100:101]
ds_read_b128 v[112:115], v10 offset:20480
v_rcp_f32 v54, v54
v_rcp_f32 v55, v55
v_pk_mul_f32 v[118:119], v[118:119], v[102:103]
v_pk_mul_f32 v[84:85], v[84:85], v[48:49]
v_pk_mul_f32 v[86:87], v[86:87], v[50:51]
v_pk_mul_f32 v[116:117], v[116:117], v[52:53]
v_pk_mul_f32 v[118:119], v[118:119], v[54:55]
v_cvt_pk_bf16_f32 v68, v84, v85
v_cvt_pk_bf16_f32 v69, v86, v87
v_cvt_pk_bf16_f32 v70, v116, v117
v_cvt_pk_bf16_f32 v71, v118, v119
buffer_store_dwordx4 v[68:71], v14, s[20:23], s68 offen offset:1024 sc1
s_waitcnt lgkmcnt(6)
ds_read_b128 v[84:87], v10 offset:25600
v_pk_fma_f32 v[72:73], v[40:41], v[16:17], v[72:73] op_sel_hi:[0,1,1]
v_pk_fma_f32 v[74:75], v[40:41], v[18:19], v[74:75] op_sel_hi:[0,1,1]
v_pk_fma_f32 v[104:105], v[40:41], v[24:25], v[104:105] op_sel_hi:[0,1,1]
v_pk_fma_f32 v[106:107], v[40:41], v[26:27], v[106:107] op_sel_hi:[0,1,1]
v_pk_fma_f32 v[88:89], v[40:41], v[20:21], v[88:89] op_sel_hi:[0,1,1]
v_pk_fma_f32 v[90:91], v[40:41], v[22:23], v[90:91] op_sel_hi:[0,1,1]
v_pk_fma_f32 v[120:121], v[40:41], v[28:29], v[120:121] op_sel_hi:[0,1,1]
v_pk_fma_f32 v[122:123], v[40:41], v[30:31], v[122:123] op_sel_hi:[0,1,1]
v_pk_mul_f32 v[48:49], v[72:73], v[72:73]
v_pk_mul_f32 v[50:51], v[74:75], v[74:75]
v_pk_mul_f32 v[52:53], v[104:105], v[104:105]
v_pk_mul_f32 v[54:55], v[106:107], v[106:107]
v_pk_fma_f32 v[48:49], v[42:43], v[48:49], v[40:41] op_sel:[0,0,1] op_sel_hi:[0,1,1]
v_pk_fma_f32 v[50:51], v[42:43], v[50:51], v[40:41] op_sel:[0,0,1] op_sel_hi:[0,1,1]
v_pk_fma_f32 v[52:53], v[42:43], v[52:53], v[40:41] op_sel:[0,0,1] op_sel_hi:[0,1,1]
v_pk_fma_f32 v[54:55], v[42:43], v[54:55], v[40:41] op_sel:[0,0,1] op_sel_hi:[0,1,1]
v_pk_mul_f32 v[48:49], v[48:49], v[72:73]
v_pk_mul_f32 v[50:51], v[50:51], v[74:75]
v_pk_mul_f32 v[52:53], v[52:53], v[104:105]
v_pk_mul_f32 v[54:55], v[54:55], v[106:107]
v_exp_f32 v48, v48
v_exp_f32 v49, v49
v_exp_f32 v50, v50
v_exp_f32 v51, v51
ds_read_b128 v[100:103], v10 offset:21504
v_exp_f32 v52, v52
v_exp_f32 v53, v53
v_exp_f32 v54, v54
v_exp_f32 v55, v55
v_pk_fma_f32 v[48:49], v[42:43], v[48:49], v[42:43] op_sel:[1,0,1]
v_pk_fma_f32 v[50:51], v[42:43], v[50:51], v[42:43] op_sel:[1,0,1]
v_pk_fma_f32 v[52:53], v[42:43], v[52:53], v[42:43] op_sel:[1,0,1]
v_pk_fma_f32 v[54:55], v[42:43], v[54:55], v[42:43] op_sel:[1,0,1]
v_rcp_f32 v48, v48
v_rcp_f32 v49, v49
v_pk_mul_f32 v[88:89], v[88:89], v[72:73]
v_rcp_f32 v50, v50
v_rcp_f32 v51, v51
v_pk_mul_f32 v[90:91], v[90:91], v[74:75]
ds_read_b128 v[116:119], v10 offset:26624
v_rcp_f32 v52, v52
v_rcp_f32 v53, v53
v_pk_mul_f32 v[120:121], v[120:121], v[104:105]
v_rcp_f32 v54, v54
v_rcp_f32 v55, v55
v_pk_mul_f32 v[122:123], v[122:123], v[106:107]
v_pk_mul_f32 v[88:89], v[88:89], v[48:49]
v_pk_mul_f32 v[90:91], v[90:91], v[50:51]
v_pk_mul_f32 v[120:121], v[120:121], v[52:53]
v_pk_mul_f32 v[122:123], v[122:123], v[54:55]
v_cvt_pk_bf16_f32 v72, v88, v89
v_cvt_pk_bf16_f32 v73, v90, v91
v_cvt_pk_bf16_f32 v74, v120, v121
v_cvt_pk_bf16_f32 v75, v122, v123
buffer_store_dwordx4 v[72:75], v14, s[20:23], s68 offen offset:2048 sc1
s_waitcnt lgkmcnt(8)
v_pk_fma_f32 v[76:77], v[44:45], v[16:17], v[76:77] op_sel_hi:[0,1,1]
v_pk_fma_f32 v[78:79], v[44:45], v[18:19], v[78:79] op_sel_hi:[0,1,1]
v_pk_fma_f32 v[108:109], v[44:45], v[24:25], v[108:109] op_sel_hi:[0,1,1]
v_pk_fma_f32 v[110:111], v[44:45], v[26:27], v[110:111] op_sel_hi:[0,1,1]
v_pk_fma_f32 v[92:93], v[44:45], v[20:21], v[92:93] op_sel_hi:[0,1,1]
v_pk_fma_f32 v[94:95], v[44:45], v[22:23], v[94:95] op_sel_hi:[0,1,1]
v_pk_fma_f32 v[124:125], v[44:45], v[28:29], v[124:125] op_sel_hi:[0,1,1]
v_pk_fma_f32 v[126:127], v[44:45], v[30:31], v[126:127] op_sel_hi:[0,1,1]
v_pk_mul_f32 v[48:49], v[76:77], v[76:77]
v_pk_mul_f32 v[50:51], v[78:79], v[78:79]
v_pk_mul_f32 v[52:53], v[108:109], v[108:109]
v_pk_mul_f32 v[54:55], v[110:111], v[110:111]
v_pk_fma_f32 v[48:49], v[46:47], v[48:49], v[44:45] op_sel:[0,0,1] op_sel_hi:[0,1,1]
v_pk_fma_f32 v[50:51], v[46:47], v[50:51], v[44:45] op_sel:[0,0,1] op_sel_hi:[0,1,1]
v_pk_fma_f32 v[52:53], v[46:47], v[52:53], v[44:45] op_sel:[0,0,1] op_sel_hi:[0,1,1]
v_pk_fma_f32 v[54:55], v[46:47], v[54:55], v[44:45] op_sel:[0,0,1] op_sel_hi:[0,1,1]
v_pk_mul_f32 v[48:49], v[48:49], v[76:77]
v_pk_mul_f32 v[50:51], v[50:51], v[78:79]
v_pk_mul_f32 v[52:53], v[52:53], v[108:109]
v_pk_mul_f32 v[54:55], v[54:55], v[110:111]
v_exp_f32 v48, v48
v_exp_f32 v49, v49
v_exp_f32 v50, v50
v_exp_f32 v51, v51
v_exp_f32 v52, v52
v_exp_f32 v53, v53
v_exp_f32 v54, v54
v_exp_f32 v55, v55
v_pk_fma_f32 v[48:49], v[46:47], v[48:49], v[46:47] op_sel:[1,0,1]
v_pk_fma_f32 v[50:51], v[46:47], v[50:51], v[46:47] op_sel:[1,0,1]
v_pk_fma_f32 v[52:53], v[46:47], v[52:53], v[46:47] op_sel:[1,0,1]
v_pk_fma_f32 v[54:55], v[46:47], v[54:55], v[46:47] op_sel:[1,0,1]
v_rcp_f32 v48, v48
v_rcp_f32 v49, v49
v_pk_mul_f32 v[92:93], v[92:93], v[76:77]
v_rcp_f32 v50, v50
v_rcp_f32 v51, v51
v_pk_mul_f32 v[94:95], v[94:95], v[78:79]
v_rcp_f32 v52, v52
v_rcp_f32 v53, v53
v_pk_mul_f32 v[124:125], v[124:125], v[108:109]
v_rcp_f32 v54, v54
v_rcp_f32 v55, v55
v_pk_mul_f32 v[126:127], v[126:127], v[110:111]
v_pk_mul_f32 v[92:93], v[92:93], v[48:49]
v_pk_mul_f32 v[94:95], v[94:95], v[50:51]
v_pk_mul_f32 v[124:125], v[124:125], v[52:53]
v_pk_mul_f32 v[126:127], v[126:127], v[54:55]
v_cvt_pk_bf16_f32 v76, v92, v93
v_cvt_pk_bf16_f32 v77, v94, v95
v_cvt_pk_bf16_f32 v78, v124, v125
v_cvt_pk_bf16_f32 v79, v126, v127
buffer_store_dwordx4 v[76:79], v14, s[20:23], s68 offen offset:3072 sc1
s_waitcnt lgkmcnt(0)
v_mfma_f32_16x16x32_bf16 v[128:131], v[80:83], v[112:115], v[128:131]
ds_read_b64_tr_b16 v[88:89], v9 offset:14336
v_mfma_f32_16x16x32_bf16 v[132:135], v[80:83], v[84:87], v[132:135]
ds_read_b64_tr_b16 v[90:91], v9 offset:14848
v_mfma_f32_16x16x32_bf16 v[136:139], v[80:83], v[100:103], v[136:139]
ds_read_b128 v[120:123], v11 offset:20480
v_mfma_f32_16x16x32_bf16 v[140:143], v[80:83], v[116:119], v[140:143]
ds_read_b128 v[92:95], v11 offset:25600
v_mfma_f32_16x16x32_bf16 v[144:147], v[96:99], v[112:115], v[144:147]
ds_read_b64_tr_b16 v[104:105], v9 offset:15360
v_mfma_f32_16x16x32_bf16 v[148:151], v[96:99], v[84:87], v[148:151]
ds_read_b64_tr_b16 v[106:107], v9 offset:15872
v_mfma_f32_16x16x32_bf16 v[152:155], v[96:99], v[100:103], v[152:155]
ds_read_b128 v[108:111], v11 offset:21504
v_mfma_f32_16x16x32_bf16 v[156:159], v[96:99], v[116:119], v[156:159]
s_waitcnt lgkmcnt(5)
v_mfma_f32_16x16x32_bf16 v[160:163], v[88:91], v[112:115], v[160:163]
ds_read_b64_tr_b16 v[80:81], v8 offset:20480
v_mfma_f32_16x16x32_bf16 v[164:167], v[88:91], v[84:87], v[164:167]
ds_read_b64_tr_b16 v[82:83], v8 offset:20992
v_mfma_f32_16x16x32_bf16 v[168:171], v[88:91], v[100:103], v[168:171]
ds_read_b128 v[124:127], v11 offset:26624
v_mfma_f32_16x16x32_bf16 v[172:175], v[88:91], v[116:119], v[172:175]
s_waitcnt lgkmcnt(4)
v_mfma_f32_16x16x32_bf16 v[176:179], v[104:107], v[112:115], v[176:179]
ds_read_b64_tr_b16 v[96:97], v8 offset:21504
v_mfma_f32_16x16x32_bf16 v[180:183], v[104:107], v[84:87], v[180:183]
ds_read_b64_tr_b16 v[98:99], v8 offset:22016
v_mfma_f32_16x16x32_bf16 v[184:187], v[104:107], v[100:103], v[184:187]
v_mfma_f32_16x16x32_bf16 v[188:191], v[104:107], v[116:119], v[188:191]
s_waitcnt lgkmcnt(2)
v_mfma_f32_16x16x32_bf16 v[128:131], v[80:83], v[120:123], v[128:131]
ds_read_b64_tr_b16 v[88:89], v9 offset:20480
v_mfma_f32_16x16x32_bf16 v[132:135], v[80:83], v[92:95], v[132:135]
ds_read_b64_tr_b16 v[90:91], v9 offset:20992
v_mfma_f32_16x16x32_bf16 v[136:139], v[80:83], v[108:111], v[136:139]
ds_read_b128 v[16:19], v13 offset:256
v_mfma_f32_16x16x32_bf16 v[140:143], v[80:83], v[124:127], v[140:143]
s_waitcnt lgkmcnt(3)
v_mfma_f32_16x16x32_bf16 v[144:147], v[96:99], v[120:123], v[144:147]
s_barrier
v_mfma_f32_16x16x32_bf16 v[148:151], v[96:99], v[92:95], v[148:151]
ds_read_b64_tr_b16 v[104:105], v9 offset:21504
v_mfma_f32_16x16x32_bf16 v[152:155], v[96:99], v[108:111], v[152:155]
ds_read_b64_tr_b16 v[106:107], v9 offset:22016
v_mfma_f32_16x16x32_bf16 v[156:159], v[96:99], v[124:127], v[156:159]
ds_read_b128 v[24:27], v13 offset:320
s_waitcnt lgkmcnt(4)
v_mfma_f32_16x16x32_bf16 v[160:163], v[88:91], v[120:123], v[160:163]
ds_read_b128 v[20:23], v13 offset:1024
v_mfma_f32_16x16x32_bf16 v[164:167], v[88:91], v[92:95], v[164:167]
v_mfma_f32_16x16x32_bf16 v[168:171], v[88:91], v[108:111], v[168:171]
v_mfma_f32_16x16x32_bf16 v[172:175], v[88:91], v[124:127], v[172:175]
s_waitcnt lgkmcnt(2)
v_mfma_f32_16x16x32_bf16 v[176:179], v[104:107], v[120:123], v[176:179]
ds_read_b128 v[28:31], v13 offset:1088
v_mfma_f32_16x16x32_bf16 v[180:183], v[104:107], v[92:95], v[180:183]
v_mfma_f32_16x16x32_bf16 v[184:187], v[104:107], v[108:111], v[184:187]
v_mfma_f32_16x16x32_bf16 v[188:191], v[104:107], v[124:127], v[188:191]
s_waitcnt lgkmcnt(0)
v_pk_fma_f32 v[128:129], v[4:5], v[16:17], v[128:129] op_sel_hi:[0,1,1]
v_pk_fma_f32 v[130:131], v[4:5], v[18:19], v[130:131] op_sel_hi:[0,1,1]
v_pk_fma_f32 v[160:161], v[4:5], v[24:25], v[160:161] op_sel_hi:[0,1,1]
v_pk_fma_f32 v[162:163], v[4:5], v[26:27], v[162:163] op_sel_hi:[0,1,1]
v_pk_fma_f32 v[144:145], v[4:5], v[20:21], v[144:145] op_sel_hi:[0,1,1]
v_pk_fma_f32 v[146:147], v[4:5], v[22:23], v[146:147] op_sel_hi:[0,1,1]
v_pk_fma_f32 v[176:177], v[4:5], v[28:29], v[176:177] op_sel_hi:[0,1,1]
v_pk_fma_f32 v[178:179], v[4:5], v[30:31], v[178:179] op_sel_hi:[0,1,1]
v_pk_mul_f32 v[48:49], v[128:129], v[128:129]
v_pk_mul_f32 v[50:51], v[130:131], v[130:131]
v_pk_mul_f32 v[52:53], v[160:161], v[160:161]
v_pk_mul_f32 v[54:55], v[162:163], v[162:163]
v_pk_fma_f32 v[48:49], v[6:7], v[48:49], v[4:5] op_sel:[0,0,1] op_sel_hi:[0,1,1]
v_pk_fma_f32 v[50:51], v[6:7], v[50:51], v[4:5] op_sel:[0,0,1] op_sel_hi:[0,1,1]
v_pk_fma_f32 v[52:53], v[6:7], v[52:53], v[4:5] op_sel:[0,0,1] op_sel_hi:[0,1,1]
v_pk_fma_f32 v[54:55], v[6:7], v[54:55], v[4:5] op_sel:[0,0,1] op_sel_hi:[0,1,1]
v_pk_mul_f32 v[48:49], v[48:49], v[128:129]
v_pk_mul_f32 v[50:51], v[50:51], v[130:131]
v_pk_mul_f32 v[52:53], v[52:53], v[160:161]
v_pk_mul_f32 v[54:55], v[54:55], v[162:163]
v_exp_f32 v48, v48
v_exp_f32 v49, v49
v_exp_f32 v50, v50
v_exp_f32 v51, v51
v_exp_f32 v52, v52
v_exp_f32 v53, v53
v_exp_f32 v54, v54
v_exp_f32 v55, v55
v_pk_fma_f32 v[48:49], v[6:7], v[48:49], v[6:7] op_sel:[1,0,1]
v_pk_fma_f32 v[50:51], v[6:7], v[50:51], v[6:7] op_sel:[1,0,1]
v_pk_fma_f32 v[52:53], v[6:7], v[52:53], v[6:7] op_sel:[1,0,1]
v_pk_fma_f32 v[54:55], v[6:7], v[54:55], v[6:7] op_sel:[1,0,1]
v_rcp_f32 v48, v48
v_rcp_f32 v49, v49
v_pk_mul_f32 v[144:145], v[144:145], v[128:129]
v_rcp_f32 v50, v50
v_rcp_f32 v51, v51
v_pk_mul_f32 v[146:147], v[146:147], v[130:131]
v_rcp_f32 v52, v52
v_rcp_f32 v53, v53
v_pk_mul_f32 v[176:177], v[176:177], v[160:161]
v_rcp_f32 v54, v54
v_rcp_f32 v55, v55
v_pk_mul_f32 v[178:179], v[178:179], v[162:163]
v_pk_mul_f32 v[144:145], v[144:145], v[48:49]
v_pk_mul_f32 v[146:147], v[146:147], v[50:51]
v_pk_mul_f32 v[176:177], v[176:177], v[52:53]
v_pk_mul_f32 v[178:179], v[178:179], v[54:55]
v_cvt_pk_bf16_f32 v128, v144, v145
v_cvt_pk_bf16_f32 v129, v146, v147
v_cvt_pk_bf16_f32 v130, v176, v177
v_cvt_pk_bf16_f32 v131, v178, v179
buffer_store_dwordx4 v[128:131], v14, s[20:23], s69 offen offset:0 sc1
s_waitcnt vmcnt(1)
s_atomic_add s5, s[54:55], s71
v_pk_fma_f32 v[132:133], v[36:37], v[16:17], v[132:133] op_sel_hi:[0,1,1]
v_pk_fma_f32 v[134:135], v[36:37], v[18:19], v[134:135] op_sel_hi:[0,1,1]
v_pk_fma_f32 v[164:165], v[36:37], v[24:25], v[164:165] op_sel_hi:[0,1,1]
v_pk_fma_f32 v[166:167], v[36:37], v[26:27], v[166:167] op_sel_hi:[0,1,1]
v_pk_fma_f32 v[148:149], v[36:37], v[20:21], v[148:149] op_sel_hi:[0,1,1]
v_pk_fma_f32 v[150:151], v[36:37], v[22:23], v[150:151] op_sel_hi:[0,1,1]
v_pk_fma_f32 v[180:181], v[36:37], v[28:29], v[180:181] op_sel_hi:[0,1,1]
v_pk_fma_f32 v[182:183], v[36:37], v[30:31], v[182:183] op_sel_hi:[0,1,1]
v_pk_mul_f32 v[48:49], v[132:133], v[132:133]
v_pk_mul_f32 v[50:51], v[134:135], v[134:135]
v_pk_mul_f32 v[52:53], v[164:165], v[164:165]
v_pk_mul_f32 v[54:55], v[166:167], v[166:167]
v_pk_fma_f32 v[48:49], v[38:39], v[48:49], v[36:37] op_sel:[0,0,1] op_sel_hi:[0,1,1]
v_pk_fma_f32 v[50:51], v[38:39], v[50:51], v[36:37] op_sel:[0,0,1] op_sel_hi:[0,1,1]
v_pk_fma_f32 v[52:53], v[38:39], v[52:53], v[36:37] op_sel:[0,0,1] op_sel_hi:[0,1,1]
v_pk_fma_f32 v[54:55], v[38:39], v[54:55], v[36:37] op_sel:[0,0,1] op_sel_hi:[0,1,1]
v_pk_mul_f32 v[48:49], v[48:49], v[132:133]
v_pk_mul_f32 v[50:51], v[50:51], v[134:135]
v_pk_mul_f32 v[52:53], v[52:53], v[164:165]
v_pk_mul_f32 v[54:55], v[54:55], v[166:167]
v_exp_f32 v48, v48
v_exp_f32 v49, v49
v_exp_f32 v50, v50
v_exp_f32 v51, v51
v_exp_f32 v52, v52
v_exp_f32 v53, v53
v_exp_f32 v54, v54
v_exp_f32 v55, v55
v_pk_fma_f32 v[48:49], v[38:39], v[48:49], v[38:39] op_sel:[1,0,1]
v_pk_fma_f32 v[50:51], v[38:39], v[50:51], v[38:39] op_sel:[1,0,1]
v_pk_fma_f32 v[52:53], v[38:39], v[52:53], v[38:39] op_sel:[1,0,1]
v_pk_fma_f32 v[54:55], v[38:39], v[54:55], v[38:39] op_sel:[1,0,1]
v_rcp_f32 v48, v48
v_rcp_f32 v49, v49
v_pk_mul_f32 v[148:149], v[148:149], v[132:133]
v_rcp_f32 v50, v50
v_rcp_f32 v51, v51
v_pk_mul_f32 v[150:151], v[150:151], v[134:135]
v_rcp_f32 v52, v52
v_rcp_f32 v53, v53
v_pk_mul_f32 v[180:181], v[180:181], v[164:165]
v_rcp_f32 v54, v54
v_rcp_f32 v55, v55
v_pk_mul_f32 v[182:183], v[182:183], v[166:167]
v_pk_mul_f32 v[148:149], v[148:149], v[48:49]
v_pk_mul_f32 v[150:151], v[150:151], v[50:51]
v_pk_mul_f32 v[180:181], v[180:181], v[52:53]
v_pk_mul_f32 v[182:183], v[182:183], v[54:55]
v_cvt_pk_bf16_f32 v132, v148, v149
v_cvt_pk_bf16_f32 v133, v150, v151
v_cvt_pk_bf16_f32 v134, v180, v181
v_cvt_pk_bf16_f32 v135, v182, v183
buffer_store_dwordx4 v[132:135], v14, s[20:23], s69 offen offset:1024 sc1
ds_read_b64_tr_b16 v[80:81], v8 offset:16384
v_pk_fma_f32 v[136:137], v[40:41], v[16:17], v[136:137] op_sel_hi:[0,1,1]
v_pk_fma_f32 v[138:139], v[40:41], v[18:19], v[138:139] op_sel_hi:[0,1,1]
v_pk_fma_f32 v[168:169], v[40:41], v[24:25], v[168:169] op_sel_hi:[0,1,1]
v_pk_fma_f32 v[170:171], v[40:41], v[26:27], v[170:171] op_sel_hi:[0,1,1]
v_pk_fma_f32 v[152:153], v[40:41], v[20:21], v[152:153] op_sel_hi:[0,1,1]
v_pk_fma_f32 v[154:155], v[40:41], v[22:23], v[154:155] op_sel_hi:[0,1,1]
v_pk_fma_f32 v[184:185], v[40:41], v[28:29], v[184:185] op_sel_hi:[0,1,1]
v_pk_fma_f32 v[186:187], v[40:41], v[30:31], v[186:187] op_sel_hi:[0,1,1]
v_pk_mul_f32 v[48:49], v[136:137], v[136:137]
v_pk_mul_f32 v[50:51], v[138:139], v[138:139]
v_pk_mul_f32 v[52:53], v[168:169], v[168:169]
v_pk_mul_f32 v[54:55], v[170:171], v[170:171]
v_pk_fma_f32 v[48:49], v[42:43], v[48:49], v[40:41] op_sel:[0,0,1] op_sel_hi:[0,1,1]
v_pk_fma_f32 v[50:51], v[42:43], v[50:51], v[40:41] op_sel:[0,0,1] op_sel_hi:[0,1,1]
v_pk_fma_f32 v[52:53], v[42:43], v[52:53], v[40:41] op_sel:[0,0,1] op_sel_hi:[0,1,1]
v_pk_fma_f32 v[54:55], v[42:43], v[54:55], v[40:41] op_sel:[0,0,1] op_sel_hi:[0,1,1]
ds_read_b64_tr_b16 v[82:83], v8 offset:16896
v_pk_mul_f32 v[48:49], v[48:49], v[136:137]
v_pk_mul_f32 v[50:51], v[50:51], v[138:139]
v_pk_mul_f32 v[52:53], v[52:53], v[168:169]
v_pk_mul_f32 v[54:55], v[54:55], v[170:171]
v_exp_f32 v48, v48
v_exp_f32 v49, v49
v_exp_f32 v50, v50
v_exp_f32 v51, v51
v_exp_f32 v52, v52
v_exp_f32 v53, v53
v_exp_f32 v54, v54
v_exp_f32 v55, v55
ds_read_b64_tr_b16 v[96:97], v8 offset:17408
v_pk_fma_f32 v[48:49], v[42:43], v[48:49], v[42:43] op_sel:[1,0,1]
v_pk_fma_f32 v[50:51], v[42:43], v[50:51], v[42:43] op_sel:[1,0,1]
v_pk_fma_f32 v[52:53], v[42:43], v[52:53], v[42:43] op_sel:[1,0,1]
v_pk_fma_f32 v[54:55], v[42:43], v[54:55], v[42:43] op_sel:[1,0,1]
v_rcp_f32 v48, v48
v_rcp_f32 v49, v49
v_pk_mul_f32 v[152:153], v[152:153], v[136:137]
v_rcp_f32 v50, v50
v_rcp_f32 v51, v51
v_pk_mul_f32 v[154:155], v[154:155], v[138:139]
ds_read_b64_tr_b16 v[98:99], v8 offset:17920
v_rcp_f32 v52, v52
v_rcp_f32 v53, v53
v_pk_mul_f32 v[184:185], v[184:185], v[168:169]
v_rcp_f32 v54, v54
v_rcp_f32 v55, v55
v_pk_mul_f32 v[186:187], v[186:187], v[170:171]
v_pk_mul_f32 v[152:153], v[152:153], v[48:49]
v_pk_mul_f32 v[154:155], v[154:155], v[50:51]
v_pk_mul_f32 v[184:185], v[184:185], v[52:53]
v_pk_mul_f32 v[186:187], v[186:187], v[54:55]
v_cvt_pk_bf16_f32 v136, v152, v153
v_cvt_pk_bf16_f32 v137, v154, v155
v_cvt_pk_bf16_f32 v138, v184, v185
v_cvt_pk_bf16_f32 v139, v186, v187
buffer_store_dwordx4 v[136:139], v14, s[20:23], s69 offen offset:2048 sc1
v_and_b32 v2, 1, v0
v_lshlrev_b32 v2, 2, v2
v_add_u32 v2, 146688, v2
v_pk_fma_f32 v[140:141], v[44:45], v[16:17], v[140:141] op_sel_hi:[0,1,1]
v_pk_fma_f32 v[142:143], v[44:45], v[18:19], v[142:143] op_sel_hi:[0,1,1]
v_pk_fma_f32 v[172:173], v[44:45], v[24:25], v[172:173] op_sel_hi:[0,1,1]
v_pk_fma_f32 v[174:175], v[44:45], v[26:27], v[174:175] op_sel_hi:[0,1,1]
v_pk_fma_f32 v[156:157], v[44:45], v[20:21], v[156:157] op_sel_hi:[0,1,1]
v_pk_fma_f32 v[158:159], v[44:45], v[22:23], v[158:159] op_sel_hi:[0,1,1]
v_pk_fma_f32 v[188:189], v[44:45], v[28:29], v[188:189] op_sel_hi:[0,1,1]
v_pk_fma_f32 v[190:191], v[44:45], v[30:31], v[190:191] op_sel_hi:[0,1,1]
v_pk_mul_f32 v[48:49], v[140:141], v[140:141]
v_pk_mul_f32 v[50:51], v[142:143], v[142:143]
v_pk_mul_f32 v[52:53], v[172:173], v[172:173]
v_pk_mul_f32 v[54:55], v[174:175], v[174:175]
v_pk_fma_f32 v[48:49], v[46:47], v[48:49], v[44:45] op_sel:[0,0,1] op_sel_hi:[0,1,1]
v_pk_fma_f32 v[50:51], v[46:47], v[50:51], v[44:45] op_sel:[0,0,1] op_sel_hi:[0,1,1]
v_pk_fma_f32 v[52:53], v[46:47], v[52:53], v[44:45] op_sel:[0,0,1] op_sel_hi:[0,1,1]
v_pk_fma_f32 v[54:55], v[46:47], v[54:55], v[44:45] op_sel:[0,0,1] op_sel_hi:[0,1,1]
ds_read_b32 v3, v2
v_pk_mul_f32 v[48:49], v[48:49], v[140:141]
v_pk_mul_f32 v[50:51], v[50:51], v[142:143]
v_pk_mul_f32 v[52:53], v[52:53], v[172:173]
v_pk_mul_f32 v[54:55], v[54:55], v[174:175]
v_exp_f32 v48, v48
v_exp_f32 v49, v49
v_exp_f32 v50, v50
v_exp_f32 v51, v51
v_exp_f32 v52, v52
v_exp_f32 v53, v53
v_exp_f32 v54, v54
v_exp_f32 v55, v55
s_nop 0
v_pk_fma_f32 v[48:49], v[46:47], v[48:49], v[46:47] op_sel:[1,0,1]
v_pk_fma_f32 v[50:51], v[46:47], v[50:51], v[46:47] op_sel:[1,0,1]
v_pk_fma_f32 v[52:53], v[46:47], v[52:53], v[46:47] op_sel:[1,0,1]
v_pk_fma_f32 v[54:55], v[46:47], v[54:55], v[46:47] op_sel:[1,0,1]
v_rcp_f32 v48, v48
v_rcp_f32 v49, v49
v_pk_mul_f32 v[156:157], v[156:157], v[140:141]
v_rcp_f32 v50, v50
v_rcp_f32 v51, v51
v_pk_mul_f32 v[158:159], v[158:159], v[142:143]
s_nop 0
v_rcp_f32 v52, v52
v_rcp_f32 v53, v53
v_pk_mul_f32 v[188:189], v[188:189], v[172:173]
v_rcp_f32 v54, v54
v_rcp_f32 v55, v55
v_pk_mul_f32 v[190:191], v[190:191], v[174:175]
v_pk_mul_f32 v[156:157], v[156:157], v[48:49]
v_pk_mul_f32 v[158:159], v[158:159], v[50:51]
v_pk_mul_f32 v[188:189], v[188:189], v[52:53]
v_pk_mul_f32 v[190:191], v[190:191], v[54:55]
v_cvt_pk_bf16_f32 v140, v156, v157
v_cvt_pk_bf16_f32 v141, v158, v159
v_cvt_pk_bf16_f32 v142, v188, v189
v_cvt_pk_bf16_f32 v143, v190, v191
buffer_store_dwordx4 v[140:143], v14, s[20:23], s69 offen offset:3072 sc1
s_waitcnt lgkmcnt(0)
v_cmp_eq_u32 vcc, 0, v3
s_nop 0
s_cbranch_vccz L_ok49
s_mov_b32 s78, 400000
s_branch L_lc51
L_lp50:
s_sleep 1
L_lc51:
ds_read_b32 v3, v2
s_waitcnt lgkmcnt(0)
v_cmp_eq_u32 vcc, 0, v3
s_sub_u32 s78, s78, 1
s_cbranch_vccz L_lo52
s_cmp_lg_u32 s78, 0
s_cbranch_scc1 L_lp50
L_lo52:
L_ok49:
v_mfma_f32_16x16x32_bf16 v[192:195], v[80:83], v[112:115], v[192:195]
ds_read_b64_tr_b16 v[88:89], v9 offset:16384
v_mfma_f32_16x16x32_bf16 v[196:199], v[80:83], v[84:87], v[196:199]
ds_read_b64_tr_b16 v[90:91], v9 offset:16896
v_mfma_f32_16x16x32_bf16 v[200:203], v[80:83], v[100:103], v[200:203]
v_mfma_f32_16x16x32_bf16 v[204:207], v[80:83], v[116:119], v[204:207]
v_mfma_f32_16x16x32_bf16 v[208:211], v[96:99], v[112:115], v[208:211]
ds_read_b64_tr_b16 v[104:105], v9 offset:17408
v_mfma_f32_16x16x32_bf16 v[212:215], v[96:99], v[84:87], v[212:215]
ds_read_b64_tr_b16 v[106:107], v9 offset:17920
v_mfma_f32_16x16x32_bf16 v[216:219], v[96:99], v[100:103], v[216:219]
v_mfma_f32_16x16x32_bf16 v[220:223], v[96:99], v[116:119], v[220:223]
s_waitcnt lgkmcnt(2)
v_mfma_f32_16x16x32_bf16 v[224:227], v[88:91], v[112:115], v[224:227]
ds_read_b64_tr_b16 v[80:81], v8 offset:22528
v_mfma_f32_16x16x32_bf16 v[228:231], v[88:91], v[84:87], v[228:231]
ds_read_b64_tr_b16 v[82:83], v8 offset:23040
v_mfma_f32_16x16x32_bf16 v[232:235], v[88:91], v[100:103], v[232:235]
v_mfma_f32_16x16x32_bf16 v[236:239], v[88:91], v[116:119], v[236:239]
s_waitcnt lgkmcnt(2)
v_mfma_f32_16x16x32_bf16 v[240:243], v[104:107], v[112:115], v[240:243]
ds_read_b64_tr_b16 v[96:97], v8 offset:23552
v_mfma_f32_16x16x32_bf16 v[244:247], v[104:107], v[84:87], v[244:247]
ds_read_b64_tr_b16 v[98:99], v8 offset:24064
v_mfma_f32_16x16x32_bf16 v[248:251], v[104:107], v[100:103], v[248:251]
v_mfma_f32_16x16x32_bf16 v[252:255], v[104:107], v[116:119], v[252:255]
s_waitcnt lgkmcnt(2)
v_mfma_f32_16x16x32_bf16 v[192:195], v[80:83], v[120:123], v[192:195]
ds_read_b64_tr_b16 v[88:89], v9 offset:22528
v_mfma_f32_16x16x32_bf16 v[196:199], v[80:83], v[92:95], v[196:199]
ds_read_b64_tr_b16 v[90:91], v9 offset:23040
v_mfma_f32_16x16x32_bf16 v[200:203], v[80:83], v[108:111], v[200:203]
ds_read_b128 v[16:19], v13 offset:512
v_mfma_f32_16x16x32_bf16 v[204:207], v[80:83], v[124:127], v[204:207]
s_waitcnt lgkmcnt(3)
v_mfma_f32_16x16x32_bf16 v[208:211], v[96:99], v[120:123], v[208:211]
ds_read_b64_tr_b16 v[104:105], v9 offset:23552
v_mfma_f32_16x16x32_bf16 v[212:215], v[96:99], v[92:95], v[212:215]
ds_read_b64_tr_b16 v[106:107], v9 offset:24064
v_mfma_f32_16x16x32_bf16 v[216:219], v[96:99], v[108:111], v[216:219]
ds_read_b128 v[24:27], v13 offset:576
v_mfma_f32_16x16x32_bf16 v[220:223], v[96:99], v[124:127], v[220:223]
s_waitcnt lgkmcnt(4)
v_mfma_f32_16x16x32_bf16 v[224:227], v[88:91], v[120:123], v[224:227]
ds_read_b128 v[20:23], v13 offset:1280
v_mfma_f32_16x16x32_bf16 v[228:231], v[88:91], v[92:95], v[228:231]
v_mfma_f32_16x16x32_bf16 v[232:235], v[88:91], v[108:111], v[232:235]
v_mfma_f32_16x16x32_bf16 v[236:239], v[88:91], v[124:127], v[236:239]
s_waitcnt lgkmcnt(2)
v_mfma_f32_16x16x32_bf16 v[240:243], v[104:107], v[120:123], v[240:243]
s_barrier
v_mfma_f32_16x16x32_bf16 v[244:247], v[104:107], v[92:95], v[244:247]
ds_read_b128 v[28:31], v13 offset:1344
v_mfma_f32_16x16x32_bf16 v[248:251], v[104:107], v[108:111], v[248:251]
v_mfma_f32_16x16x32_bf16 v[252:255], v[104:107], v[124:127], v[252:255]
s_waitcnt lgkmcnt(0)
v_pk_fma_f32 v[192:193], v[4:5], v[16:17], v[192:193] op_sel_hi:[0,1,1]
v_pk_fma_f32 v[194:195], v[4:5], v[18:19], v[194:195] op_sel_hi:[0,1,1]
v_pk_fma_f32 v[224:225], v[4:5], v[24:25], v[224:225] op_sel_hi:[0,1,1]
v_pk_fma_f32 v[226:227], v[4:5], v[26:27], v[226:227] op_sel_hi:[0,1,1]
v_pk_fma_f32 v[208:209], v[4:5], v[20:21], v[208:209] op_sel_hi:[0,1,1]
v_pk_fma_f32 v[210:211], v[4:5], v[22:23], v[210:211] op_sel_hi:[0,1,1]
v_pk_fma_f32 v[240:241], v[4:5], v[28:29], v[240:241] op_sel_hi:[0,1,1]
v_pk_fma_f32 v[242:243], v[4:5], v[30:31], v[242:243] op_sel_hi:[0,1,1]
v_pk_mul_f32 v[48:49], v[192:193], v[192:193]
v_pk_mul_f32 v[50:51], v[194:195], v[194:195]
v_pk_mul_f32 v[52:53], v[224:225], v[224:225]
v_pk_mul_f32 v[54:55], v[226:227], v[226:227]
v_pk_fma_f32 v[48:49], v[6:7], v[48:49], v[4:5] op_sel:[0,0,1] op_sel_hi:[0,1,1]
v_pk_fma_f32 v[50:51], v[6:7], v[50:51], v[4:5] op_sel:[0,0,1] op_sel_hi:[0,1,1]
v_pk_fma_f32 v[52:53], v[6:7], v[52:53], v[4:5] op_sel:[0,0,1] op_sel_hi:[0,1,1]
v_pk_fma_f32 v[54:55], v[6:7], v[54:55], v[4:5] op_sel:[0,0,1] op_sel_hi:[0,1,1]
v_pk_mul_f32 v[48:49], v[48:49], v[192:193]
v_pk_mul_f32 v[50:51], v[50:51], v[194:195]
v_pk_mul_f32 v[52:53], v[52:53], v[224:225]
v_pk_mul_f32 v[54:55], v[54:55], v[226:227]
v_exp_f32 v48, v48
v_exp_f32 v49, v49
v_exp_f32 v50, v50
v_exp_f32 v51, v51
v_exp_f32 v52, v52
v_exp_f32 v53, v53
v_exp_f32 v54, v54
v_exp_f32 v55, v55
v_pk_fma_f32 v[48:49], v[6:7], v[48:49], v[6:7] op_sel:[1,0,1]
v_pk_fma_f32 v[50:51], v[6:7], v[50:51], v[6:7] op_sel:[1,0,1]
v_pk_fma_f32 v[52:53], v[6:7], v[52:53], v[6:7] op_sel:[1,0,1]
v_pk_fma_f32 v[54:55], v[6:7], v[54:55], v[6:7] op_sel:[1,0,1]
v_rcp_f32 v48, v48
v_rcp_f32 v49, v49
v_pk_mul_f32 v[208:209], v[208:209], v[192:193]
v_rcp_f32 v50, v50
v_rcp_f32 v51, v51
v_pk_mul_f32 v[210:211], v[210:211], v[194:195]
v_rcp_f32 v52, v52
v_rcp_f32 v53, v53
v_pk_mul_f32 v[240:241], v[240:241], v[224:225]
v_rcp_f32 v54, v54
v_rcp_f32 v55, v55
v_pk_mul_f32 v[242:243], v[242:243], v[226:227]
v_pk_mul_f32 v[208:209], v[208:209], v[48:49]
v_pk_mul_f32 v[210:211], v[210:211], v[50:51]
v_pk_mul_f32 v[240:241], v[240:241], v[52:53]
v_pk_mul_f32 v[242:243], v[242:243], v[54:55]
v_cvt_pk_bf16_f32 v192, v208, v209
v_cvt_pk_bf16_f32 v193, v210, v211
v_cvt_pk_bf16_f32 v194, v240, v241
v_cvt_pk_bf16_f32 v195, v242, v243
buffer_store_dwordx4 v[192:195], v14, s[20:23], s70 offen offset:0 sc1
s_waitcnt lgkmcnt(0)
s_waitcnt vmcnt(1)
s_atomic_add s6, s[54:55], s72
v_lshrrev_b32 v5, 4, v0
v_and_b32 v2, 15, v0
v_and_b32 v3, 7, v0
v_xor_b32 v3, v3, v5
v_lshlrev_b32 v4, 8, v2
v_lshl_add_u32 v4, v3, 4, v4
s_mul_i32 s61, s81, 24576
s_mov_b32 s60, s61
s_add_u32 s61, s61, 16384
v_add_u32 v13, s60, v4
v_xor_b32 v7, 64, v13
v_add_u32 v12, s60, v14
v_pk_fma_f32 v[196:197], v[36:37], v[16:17], v[196:197] op_sel_hi:[0,1,1]
v_pk_fma_f32 v[198:199], v[36:37], v[18:19], v[198:199] op_sel_hi:[0,1,1]
v_pk_fma_f32 v[228:229], v[36:37], v[24:25], v[228:229] op_sel_hi:[0,1,1]
v_pk_fma_f32 v[230:231], v[36:37], v[26:27], v[230:231] op_sel_hi:[0,1,1]
v_pk_fma_f32 v[212:213], v[36:37], v[20:21], v[212:213] op_sel_hi:[0,1,1]
v_pk_fma_f32 v[214:215], v[36:37], v[22:23], v[214:215] op_sel_hi:[0,1,1]
v_pk_fma_f32 v[244:245], v[36:37], v[28:29], v[244:245] op_sel_hi:[0,1,1]
v_pk_fma_f32 v[246:247], v[36:37], v[30:31], v[246:247] op_sel_hi:[0,1,1]
v_bfe_u32 v3, v0, 1, 2
v_xor_b32 v3, v3, v5
v_lshlrev_b32 v4, 6, v2
v_lshl_add_u32 v4, v3, 4, v4
v_add_u32 v6, s61, v4
v_pk_mul_f32 v[48:49], v[196:197], v[196:197]
v_pk_mul_f32 v[50:51], v[198:199], v[198:199]
v_pk_mul_f32 v[52:53], v[228:229], v[228:229]
v_pk_mul_f32 v[54:55], v[230:231], v[230:231]
v_pk_fma_f32 v[48:49], v[38:39], v[48:49], v[36:37] op_sel:[0,0,1] op_sel_hi:[0,1,1]
v_pk_fma_f32 v[50:51], v[38:39], v[50:51], v[36:37] op_sel:[0,0,1] op_sel_hi:[0,1,1]
v_pk_fma_f32 v[52:53], v[38:39], v[52:53], v[36:37] op_sel:[0,0,1] op_sel_hi:[0,1,1]
v_pk_fma_f32 v[54:55], v[38:39], v[54:55], v[36:37] op_sel:[0,0,1] op_sel_hi:[0,1,1]
ds_read_b128 v[136:139], v12 offset:0
ds_read_b128 v[140:143], v12 offset:1024
v_pk_mul_f32 v[48:49], v[48:49], v[196:197]
v_pk_mul_f32 v[50:51], v[50:51], v[198:199]
v_pk_mul_f32 v[52:53], v[52:53], v[228:229]
v_pk_mul_f32 v[54:55], v[54:55], v[230:231]
v_exp_f32 v48, v48
v_exp_f32 v49, v49
v_exp_f32 v50, v50
v_exp_f32 v51, v51
ds_read_b128 v[144:147], v12 offset:2048
v_exp_f32 v52, v52
v_exp_f32 v53, v53
v_exp_f32 v54, v54
v_exp_f32 v55, v55
ds_read_b128 v[148:151], v12 offset:3072
ds_read_b128 v[152:155], v12 offset:4096
v_pk_fma_f32 v[48:49], v[38:39], v[48:49], v[38:39] op_sel:[1,0,1]
v_pk_fma_f32 v[50:51], v[38:39], v[50:51], v[38:39] op_sel:[1,0,1]
v_pk_fma_f32 v[52:53], v[38:39], v[52:53], v[38:39] op_sel:[1,0,1]
v_pk_fma_f32 v[54:55], v[38:39], v[54:55], v[38:39] op_sel:[1,0,1]
v_rcp_f32 v48, v48
v_rcp_f32 v49, v49
v_pk_mul_f32 v[212:213], v[212:213], v[196:197]
ds_read_b128 v[156:159], v12 offset:5120
v_rcp_f32 v50, v50
v_rcp_f32 v51, v51
v_pk_mul_f32 v[214:215], v[214:215], v[198:199]
ds_read_b128 v[160:163], v12 offset:6144
ds_read_b128 v[164:167], v12 offset:7168
v_rcp_f32 v52, v52
v_rcp_f32 v53, v53
v_pk_mul_f32 v[244:245], v[244:245], v[228:229]
ds_read_b128 v[168:171], v12 offset:8192
v_rcp_f32 v54, v54
v_rcp_f32 v55, v55
v_pk_mul_f32 v[246:247], v[246:247], v[230:231]
v_pk_mul_f32 v[212:213], v[212:213], v[48:49]
v_pk_mul_f32 v[214:215], v[214:215], v[50:51]
v_pk_mul_f32 v[244:245], v[244:245], v[52:53]
v_pk_mul_f32 v[246:247], v[246:247], v[54:55]
ds_read_b128 v[172:175], v12 offset:9216
v_cvt_pk_bf16_f32 v196, v212, v213
v_cvt_pk_bf16_f32 v197, v214, v215
v_cvt_pk_bf16_f32 v198, v244, v245
v_cvt_pk_bf16_f32 v199, v246, v247
buffer_store_dwordx4 v[196:199], v14, s[20:23], s70 offen offset:1024 sc1
s_load_dword s74, s[54:55], s89 glc
v_pk_fma_f32 v[200:201], v[40:41], v[16:17], v[200:201] op_sel_hi:[0,1,1]
v_pk_fma_f32 v[202:203], v[40:41], v[18:19], v[202:203] op_sel_hi:[0,1,1]
v_pk_fma_f32 v[232:233], v[40:41], v[24:25], v[232:233] op_sel_hi:[0,1,1]
v_pk_fma_f32 v[234:235], v[40:41], v[26:27], v[234:235] op_sel_hi:[0,1,1]
v_pk_fma_f32 v[216:217], v[40:41], v[20:21], v[216:217] op_sel_hi:[0,1,1]
v_pk_fma_f32 v[218:219], v[40:41], v[22:23], v[218:219] op_sel_hi:[0,1,1]
v_pk_fma_f32 v[248:249], v[40:41], v[28:29], v[248:249] op_sel_hi:[0,1,1]
v_pk_fma_f32 v[250:251], v[40:41], v[30:31], v[250:251] op_sel_hi:[0,1,1]
v_pk_mul_f32 v[48:49], v[200:201], v[200:201]
v_pk_mul_f32 v[50:51], v[202:203], v[202:203]
v_pk_mul_f32 v[52:53], v[232:233], v[232:233]
v_pk_mul_f32 v[54:55], v[234:235], v[234:235]
v_pk_fma_f32 v[48:49], v[42:43], v[48:49], v[40:41] op_sel:[0,0,1] op_sel_hi:[0,1,1]
v_pk_fma_f32 v[50:51], v[42:43], v[50:51], v[40:41] op_sel:[0,0,1] op_sel_hi:[0,1,1]
v_pk_fma_f32 v[52:53], v[42:43], v[52:53], v[40:41] op_sel:[0,0,1] op_sel_hi:[0,1,1]
v_pk_fma_f32 v[54:55], v[42:43], v[54:55], v[40:41] op_sel:[0,0,1] op_sel_hi:[0,1,1]
v_pk_mul_f32 v[48:49], v[48:49], v[200:201]
v_pk_mul_f32 v[50:51], v[50:51], v[202:203]
v_pk_mul_f32 v[52:53], v[52:53], v[232:233]
v_pk_mul_f32 v[54:55], v[54:55], v[234:235]
v_exp_f32 v48, v48
v_exp_f32 v49, v49
v_exp_f32 v50, v50
v_exp_f32 v51, v51
v_exp_f32 v52, v52
v_exp_f32 v53, v53
v_exp_f32 v54, v54
v_exp_f32 v55, v55
v_pk_fma_f32 v[48:49], v[42:43], v[48:49], v[42:43] op_sel:[1,0,1]
v_pk_fma_f32 v[50:51], v[42:43], v[50:51], v[42:43] op_sel:[1,0,1]
v_pk_fma_f32 v[52:53], v[42:43], v[52:53], v[42:43] op_sel:[1,0,1]
v_pk_fma_f32 v[54:55], v[42:43], v[54:55], v[42:43] op_sel:[1,0,1]
v_rcp_f32 v48, v48
v_rcp_f32 v49, v49
v_pk_mul_f32 v[216:217], v[216:217], v[200:201]
v_rcp_f32 v50, v50
v_rcp_f32 v51, v51
v_pk_mul_f32 v[218:219], v[218:219], v[202:203]
v_rcp_f32 v52, v52
v_rcp_f32 v53, v53
v_pk_mul_f32 v[248:249], v[248:249], v[232:233]
v_rcp_f32 v54, v54
v_rcp_f32 v55, v55
v_pk_mul_f32 v[250:251], v[250:251], v[234:235]
v_pk_mul_f32 v[216:217], v[216:217], v[48:49]
v_pk_mul_f32 v[218:219], v[218:219], v[50:51]
v_pk_mul_f32 v[248:249], v[248:249], v[52:53]
v_pk_mul_f32 v[250:251], v[250:251], v[54:55]
v_cvt_pk_bf16_f32 v200, v216, v217
v_cvt_pk_bf16_f32 v201, v218, v219
v_cvt_pk_bf16_f32 v202, v248, v249
v_cvt_pk_bf16_f32 v203, v250, v251
buffer_store_dwordx4 v[200:203], v14, s[20:23], s70 offen offset:2048 sc1
s_mov_b32 s78, 40000
s_branch L_sc46
L_sp45:
s_sleep 3
L_sl48:
s_load_dword s74, s[54:55], s89 glc
L_sc46:
s_waitcnt lgkmcnt(0)
s_bfe_u32 s85, s74, 0x80000
s_cmp_eq_u32 s85, 2
s_cbranch_scc1 L_so47
s_sub_u32 s78, s78, 1
s_cmp_lg_u32 s78, 0
s_cbranch_scc1 L_sp45
L_so47:
v_pk_fma_f32 v[204:205], v[44:45], v[16:17], v[204:205] op_sel_hi:[0,1,1]
v_pk_fma_f32 v[206:207], v[44:45], v[18:19], v[206:207] op_sel_hi:[0,1,1]
v_pk_fma_f32 v[236:237], v[44:45], v[24:25], v[236:237] op_sel_hi:[0,1,1]
v_pk_fma_f32 v[238:239], v[44:45], v[26:27], v[238:239] op_sel_hi:[0,1,1]
v_pk_fma_f32 v[220:221], v[44:45], v[20:21], v[220:221] op_sel_hi:[0,1,1]
v_pk_fma_f32 v[222:223], v[44:45], v[22:23], v[222:223] op_sel_hi:[0,1,1]
v_pk_fma_f32 v[252:253], v[44:45], v[28:29], v[252:253] op_sel_hi:[0,1,1]
v_pk_fma_f32 v[254:255], v[44:45], v[30:31], v[254:255] op_sel_hi:[0,1,1]
s_add_u32 s87, s90, 0
buffer_load_dwordx4 v[80:83], v14, s[20:23], s87 offen offset:0 sc1
v_pk_mul_f32 v[48:49], v[204:205], v[204:205]
v_pk_mul_f32 v[50:51], v[206:207], v[206:207]
v_pk_mul_f32 v[52:53], v[236:237], v[236:237]
v_pk_mul_f32 v[54:55], v[238:239], v[238:239]
v_pk_fma_f32 v[48:49], v[46:47], v[48:49], v[44:45] op_sel:[0,0,1] op_sel_hi:[0,1,1]
v_pk_fma_f32 v[50:51], v[46:47], v[50:51], v[44:45] op_sel:[0,0,1] op_sel_hi:[0,1,1]
v_pk_fma_f32 v[52:53], v[46:47], v[52:53], v[44:45] op_sel:[0,0,1] op_sel_hi:[0,1,1]
v_pk_fma_f32 v[54:55], v[46:47], v[54:55], v[44:45] op_sel:[0,0,1] op_sel_hi:[0,1,1]
buffer_load_dwordx4 v[84:87], v14, s[20:23], s87 offen offset:1024 sc1
v_pk_mul_f32 v[48:49], v[48:49], v[204:205]
v_pk_mul_f32 v[50:51], v[50:51], v[206:207]
v_pk_mul_f32 v[52:53], v[52:53], v[236:237]
v_pk_mul_f32 v[54:55], v[54:55], v[238:239]
v_exp_f32 v48, v48
v_exp_f32 v49, v49
v_exp_f32 v50, v50
v_exp_f32 v51, v51
buffer_load_dwordx4 v[88:91], v14, s[20:23], s87 offen offset:2048 sc1
v_exp_f32 v52, v52
v_exp_f32 v53, v53
v_exp_f32 v54, v54
v_exp_f32 v55, v55
buffer_load_dwordx4 v[92:95], v14, s[20:23], s87 offen offset:3072 sc1
v_pk_fma_f32 v[48:49], v[46:47], v[48:49], v[46:47] op_sel:[1,0,1]
v_pk_fma_f32 v[50:51], v[46:47], v[50:51], v[46:47] op_sel:[1,0,1]
v_pk_fma_f32 v[52:53], v[46:47], v[52:53], v[46:47] op_sel:[1,0,1]
v_pk_fma_f32 v[54:55], v[46:47], v[54:55], v[46:47] op_sel:[1,0,1]
v_rcp_f32 v48, v48
v_rcp_f32 v49, v49
v_pk_mul_f32 v[220:221], v[220:221], v[204:205]
s_add_u32 s87, s90, 4096
buffer_load_dwordx4 v[96:99], v14, s[20:23], s87 offen offset:0 sc1
v_rcp_f32 v50, v50
v_rcp_f32 v51, v51
v_pk_mul_f32 v[222:223], v[222:223], v[206:207]
buffer_load_dwordx4 v[100:103], v14, s[20:23], s87 offen offset:1024 sc1
v_rcp_f32 v52, v52
v_rcp_f32 v53, v53
v_pk_mul_f32 v[252:253], v[252:253], v[236:237]
buffer_load_dwordx4 v[104:107], v14, s[20:23], s87 offen offset:2048 sc1
v_rcp_f32 v54, v54
v_rcp_f32 v55, v55
v_pk_mul_f32 v[254:255], v[254:255], v[238:239]
v_pk_mul_f32 v[220:221], v[220:221], v[48:49]
v_pk_mul_f32 v[222:223], v[222:223], v[50:51]
v_pk_mul_f32 v[252:253], v[252:253], v[52:53]
v_pk_mul_f32 v[254:255], v[254:255], v[54:55]
buffer_load_dwordx4 v[108:111], v14, s[20:23], s87 offen offset:3072 sc1
v_cvt_pk_bf16_f32 v204, v220, v221
v_cvt_pk_bf16_f32 v205, v222, v223
v_cvt_pk_bf16_f32 v206, v252, v253
v_cvt_pk_bf16_f32 v207, v254, v255
buffer_store_dwordx4 v[204:207], v14, s[20:23], s70 offen offset:3072 sc1
L_P2G:
s_setprio 0
s_waitcnt lgkmcnt(0)
v_and_b32 v2, 1, v0
v_lshlrev_b32 v2, 2, v2
v_add_u32 v2, 146704, v2
ds_read_b32 v3, v2
s_load_dword s74, s[54:55], s89 glc
s_waitcnt vmcnt(4)
v_mfma_f32_16x16x32_bf16 v[176:179], v[136:139], v[80:83], 0
v_mfma_f32_16x16x32_bf16 v[180:183], v[136:139], v[84:87], 0
s_add_u32 s85, s91, 20480
buffer_load_dwordx4 v[16:19], v14, s[20:23], s85 offen offset:0 sc1
v_mfma_f32_16x16x32_bf16 v[184:187], v[136:139], v[88:91], 0
v_mfma_f32_16x16x32_bf16 v[188:191], v[136:139], v[92:95], 0
s_mov_b32 s78, 40000
s_branch L_sc54
L_sp53:
s_sleep 3
L_sl56:
s_load_dword s74, s[54:55], s89 glc
L_sc54:
s_waitcnt lgkmcnt(0)
s_bfe_u32 s85, s74, 0x80008
s_cmp_eq_u32 s85, 2
s_cbranch_scc1 L_so55
s_sub_u32 s78, s78, 1
s_cmp_lg_u32 s78, 0
s_cbranch_scc1 L_sp53
L_so55:
v_mfma_f32_16x16x32_bf16 v[204:207], v[140:143], v[92:95], 0
v_mfma_f32_16x16x32_bf16 v[200:203], v[140:143], v[88:91], 0
s_add_u32 s87, s90, 8192
buffer_load_dwordx4 v[20:23], v14, s[20:23], s87 offen offset:0 sc1
v_mfma_f32_16x16x32_bf16 v[196:199], v[140:143], v[84:87], 0
v_mfma_f32_16x16x32_bf16 v[192:195], v[140:143], v[80:83], 0
buffer_load_dwordx4 v[24:27], v14, s[20:23], s87 offen offset:1024 sc1
v_mfma_f32_16x16x32_bf16 v[208:211], v[144:147], v[80:83], 0
v_mfma_f32_16x16x32_bf16 v[212:215], v[144:147], v[84:87], 0
buffer_load_dwordx4 v[28:31], v14, s[20:23], s87 offen offset:2048 sc1
v_mfma_f32_16x16x32_bf16 v[216:219], v[144:147], v[88:91], 0
v_mfma_f32_16x16x32_bf16 v[220:223], v[144:147], v[92:95], 0
buffer_load_dwordx4 v[32:35], v14, s[20:23], s87 offen offset:3072 sc1
v_mfma_f32_16x16x32_bf16 v[236:239], v[148:151], v[92:95], 0
v_mfma_f32_16x16x32_bf16 v[232:235], v[148:151], v[88:91], 0
s_add_u32 s85, s91, 20480
buffer_load_dwordx4 v[36:39], v14, s[20:23], s85 offen offset:1024 sc1
v_mfma_f32_16x16x32_bf16 v[228:231], v[148:151], v[84:87], 0
v_mfma_f32_16x16x32_bf16 v[224:227], v[148:151], v[80:83], 0
s_add_u32 s85, s91, 20480
buffer_load_dwordx4 v[40:43], v14, s[20:23], s85 offen offset:2048 sc1
v_mfma_f32_16x16x32_bf16 v[240:243], v[152:155], v[80:83], 0
v_mfma_f32_16x16x32_bf16 v[244:247], v[152:155], v[84:87], 0
s_add_u32 s85, s91, 20480
buffer_load_dwordx4 v[44:47], v14, s[20:23], s85 offen offset:3072 sc1
v_mfma_f32_16x16x32_bf16 v[248:251], v[152:155], v[88:91], 0
v_mfma_f32_16x16x32_bf16 v[252:255], v[152:155], v[92:95], 0
s_add_u32 s85, s91, 24576
buffer_load_dwordx4 v[48:51], v14, s[20:23], s85 offen offset:0 sc1
s_waitcnt vmcnt(9)
s_waitcnt lgkmcnt(0)
v_cmp_eq_u32 vcc, 0, v3
s_nop 0
s_cbranch_vccz L_ok57
s_mov_b32 s78, 400000
s_branch L_lc59
L_lp58:
s_sleep 1
L_lc59:
ds_read_b32 v3, v2
s_waitcnt lgkmcnt(0)
v_cmp_eq_u32 vcc, 0, v3
s_sub_u32 s78, s78, 1
s_cbranch_vccz L_lo60
s_cmp_lg_u32 s78, 0
s_cbranch_scc1 L_lp58
L_lo60:
L_ok57:
v_mov_b32 v2, 146696
s_mov_b64 exec, 1
ds_add_u32 v2, v1
s_mov_b64 exec, -1
s_waitcnt vmcnt(9)
s_cmp_eq_u32 s76, 0
s_cbranch_scc1 L_sk61
s_mov_b32 s76, 0
s_atomic_add s7, s[54:55], s79
L_sk61:
v_mfma_f32_16x16x32_bf16 v[176:179], v[156:159], v[96:99], v[176:179]
ds_read_b128 v[52:55], v12 offset:10240
v_mfma_f32_16x16x32_bf16 v[180:183], v[156:159], v[100:103], v[180:183]
s_add_u32 s87, s90, 12288
buffer_load_dwordx4 v[56:59], v14, s[20:23], s87 offen offset:0 sc1
v_mfma_f32_16x16x32_bf16 v[184:187], v[156:159], v[104:107], v[184:187]
ds_read_b128 v[60:63], v12 offset:11264
v_mfma_f32_16x16x32_bf16 v[188:191], v[156:159], v[108:111], v[188:191]
buffer_load_dwordx4 v[64:67], v14, s[20:23], s87 offen offset:1024 sc1
v_mfma_f32_16x16x32_bf16 v[204:207], v[160:163], v[108:111], v[204:207]
ds_read_b128 v[68:71], v12 offset:12288
v_mfma_f32_16x16x32_bf16 v[200:203], v[160:163], v[104:107], v[200:203]
buffer_load_dwordx4 v[72:75], v14, s[20:23], s87 offen offset:2048 sc1
v_mfma_f32_16x16x32_bf16 v[196:199], v[160:163], v[100:103], v[196:199]
ds_read_b128 v[76:79], v12 offset:13312
v_mfma_f32_16x16x32_bf16 v[192:195], v[160:163], v[96:99], v[192:195]
buffer_load_dwordx4 v[112:115], v14, s[20:23], s87 offen offset:3072 sc1
v_mfma_f32_16x16x32_bf16 v[208:211], v[164:167], v[96:99], v[208:211]
ds_read_b128 v[116:119], v12 offset:14336
v_mfma_f32_16x16x32_bf16 v[212:215], v[164:167], v[100:103], v[212:215]
s_add_u32 s85, s91, 24576
buffer_load_dwordx4 v[120:123], v14, s[20:23], s85 offen offset:1024 sc1
v_mfma_f32_16x16x32_bf16 v[216:219], v[164:167], v[104:107], v[216:219]
v_mfma_f32_16x16x32_bf16 v[220:223], v[164:167], v[108:111], v[220:223]
s_add_u32 s85, s91, 24576
buffer_load_dwordx4 v[124:127], v14, s[20:23], s85 offen offset:2048 sc1
v_mfma_f32_16x16x32_bf16 v[236:239], v[168:171], v[108:111], v[236:239]
v_mfma_f32_16x16x32_bf16 v[232:235], v[168:171], v[104:107], v[232:235]
s_add_u32 s85, s91, 24576
buffer_load_dwordx4 v[128:131], v14, s[20:23], s85 offen offset:3072 sc1
v_mfma_f32_16x16x32_bf16 v[228:231], v[168:171], v[100:103], v[228:231]
v_mfma_f32_16x16x32_bf16 v[224:227], v[168:171], v[96:99], v[224:227]
v_mfma_f32_16x16x32_bf16 v[240:243], v[172:175], v[96:99], v[240:243]
v_mfma_f32_16x16x32_bf16 v[244:247], v[172:175], v[100:103], v[244:247]
s_add_u32 s85, s91, 28672
buffer_load_dwordx4 v[132:135], v14, s[20:23], s85 offen offset:0 sc1
v_mfma_f32_16x16x32_bf16 v[248:251], v[172:175], v[104:107], v[248:251]
v_mfma_f32_16x16x32_bf16 v[252:255], v[172:175], v[108:111], v[252:255]
s_waitcnt vmcnt(12)
s_waitcnt lgkmcnt(0)
v_mfma_f32_16x16x32_bf16 v[176:179], v[52:55], v[20:23], v[176:179]
ds_read_b128 v[136:139], v12 offset:15360
v_mfma_f32_16x16x32_bf16 v[180:183], v[52:55], v[24:27], v[180:183]
s_add_u32 s85, s91, 28672
buffer_load_dwordx4 v[140:143], v14, s[20:23], s85 offen offset:1024 sc1
v_mfma_f32_16x16x32_bf16 v[184:187], v[52:55], v[28:31], v[184:187]
ds_read_b128 v[144:147], v12 offset:16384
v_mfma_f32_16x16x32_bf16 v[188:191], v[52:55], v[32:35], v[188:191]
ds_read_b128 v[148:151], v12 offset:17408
s_load_dword s74, s[54:55], s89 glc
v_mfma_f32_16x16x32_bf16 v[204:207], v[60:63], v[32:35], v[204:207]
ds_read_b128 v[152:155], v12 offset:18432
v_mfma_f32_16x16x32_bf16 v[200:203], v[60:63], v[28:31], v[200:203]
ds_read_b128 v[80:83], v12 offset:19456
v_mfma_f32_16x16x32_bf16 v[196:199], v[60:63], v[24:27], v[196:199]
v_mfma_f32_16x16x32_bf16 v[192:195], v[60:63], v[20:23], v[192:195]
v_mfma_f32_16x16x32_bf16 v[208:211], v[68:71], v[20:23], v[208:211]
v_mfma_f32_16x16x32_bf16 v[212:215], v[68:71], v[24:27], v[212:215]
s_add_u32 s85, s91, 28672
buffer_load_dwordx4 v[84:87], v14, s[20:23], s85 offen offset:2048 sc1
v_mfma_f32_16x16x32_bf16 v[216:219], v[68:71], v[28:31], v[216:219]
v_mfma_f32_16x16x32_bf16 v[220:223], v[68:71], v[32:35], v[220:223]
v_mfma_f32_16x16x32_bf16 v[236:239], v[76:79], v[32:35], v[236:239]
v_mfma_f32_16x16x32_bf16 v[232:235], v[76:79], v[28:31], v[232:235]
s_add_u32 s85, s91, 28672
buffer_load_dwordx4 v[88:91], v14, s[20:23], s85 offen offset:3072 sc1
v_mfma_f32_16x16x32_bf16 v[228:231], v[76:79], v[24:27], v[228:231]
v_mfma_f32_16x16x32_bf16 v[224:227], v[76:79], v[20:23], v[224:227]
v_mfma_f32_16x16x32_bf16 v[240:243], v[116:119], v[20:23], v[240:243]
v_mfma_f32_16x16x32_bf16 v[244:247], v[116:119], v[24:27], v[244:247]
s_add_u32 s85, s91, 32768
buffer_load_dwordx4 v[92:95], v14, s[20:23], s85 offen offset:0 sc1
v_mfma_f32_16x16x32_bf16 v[248:251], v[116:119], v[28:31], v[248:251]
v_mfma_f32_16x16x32_bf16 v[252:255], v[116:119], v[32:35], v[252:255]
s_waitcnt vmcnt(8)
s_waitcnt lgkmcnt(0)
s_mov_b32 s78, 40000
s_branch L_sc63
L_sp62:
s_sleep 3
L_sl65:
s_load_dword s74, s[54:55], s89 glc
L_sc63:
s_waitcnt lgkmcnt(0)
s_bfe_u32 s85, s74, 0x80010
s_cmp_eq_u32 s85, 5
s_cbranch_scc1 L_so64
s_sub_u32 s78, s78, 1
s_cmp_lg_u32 s78, 0
s_cbranch_scc1 L_sp62
L_so64:
v_mfma_f32_16x16x32_bf16 v[176:179], v[136:139], v[56:59], v[176:179]
v_mfma_f32_16x16x32_bf16 v[180:183], v[136:139], v[64:67], v[180:183]
s_add_u32 s87, s90, 16384
buffer_load_dwordx4 v[156:159], v14, s[20:23], s87 offen offset:0 sc1
v_mfma_f32_16x16x32_bf16 v[184:187], v[136:139], v[72:75], v[184:187]
v_mfma_f32_16x16x32_bf16 v[188:191], v[136:139], v[112:115], v[188:191]
buffer_load_dwordx4 v[160:163], v14, s[20:23], s87 offen offset:1024 sc1
v_mfma_f32_16x16x32_bf16 v[204:207], v[144:147], v[112:115], v[204:207]
v_mfma_f32_16x16x32_bf16 v[200:203], v[144:147], v[72:75], v[200:203]
buffer_load_dwordx4 v[164:167], v14, s[20:23], s87 offen offset:2048 sc1
v_mfma_f32_16x16x32_bf16 v[196:199], v[144:147], v[64:67], v[196:199]
v_mfma_f32_16x16x32_bf16 v[192:195], v[144:147], v[56:59], v[192:195]
buffer_load_dwordx4 v[168:171], v14, s[20:23], s87 offen offset:3072 sc1
v_mfma_f32_16x16x32_bf16 v[208:211], v[148:151], v[56:59], v[208:211]
v_mfma_f32_16x16x32_bf16 v[212:215], v[148:151], v[64:67], v[212:215]
s_add_u32 s87, s90, 20480
buffer_load_dwordx4 v[172:175], v14, s[20:23], s87 offen offset:0 sc1
v_mfma_f32_16x16x32_bf16 v[216:219], v[148:151], v[72:75], v[216:219]
v_mfma_f32_16x16x32_bf16 v[220:223], v[148:151], v[112:115], v[220:223]
buffer_load_dwordx4 v[96:99], v14, s[20:23], s87 offen offset:1024 sc1
v_mfma_f32_16x16x32_bf16 v[236:239], v[152:155], v[112:115], v[236:239]
v_mfma_f32_16x16x32_bf16 v[232:235], v[152:155], v[72:75], v[232:235]
buffer_load_dwordx4 v[100:103], v14, s[20:23], s87 offen offset:2048 sc1
v_mfma_f32_16x16x32_bf16 v[228:231], v[152:155], v[64:67], v[228:231]
v_mfma_f32_16x16x32_bf16 v[224:227], v[152:155], v[56:59], v[224:227]
buffer_load_dwordx4 v[104:107], v14, s[20:23], s87 offen offset:3072 sc1
v_mfma_f32_16x16x32_bf16 v[240:243], v[80:83], v[56:59], v[240:243]
v_mfma_f32_16x16x32_bf16 v[244:247], v[80:83], v[64:67], v[244:247]
s_add_u32 s85, s91, 32768
buffer_load_dwordx4 v[108:111], v14, s[20:23], s85 offen offset:1024 sc1
v_mfma_f32_16x16x32_bf16 v[248:251], v[80:83], v[72:75], v[248:251]
v_mfma_f32_16x16x32_bf16 v[252:255], v[80:83], v[112:115], v[252:255]
s_add_u32 s85, s91, 32768
buffer_load_dwordx4 v[52:55], v14, s[20:23], s85 offen offset:2048 sc1
s_waitcnt vmcnt(6)
v_mfma_f32_16x16x32_bf16 v[176:179], v[16:19], v[156:159], v[176:179]
v_mfma_f32_16x16x32_bf16 v[180:183], v[16:19], v[160:163], v[180:183]
s_add_u32 s87, s90, 24576
buffer_load_dwordx4 v[60:63], v14, s[20:23], s87 offen offset:0 sc1
v_mfma_f32_16x16x32_bf16 v[184:187], v[16:19], v[164:167], v[184:187]
v_mfma_f32_16x16x32_bf16 v[188:191], v[16:19], v[168:171], v[188:191]
buffer_load_dwordx4 v[68:71], v14, s[20:23], s87 offen offset:1024 sc1
v_mfma_f32_16x16x32_bf16 v[204:207], v[36:39], v[168:171], v[204:207]
v_mfma_f32_16x16x32_bf16 v[200:203], v[36:39], v[164:167], v[200:203]
buffer_load_dwordx4 v[76:79], v14, s[20:23], s87 offen offset:2048 sc1
v_mfma_f32_16x16x32_bf16 v[196:199], v[36:39], v[160:163], v[196:199]
v_mfma_f32_16x16x32_bf16 v[192:195], v[36:39], v[156:159], v[192:195]
buffer_load_dwordx4 v[116:119], v14, s[20:23], s87 offen offset:3072 sc1
v_mfma_f32_16x16x32_bf16 v[208:211], v[40:43], v[156:159], v[208:211]
v_mfma_f32_16x16x32_bf16 v[212:215], v[40:43], v[160:163], v[212:215]
s_add_u32 s85, s91, 32768
buffer_load_dwordx4 v[32:35], v14, s[20:23], s85 offen offset:3072 sc1
v_mfma_f32_16x16x32_bf16 v[216:219], v[40:43], v[164:167], v[216:219]
v_mfma_f32_16x16x32_bf16 v[220:223], v[40:43], v[168:171], v[220:223]
s_add_u32 s85, s91, 36864
buffer_load_dwordx4 v[136:139], v14, s[20:23], s85 offen offset:0 sc1
v_mfma_f32_16x16x32_bf16 v[236:239], v[44:47], v[168:171], v[236:239]
v_mfma_f32_16x16x32_bf16 v[232:235], v[44:47], v[164:167], v[232:235]
s_add_u32 s85, s91, 36864
buffer_load_dwordx4 v[144:147], v14, s[20:23], s85 offen offset:1024 sc1
v_mfma_f32_16x16x32_bf16 v[228:231], v[44:47], v[160:163], v[228:231]
v_mfma_f32_16x16x32_bf16 v[224:227], v[44:47], v[156:159], v[224:227]
s_add_u32 s85, s91, 36864
buffer_load_dwordx4 v[148:151], v14, s[20:23], s85 offen offset:2048 sc1
v_mfma_f32_16x16x32_bf16 v[240:243], v[48:51], v[156:159], v[240:243]
v_mfma_f32_16x16x32_bf16 v[244:247], v[48:51], v[160:163], v[244:247]
s_add_u32 s85, s91, 36864
buffer_load_dwordx4 v[152:155], v14, s[20:23], s85 offen offset:3072 sc1
v_mfma_f32_16x16x32_bf16 v[248:251], v[48:51], v[164:167], v[248:251]
v_mfma_f32_16x16x32_bf16 v[252:255], v[48:51], v[168:171], v[252:255]
s_add_u32 s85, s91, 40960
buffer_load_dwordx4 v[80:83], v14, s[20:23], s85 offen offset:0 sc1
s_waitcnt vmcnt(12)
v_mfma_f32_16x16x32_bf16 v[176:179], v[120:123], v[172:175], v[176:179]
v_mfma_f32_16x16x32_bf16 v[180:183], v[120:123], v[96:99], v[180:183]
s_add_u32 s87, s90, 28672
buffer_load_dwordx4 v[56:59], v14, s[20:23], s87 offen offset:0 sc1
v_mfma_f32_16x16x32_bf16 v[184:187], v[120:123], v[100:103], v[184:187]
v_mfma_f32_16x16x32_bf16 v[188:191], v[120:123], v[104:107], v[188:191]
buffer_load_dwordx4 v[64:67], v14, s[20:23], s87 offen offset:1024 sc1
v_mfma_f32_16x16x32_bf16 v[204:207], v[124:127], v[104:107], v[204:207]
v_mfma_f32_16x16x32_bf16 v[200:203], v[124:127], v[100:103], v[200:203]
buffer_load_dwordx4 v[72:75], v14, s[20:23], s87 offen offset:2048 sc1
v_mfma_f32_16x16x32_bf16 v[196:199], v[124:127], v[96:99], v[196:199]
v_mfma_f32_16x16x32_bf16 v[192:195], v[124:127], v[172:175], v[192:195]
buffer_load_dwordx4 v[112:115], v14, s[20:23], s87 offen offset:3072 sc1
v_mfma_f32_16x16x32_bf16 v[208:211], v[128:131], v[172:175], v[208:211]
v_mfma_f32_16x16x32_bf16 v[212:215], v[128:131], v[96:99], v[212:215]
s_add_u32 s87, s90, 32768
buffer_load_dwordx4 v[36:39], v14, s[20:23], s87 offen offset:0 sc1
v_mfma_f32_16x16x32_bf16 v[216:219], v[128:131], v[100:103], v[216:219]
v_mfma_f32_16x16x32_bf16 v[220:223], v[128:131], v[104:107], v[220:223]
buffer_load_dwordx4 v[40:43], v14, s[20:23], s87 offen offset:1024 sc1
v_mfma_f32_16x16x32_bf16 v[236:239], v[132:135], v[104:107], v[236:239]
v_mfma_f32_16x16x32_bf16 v[232:235], v[132:135], v[100:103], v[232:235]
buffer_load_dwordx4 v[44:47], v14, s[20:23], s87 offen offset:2048 sc1
v_mfma_f32_16x16x32_bf16 v[228:231], v[132:135], v[96:99], v[228:231]
v_mfma_f32_16x16x32_bf16 v[224:227], v[132:135], v[172:175], v[224:227]
buffer_load_dwordx4 v[48:51], v14, s[20:23], s87 offen offset:3072 sc1
v_mfma_f32_16x16x32_bf16 v[240:243], v[140:143], v[172:175], v[240:243]
v_mfma_f32_16x16x32_bf16 v[244:247], v[140:143], v[96:99], v[244:247]
s_add_u32 s85, s91, 40960
buffer_load_dwordx4 v[156:159], v14, s[20:23], s85 offen offset:1024 sc1
v_mfma_f32_16x16x32_bf16 v[248:251], v[140:143], v[100:103], v[248:251]
v_mfma_f32_16x16x32_bf16 v[252:255], v[140:143], v[104:107], v[252:255]
s_add_u32 s85, s91, 40960
buffer_load_dwordx4 v[160:163], v14, s[20:23], s85 offen offset:2048 sc1
s_waitcnt vmcnt(16)
v_mfma_f32_16x16x32_bf16 v[176:179], v[84:87], v[60:63], v[176:179]
s_mov_b64 s[24:25], s[50:51]
s_mov_b32 s26, 2621440
v_mfma_f32_16x16x32_bf16 v[180:183], v[84:87], v[68:71], v[180:183]
s_add_u32 s85, s91, 40960
buffer_load_dwordx4 v[164:167], v14, s[20:23], s85 offen offset:3072 sc1
s_mov_b32 s27, 0x20000
s_lshl_b32 s60, s56, 6
v_mfma_f32_16x16x32_bf16 v[184:187], v[84:87], v[76:79], v[184:187]
v_mov_b32 v30, 0xbfb8aa3b
v_mov_b32 v31, 1.0
v_mfma_f32_16x16x32_bf16 v[188:191], v[84:87], v[116:119], v[188:191]
s_add_u32 s85, s91, 45056
buffer_load_dwordx4 v[168:171], v14, s[20:23], s85 offen offset:0 sc1
s_bfe_u32 s61, s92, 0x10005
s_lshl_b32 s62, s61, 5
v_mfma_f32_16x16x32_bf16 v[204:207], v[88:91], v[116:119], v[204:207]
s_lshl_b32 s61, s61, 7
s_sub_u32 s61, 128, s61
v_mfma_f32_16x16x32_bf16 v[200:203], v[88:91], v[76:79], v[200:203]
v_add_u32 v5, s60, v0
v_lshrrev_b32 v2, 4, v5
v_mfma_f32_16x16x32_bf16 v[196:199], v[88:91], v[68:71], v[196:199]
v_and_b32 v4, 7, v2
v_xor_b32 v4, v4, v5
v_mfma_f32_16x16x32_bf16 v[192:195], v[88:91], v[60:63], v[192:195]
v_lshlrev_b32 v16, 4, v4
v_and_b32 v3, 15, v5
v_mfma_f32_16x16x32_bf16 v[208:211], v[92:95], v[60:63], v[208:211]
v_lshl_add_u32 v3, v3, 3, s62
v_and_b32 v5, 15, v2
v_mfma_f32_16x16x32_bf16 v[212:215], v[92:95], v[68:71], v[212:215]
v_bfe_u32 v4, v2, 4, 1
v_lshl_add_u32 v5, v5, 1, v4
v_mfma_f32_16x16x32_bf16 v[216:219], v[92:95], v[76:79], v[216:219]
v_and_or_b32 v5, v2, 32, v5
v_mul_u32_u24 v5, 1280, v5
v_mfma_f32_16x16x32_bf16 v[220:223], v[92:95], v[116:119], v[220:223]
v_add_u32 v20, v3, v5
buffer_load_dwordx2 v[24:25], v20, s[8:11], s92 offen
s_add_u32 s60, s60, 512
v_mfma_f32_16x16x32_bf16 v[236:239], v[108:111], v[116:119], v[236:239]
v_add_u32 v5, s60, v0
v_lshrrev_b32 v2, 4, v5
v_mfma_f32_16x16x32_bf16 v[232:235], v[108:111], v[76:79], v[232:235]
v_and_b32 v4, 7, v2
v_xor_b32 v4, v4, v5
v_mfma_f32_16x16x32_bf16 v[228:231], v[108:111], v[68:71], v[228:231]
v_lshlrev_b32 v17, 4, v4
v_and_b32 v3, 15, v5
v_mfma_f32_16x16x32_bf16 v[224:227], v[108:111], v[60:63], v[224:227]
v_lshl_add_u32 v3, v3, 3, s62
v_and_b32 v5, 15, v2
v_mfma_f32_16x16x32_bf16 v[240:243], v[52:55], v[60:63], v[240:243]
v_bfe_u32 v4, v2, 4, 1
v_lshl_add_u32 v5, v5, 1, v4
v_mfma_f32_16x16x32_bf16 v[244:247], v[52:55], v[68:71], v[244:247]
v_and_or_b32 v5, v2, 32, v5
v_mul_u32_u24 v5, 1280, v5
v_mfma_f32_16x16x32_bf16 v[248:251], v[52:55], v[76:79], v[248:251]
v_add_u32 v21, v3, v5
buffer_load_dwordx2 v[26:27], v21, s[8:11], s92 offen
s_add_u32 s60, s60, 512
v_mfma_f32_16x16x32_bf16 v[252:255], v[52:55], v[116:119], v[252:255]
v_add_u32 v5, s60, v0
v_lshrrev_b32 v2, 2, v5
s_waitcnt vmcnt(2)
v_mfma_f32_16x16x32_bf16 v[176:179], v[32:35], v[56:59], v[176:179]
v_bfe_u32 v4, v2, 1, 2
v_xor_b32 v4, v4, v5
v_mfma_f32_16x16x32_bf16 v[176:179], v[80:83], v[36:39], v[176:179]
v_lshlrev_b32 v18, 4, v4
v_and_b32 v3, 3, v5
v_mfma_f32_16x16x32_bf16 v[180:183], v[32:35], v[64:67], v[180:183]
v_lshl_add_u32 v3, v3, 3, s61
v_and_b32 v5, 15, v2
v_mfma_f32_16x16x32_bf16 v[180:183], v[80:83], v[40:43], v[180:183]
v_bfe_u32 v4, v2, 4, 1
v_lshl_add_u32 v5, v5, 1, v4
v_mfma_f32_16x16x32_bf16 v[184:187], v[32:35], v[72:75], v[184:187]
v_and_or_b32 v5, v2, 32, v5
v_mul_u32_u24 v5, 1280, v5
v_mfma_f32_16x16x32_bf16 v[184:187], v[80:83], v[44:47], v[184:187]
v_add_u32 v22, v3, v5
buffer_load_dwordx2 v[28:29], v22, s[8:11], s92 offen
s_add_u32 s60, s60, 512
v_mfma_f32_16x16x32_bf16 v[188:191], v[32:35], v[112:115], v[188:191]
v_mfma_f32_16x16x32_bf16 v[188:191], v[80:83], v[48:51], v[188:191]
v_mfma_f32_16x16x32_bf16 v[192:195], v[136:139], v[56:59], v[192:195]
ds_write_b128 v13, v[176:179] offset:0
v_mfma_f32_16x16x32_bf16 v[192:195], v[156:159], v[36:39], v[192:195]
v_mfma_f32_16x16x32_bf16 v[196:199], v[136:139], v[64:67], v[196:199]
ds_write_b128 v13, v[180:183] offset:4096
v_mfma_f32_16x16x32_bf16 v[196:199], v[156:159], v[40:43], v[196:199]
v_mfma_f32_16x16x32_bf16 v[200:203], v[136:139], v[72:75], v[200:203]
ds_write_b128 v13, v[184:187] offset:8192
v_mfma_f32_16x16x32_bf16 v[200:203], v[156:159], v[44:47], v[200:203]
v_mfma_f32_16x16x32_bf16 v[204:207], v[136:139], v[112:115], v[204:207]
ds_write_b128 v13, v[188:191] offset:12288
v_mfma_f32_16x16x32_bf16 v[204:207], v[156:159], v[48:51], v[204:207]
v_mfma_f32_16x16x32_bf16 v[208:211], v[144:147], v[56:59], v[208:211]
ds_write_b128 v7, v[192:195] offset:0
v_mfma_f32_16x16x32_bf16 v[208:211], v[160:163], v[36:39], v[208:211]
v_mfma_f32_16x16x32_bf16 v[212:215], v[144:147], v[64:67], v[212:215]
ds_write_b128 v7, v[196:199] offset:4096
v_mfma_f32_16x16x32_bf16 v[212:215], v[160:163], v[40:43], v[212:215]
v_mfma_f32_16x16x32_bf16 v[216:219], v[144:147], v[72:75], v[216:219]
ds_write_b128 v7, v[200:203] offset:8192
v_mfma_f32_16x16x32_bf16 v[216:219], v[160:163], v[44:47], v[216:219]
v_mfma_f32_16x16x32_bf16 v[220:223], v[144:147], v[112:115], v[220:223]
ds_write_b128 v7, v[204:207] offset:12288
v_mfma_f32_16x16x32_bf16 v[220:223], v[160:163], v[48:51], v[220:223]
v_mfma_f32_16x16x32_bf16 v[224:227], v[148:151], v[56:59], v[224:227]
ds_write_b128 v13, v[208:211] offset:128
v_mfma_f32_16x16x32_bf16 v[224:227], v[164:167], v[36:39], v[224:227]
v_mfma_f32_16x16x32_bf16 v[228:231], v[148:151], v[64:67], v[228:231]
ds_write_b128 v13, v[212:215] offset:4224
v_mfma_f32_16x16x32_bf16 v[228:231], v[164:167], v[40:43], v[228:231]
v_mfma_f32_16x16x32_bf16 v[232:235], v[148:151], v[72:75], v[232:235]
ds_write_b128 v13, v[216:219] offset:8320
v_mfma_f32_16x16x32_bf16 v[232:235], v[164:167], v[44:47], v[232:235]
v_mfma_f32_16x16x32_bf16 v[236:239], v[148:151], v[112:115], v[236:239]
ds_write_b128 v13, v[220:223] offset:12416
v_mfma_f32_16x16x32_bf16 v[236:239], v[164:167], v[48:51], v[236:239]
v_mfma_f32_16x16x32_bf16 v[240:243], v[152:155], v[56:59], v[240:243]
ds_write_b128 v7, v[224:227] offset:128
v_mfma_f32_16x16x32_bf16 v[240:243], v[168:171], v[36:39], v[240:243]
v_mfma_f32_16x16x32_bf16 v[244:247], v[152:155], v[64:67], v[244:247]
ds_write_b128 v7, v[228:231] offset:4224
v_mfma_f32_16x16x32_bf16 v[244:247], v[168:171], v[40:43], v[244:247]
v_mfma_f32_16x16x32_bf16 v[248:251], v[152:155], v[72:75], v[248:251]
ds_write_b128 v7, v[232:235] offset:8320
v_mfma_f32_16x16x32_bf16 v[248:251], v[168:171], v[44:47], v[248:251]
v_mfma_f32_16x16x32_bf16 v[252:255], v[152:155], v[112:115], v[252:255]
ds_write_b128 v7, v[236:239] offset:12416
v_mfma_f32_16x16x32_bf16 v[252:255], v[168:171], v[48:51], v[252:255]
L_FIN:
s_nop 3
ds_write_b128 v6, v[240:243] offset:0
ds_write_b128 v6, v[244:247] offset:1024
ds_write_b128 v6, v[248:251] offset:2048
s_nop 0
ds_write_b128 v6, v[252:255] offset:3072
v_add_u32 v128, 65536, v16
v_add_u32 v129, 131072, v16
v_add_u32 v130, 65536, v17
v_add_u32 v131, 131072, v17
v_add_u32 v132, 65536, v18
s_waitcnt vmcnt(0)
v_lshlrev_b32 v136, 16, v24
v_and_b32 v137, 0xffff0000, v24
v_lshlrev_b32 v138, 16, v25
v_and_b32 v139, 0xffff0000, v25
v_lshlrev_b32 v140, 16, v26
v_and_b32 v141, 0xffff0000, v26
v_lshlrev_b32 v142, 16, v27
v_and_b32 v143, 0xffff0000, v27
v_lshlrev_b32 v144, 16, v28
v_and_b32 v145, 0xffff0000, v28
v_lshlrev_b32 v146, 16, v29
v_and_b32 v147, 0xffff0000, v29
s_setprio 0
s_cmp_ge_u32 s56, 4
s_waitcnt lgkmcnt(0)
s_barrier
s_cbranch_scc1 L_two
ds_read_b128 v[96:99], v18 offset:0
ds_read_b128 v[100:103], v18 offset:24576
ds_read_b128 v[104:107], v18 offset:49152
ds_read_b128 v[108:111], v132 offset:8192
ds_read_b128 v[112:115], v18 offset:53248
ds_read_b128 v[116:119], v132 offset:12288
ds_read_b128 v[120:123], v18 offset:4096
ds_read_b128 v[124:127], v18 offset:28672
s_waitcnt lgkmcnt(6)
v_pk_add_f32 v[96:97], v[96:97], v[100:101]
v_pk_add_f32 v[98:99], v[98:99], v[102:103]
s_waitcnt lgkmcnt(5)
v_pk_add_f32 v[96:97], v[96:97], v[104:105]
v_pk_add_f32 v[98:99], v[98:99], v[106:107]
s_waitcnt lgkmcnt(4)
v_pk_add_f32 v[96:97], v[96:97], v[108:109]
v_pk_add_f32 v[98:99], v[98:99], v[110:111]
s_waitcnt lgkmcnt(3)
v_pk_add_f32 v[96:97], v[96:97], v[112:113]
v_pk_add_f32 v[98:99], v[98:99], v[114:115]
ds_read_b128 v[32:35], v16 offset:0
s_waitcnt lgkmcnt(3)
v_pk_add_f32 v[96:97], v[96:97], v[116:117]
v_pk_add_f32 v[98:99], v[98:99], v[118:119]
ds_read_b128 v[36:39], v16 offset:24576
v_pk_mul_f32 v[100:101], v[30:31], v[96:97] op_sel_hi:[0,1]
ds_read_b128 v[40:43], v16 offset:49152
v_pk_mul_f32 v[102:103], v[30:31], v[98:99] op_sel_hi:[0,1]
ds_read_b128 v[44:47], v128 offset:8192
v_exp_f32 v100, v100
ds_read_b128 v[48:51], v129 offset:0
v_exp_f32 v101, v101
ds_read_b128 v[52:55], v129 offset:16384
v_exp_f32 v102, v102
ds_read_b128 v[56:59], v128 offset:32768
v_exp_f32 v103, v103
ds_read_b128 v[60:63], v128 offset:49152
s_waitcnt lgkmcnt(8)
v_pk_add_f32 v[120:121], v[120:121], v[124:125]
v_pk_add_f32 v[122:123], v[122:123], v[126:127]
v_pk_mul_f32 v[120:121], v[120:121], v[96:97]
v_pk_mul_f32 v[122:123], v[122:123], v[98:99]
v_pk_add_f32 v[100:101], v[30:31], v[100:101] op_sel:[1,0]
v_pk_add_f32 v[102:103], v[30:31], v[102:103] op_sel:[1,0]
v_rcp_f32 v100, v100
v_rcp_f32 v101, v101
v_rcp_f32 v102, v102
v_rcp_f32 v103, v103
v_pk_fma_f32 v[144:145], v[120:121], v[100:101], v[144:145]
v_pk_fma_f32 v[146:147], v[122:123], v[102:103], v[146:147]
v_cvt_pk_bf16_f32 v120, v144, v145
v_cvt_pk_bf16_f32 v121, v146, v147
buffer_store_dwordx2 v[120:121], v22, s[24:27], s92 offen sc1
L_join:
s_waitcnt lgkmcnt(6)
v_pk_add_f32 v[32:33], v[32:33], v[36:37]
v_pk_add_f32 v[34:35], v[34:35], v[38:39]
s_waitcnt lgkmcnt(5)
v_pk_add_f32 v[32:33], v[32:33], v[40:41]
v_pk_add_f32 v[34:35], v[34:35], v[42:43]
s_waitcnt lgkmcnt(4)
v_pk_add_f32 v[32:33], v[32:33], v[44:45]
v_pk_add_f32 v[34:35], v[34:35], v[46:47]
s_waitcnt lgkmcnt(3)
v_pk_add_f32 v[32:33], v[32:33], v[48:49]
v_pk_add_f32 v[34:35], v[34:35], v[50:51]
ds_read_b128 v[64:67], v17 offset:0
s_waitcnt lgkmcnt(3)
v_pk_add_f32 v[32:33], v[32:33], v[52:53]
v_pk_add_f32 v[34:35], v[34:35], v[54:55]
ds_read_b128 v[68:71], v17 offset:24576
v_pk_mul_f32 v[36:37], v[30:31], v[32:33] op_sel_hi:[0,1]
ds_read_b128 v[72:75], v17 offset:49152
v_pk_mul_f32 v[38:39], v[30:31], v[34:35] op_sel_hi:[0,1]
ds_read_b128 v[76:79], v130 offset:8192
v_exp_f32 v36, v36
ds_read_b128 v[80:83], v131 offset:0
v_exp_f32 v37, v37
ds_read_b128 v[84:87], v131 offset:16384
v_exp_f32 v38, v38
ds_read_b128 v[88:91], v130 offset:32768
v_exp_f32 v39, v39
ds_read_b128 v[92:95], v130 offset:49152
s_waitcnt lgkmcnt(8)
v_pk_add_f32 v[56:57], v[56:57], v[60:61]
v_pk_add_f32 v[58:59], v[58:59], v[62:63]
v_pk_mul_f32 v[56:57], v[56:57], v[32:33]
v_pk_mul_f32 v[58:59], v[58:59], v[34:35]
v_pk_add_f32 v[36:37], v[30:31], v[36:37] op_sel:[1,0]
v_pk_add_f32 v[38:39], v[30:31], v[38:39] op_sel:[1,0]
v_rcp_f32 v36, v36
v_rcp_f32 v37, v37
v_rcp_f32 v38, v38
v_rcp_f32 v39, v39
v_pk_fma_f32 v[136:137], v[56:57], v[36:37], v[136:137]
v_pk_fma_f32 v[138:139], v[58:59], v[38:39], v[138:139]
v_cvt_pk_bf16_f32 v56, v136, v137
v_cvt_pk_bf16_f32 v57, v138, v139
buffer_store_dwordx2 v[56:57], v20, s[24:27], s92 offen sc1
s_waitcnt lgkmcnt(6)
v_pk_add_f32 v[64:65], v[64:65], v[68:69]
v_pk_add_f32 v[66:67], v[66:67], v[70:71]
s_waitcnt lgkmcnt(5)
v_pk_add_f32 v[64:65], v[64:65], v[72:73]
v_pk_add_f32 v[66:67], v[66:67], v[74:75]
s_waitcnt lgkmcnt(4)
v_pk_add_f32 v[64:65], v[64:65], v[76:77]
v_pk_add_f32 v[66:67], v[66:67], v[78:79]
s_waitcnt lgkmcnt(3)
v_pk_add_f32 v[64:65], v[64:65], v[80:81]
v_pk_add_f32 v[66:67], v[66:67], v[82:83]
s_waitcnt lgkmcnt(2)
v_pk_add_f32 v[64:65], v[64:65], v[84:85]
v_pk_add_f32 v[66:67], v[66:67], v[86:87]
v_pk_mul_f32 v[68:69], v[30:31], v[64:65] op_sel_hi:[0,1]
v_pk_mul_f32 v[70:71], v[30:31], v[66:67] op_sel_hi:[0,1]
v_exp_f32 v68, v68
v_exp_f32 v69, v69
v_exp_f32 v70, v70
v_exp_f32 v71, v71
s_waitcnt lgkmcnt(0)
v_pk_add_f32 v[88:89], v[88:89], v[92:93]
v_pk_add_f32 v[90:91], v[90:91], v[94:95]
v_pk_mul_f32 v[88:89], v[88:89], v[64:65]
v_pk_mul_f32 v[90:91], v[90:91], v[66:67]
v_pk_add_f32 v[68:69], v[30:31], v[68:69] op_sel:[1,0]
v_pk_add_f32 v[70:71], v[30:31], v[70:71] op_sel:[1,0]
v_rcp_f32 v68, v68
v_rcp_f32 v69, v69
v_rcp_f32 v70, v70
v_rcp_f32 v71, v71
v_pk_fma_f32 v[140:141], v[88:89], v[68:69], v[140:141]
v_pk_fma_f32 v[142:143], v[90:91], v[70:71], v[142:143]
v_cvt_pk_bf16_f32 v88, v140, v141
v_cvt_pk_bf16_f32 v89, v142, v143
buffer_store_dwordx2 v[88:89], v21, s[24:27], s92 offen sc1
L_done:
L_end:
s_endpgm
L_two:
ds_read_b128 v[32:35], v16 offset:0
ds_read_b128 v[36:39], v16 offset:24576
ds_read_b128 v[40:43], v16 offset:49152
ds_read_b128 v[44:47], v128 offset:8192
ds_read_b128 v[48:51], v129 offset:0
ds_read_b128 v[52:55], v129 offset:16384
ds_read_b128 v[56:59], v128 offset:32768
ds_read_b128 v[60:63], v128 offset:49152
s_branch L_join
L_G0A:
s_and_b32 s86, s81, 1
s_lshr_b32 s87, s81, 1
v_lshrrev_b32 v6, 1, v2
v_xor_b32 v6, v6, v1
v_lshlrev_b32 v6, 4, v6
v_lshl_add_u32 v6, v2, 7, v6
v_lshrrev_b32 v7, 3, v2
v_mul_u32_u24 v7, 9216, v7
s_mul_i32 s60, s86, 5120
s_add_u32 s60, s60, 98304
v_add3_u32 v12, s60, v6, v7
v_xor_b32 v13, 64, v12
s_mul_i32 s61, s58, 160
s_mul_i32 s62, s87, 80
s_add_u32 s61, s61, s62
s_lshl_b32 s62, s59, 7
s_sub_u32 s83, s61, s62
v_lshl_add_u32 v72, v4, 3, s83
v_add_u32 v73, 40, v72
v_and_b32 v6, 1, v4
v_mul_u32_u24 v6, 40, v6
v_add3_u32 v75, v6, s83, 32
v_lshrrev_b32 v6, 1, v4
v_lshl_add_u32 v74, v6, 8, v75
v_lshrrev_b32 v6, 7, v72
v_mad_u32_u24 v6, v1, 24, v6
v_lshlrev_b32 v6, 10, v6
v_lshl_add_u32 v6, v3, 7, v6
v_bfe_u32 v7, v72, 5, 2
v_xor_b32 v7, v7, v5
v_lshl_add_u32 v6, v7, 5, v6
v_and_b32 v7, 31, v72
v_add_u32 v8, v6, v7
v_lshrrev_b32 v6, 7, v73
v_mad_u32_u24 v6, v1, 24, v6
v_lshlrev_b32 v6, 10, v6
v_lshl_add_u32 v6, v3, 7, v6
v_bfe_u32 v7, v73, 5, 2
v_xor_b32 v7, v7, v5
v_lshl_add_u32 v6, v7, 5, v6
v_and_b32 v7, 31, v73
v_add_u32 v9, v6, v7
v_lshrrev_b32 v6, 7, v74
v_mad_u32_u24 v6, v1, 24, v6
v_lshlrev_b32 v6, 10, v6
v_lshl_add_u32 v6, v3, 7, v6
v_bfe_u32 v7, v74, 5, 2
v_xor_b32 v7, v7, v5
v_lshl_add_u32 v6, v7, 5, v6
v_and_b32 v7, 31, v74
v_add_u32 v10, v6, v7
v_lshrrev_b32 v6, 7, v75
v_mad_u32_u24 v6, v1, 24, v6
v_lshlrev_b32 v6, 10, v6
v_lshl_add_u32 v6, v3, 7, v6
v_bfe_u32 v7, v75, 5, 2
v_xor_b32 v7, v7, v5
v_lshl_add_u32 v6, v7, 5, v6
v_and_b32 v7, 31, v75
v_add_u32 v11, v6, v7
v_lshl_add_u32 v72, v1, 3, s83
v_add_u32 v73, 40, v72
v_and_b32 v6, 1, v1
v_mul_u32_u24 v6, 40, v6
v_add3_u32 v75, v6, s83, 32
v_lshrrev_b32 v6, 1, v1
v_lshl_add_u32 v74, v6, 8, v75
v_lshlrev_b32 v72, 1, v72
v_add_u32 v72, 141312, v72
v_lshlrev_b32 v73, 1, v73
v_add_u32 v73, 141312, v73
v_lshlrev_b32 v74, 1, v74
v_add_u32 v74, 141312, v74
v_lshl_add_u32 v76, v3, 3, s83
v_add_u32 v77, 40, v76
v_and_b32 v6, 1, v3
v_mul_u32_u24 v6, 40, v6
v_add3_u32 v79, v6, s83, 32
v_lshrrev_b32 v6, 1, v3
v_lshl_add_u32 v78, v6, 8, v79
v_lshlrev_b32 v76, 1, v76
v_lshl_add_u32 v76, v4, 2, v76
v_add_u32 v76, 142336, v76
v_lshlrev_b32 v77, 1, v77
v_lshl_add_u32 v77, v4, 2, v77
v_add_u32 v77, 142336, v77
v_lshlrev_b32 v79, 1, v79
v_lshl_add_u32 v79, v4, 2, v79
v_add_u32 v79, 142336, v79
s_lshl_b32 s61, s86, 7
s_add_u32 s61, s61, 142848
v_lshl_add_u32 v75, v2, 3, s61
s_lshl_b32 s61, s86, 6
s_add_u32 s61, s61, 145408
v_lshl_add_u32 v78, v1, 4, s61
v_mov_b32 v7, 0xff61b1e6
v_lshlrev_b32 v95, 2, v1
v_sub_u32 v95, v2, v95
v_subrev_u32 v6, 0, v95
v_cmp_gt_u32 vcc, 8, v6
v_add_u32 v3, 16, v6
s_nop 0
v_cndmask_b32_e64 v80, v7, 0, vcc
v_cmp_gt_u32 vcc, 8, v3
v_ashrrev_i32 v6, 31, v6
s_nop 0
v_cndmask_b32_e64 v84, v7, 0, vcc
v_and_b32 v88, 0xffff, v6
v_subrev_u32 v6, 1, v95
v_cmp_gt_u32 vcc, 8, v6
v_add_u32 v3, 16, v6
s_nop 0
v_cndmask_b32_e64 v81, v7, 0, vcc
v_cmp_gt_u32 vcc, 8, v3
v_ashrrev_i32 v6, 31, v6
s_nop 0
v_cndmask_b32_e64 v85, v7, 0, vcc
v_and_b32 v6, 0xffff0000, v6
v_or_b32 v88, v88, v6
v_subrev_u32 v6, 2, v95
v_cmp_gt_u32 vcc, 8, v6
v_add_u32 v3, 16, v6
s_nop 0
v_cndmask_b32_e64 v82, v7, 0, vcc
v_cmp_gt_u32 vcc, 8, v3
v_ashrrev_i32 v6, 31, v6
s_nop 0
v_cndmask_b32_e64 v86, v7, 0, vcc
v_and_b32 v89, 0xffff, v6
v_subrev_u32 v6, 3, v95
v_cmp_gt_u32 vcc, 8, v6
v_add_u32 v3, 16, v6
s_nop 0
v_cndmask_b32_e64 v83, v7, 0, vcc
v_cmp_gt_u32 vcc, 8, v3
v_ashrrev_i32 v6, 31, v6
s_nop 0
v_cndmask_b32_e64 v87, v7, 0, vcc
v_and_b32 v6, 0xffff0000, v6
v_or_b32 v89, v89, v6
v_not_b32 v90, v88
v_not_b32 v91, v89
v_cmp_eq_u32 vcc, 0, v1
s_nop 1
v_cndmask_b32_e64 v92, 0, -1, vcc
v_cmp_eq_u32 vcc, 1, v1
s_nop 1
v_cndmask_b32_e64 v93, 0, -1, vcc
v_or_b32 v94, v92, v93
s_lshl_b32 s61, s58, 1
s_add_u32 s61, s61, s87
s_lshl_b32 s88, s61, 12
s_cmp_eq_u32 s80, 0
s_cselect_b32 s62, 0, 7
s_add_u32 s62, s62, s57
s_lshr_b32 s62, s62, 5
s_lshl_b32 s62, s62, 7
s_add_u32 s79, s62, 286720
s_add_u32 s62, s57, 79
s_lshr_b32 s62, s62, 5
s_min_u32 s62, s62, 31
s_lshl_b32 s62, s62, 7
s_add_u32 s76, s62, 286720
s_lshr_b32 s62, s61, 2
s_add_u32 s62, s62, 16
s_lshl_b32 s62, s62, 12
s_and_b32 s61, s61, 3
s_lshl_b32 s61, s61, 8
s_add_u32 s84, s62, s61
s_and_b32 s61, s57, 15
s_lshr_b32 s62, s57, 4
s_add_u32 s63, s57, 7
s_lshr_b32 s63, s63, 4
s_cmp_eq_u32 s80, 0
s_cselect_b32 s63, -1, s63
s_lshl_b32 s64, s86, 10
s_add_u32 s64, s64, 4194304
v_add_u32 v4, s61, v2
v_and_b32 v5, 15, v4
v_lshlrev_b32 v5, 4, v5
v_lshl_add_u32 v15, v1, 8, v5
v_add_u32 v15, s88, v15
v_lshl_add_u32 v95, v1, 3, v5
v_add_u32 v95, s84, v95
v_mov_b32 v3, 1073741824
v_bfi_b32 v95, v94, v95, v3
v_subrev_u32 v7, 16, v4
v_ashrrev_i32 v7, 31, v7
s_lshr_b32 s65, s62, 1
s_mul_i32 s65, s65, 303104
s_and_b32 s66, s62, 1
s_lshl_b32 s66, s66, 11
s_add_u32 s65, s65, s66
s_add_u32 s68, s65, s64
s_cmp_eq_u32 s62, s63
s_cselect_b32 s65, 10485760, 0
s_add_u32 s68, s68, s65
s_cmp_lt_i32 s62, s63
s_cselect_b32 s68, 1073741824, s68
s_add_u32 s62, s62, 1
s_lshr_b32 s65, s62, 1
s_mul_i32 s65, s65, 303104
s_and_b32 s66, s62, 1
s_lshl_b32 s66, s66, 11
s_add_u32 s65, s65, s66
s_add_u32 s69, s65, s64
s_cmp_eq_u32 s62, s63
s_cselect_b32 s65, 10485760, 0
s_add_u32 s69, s69, s65
s_add_u32 s62, s62, 1
s_lshr_b32 s65, s62, 1
s_mul_i32 s65, s65, 303104
s_and_b32 s66, s62, 1
s_lshl_b32 s66, s66, 11
s_add_u32 s65, s65, s66
s_add_u32 s70, s65, s64
s_add_u32 s62, s62, 1
s_lshr_b32 s65, s62, 1
s_mul_i32 s65, s65, 303104
s_and_b32 s66, s62, 1
s_lshl_b32 s66, s66, 11
s_add_u32 s65, s65, s66
s_add_u32 s71, s65, s64
s_add_u32 s62, s62, 1
s_lshr_b32 s65, s62, 1
s_mul_i32 s65, s65, 303104
s_and_b32 s66, s62, 1
s_lshl_b32 s66, s66, 11
s_add_u32 s65, s65, s66
s_add_u32 s72, s65, s64
s_add_u32 s62, s62, 1
s_lshr_b32 s65, s62, 1
s_mul_i32 s65, s65, 303104
s_and_b32 s66, s62, 1
s_lshl_b32 s66, s66, 11
s_add_u32 s65, s65, s66
s_add_u32 s73, s65, s64
v_mov_b64 v[96:97], 0
v_mov_b64 v[98:99], 0
v_mov_b64 v[100:101], 0
v_mov_b64 v[102:103], 0
v_mov_b64 v[104:105], 0
v_mov_b64 v[106:107], 0
v_mov_b64 v[108:109], 0
v_mov_b64 v[110:111], 0
v_mov_b64 v[112:113], 0
v_mov_b64 v[114:115], 0
v_mov_b64 v[116:117], 0
v_mov_b64 v[118:119], 0
v_mov_b64 v[120:121], 0
v_mov_b64 v[122:123], 0
v_mov_b64 v[124:125], 0
v_mov_b64 v[126:127], 0
v_mov_b64 v[128:129], 0
v_mov_b64 v[130:131], 0
v_mov_b64 v[132:133], 0
v_mov_b64 v[134:135], 0
v_mov_b64 v[136:137], 0
v_mov_b64 v[138:139], 0
v_mov_b64 v[140:141], 0
v_mov_b64 v[142:143], 0
v_mov_b64 v[144:145], 0
v_mov_b64 v[146:147], 0
v_mov_b64 v[148:149], 0
v_mov_b64 v[150:151], 0
v_mov_b64 v[152:153], 0
v_mov_b64 v[154:155], 0
v_mov_b64 v[156:157], 0
v_mov_b64 v[158:159], 0
v_mov_b64 v[160:161], 0
v_mov_b64 v[162:163], 0
v_mov_b64 v[164:165], 0
v_mov_b64 v[166:167], 0
v_mov_b64 v[168:169], 0
v_mov_b64 v[170:171], 0
v_mov_b64 v[172:173], 0
v_mov_b64 v[174:175], 0
v_mov_b64 v[176:177], 0
v_mov_b64 v[178:179], 0
v_mov_b64 v[180:181], 0
v_mov_b64 v[182:183], 0
v_mov_b64 v[184:185], 0
v_mov_b64 v[186:187], 0
v_mov_b64 v[188:189], 0
v_mov_b64 v[190:191], 0
v_mov_b64 v[192:193], 0
v_mov_b64 v[194:195], 0
v_mov_b64 v[196:197], 0
v_mov_b64 v[198:199], 0
v_mov_b64 v[200:201], 0
v_mov_b64 v[202:203], 0
v_mov_b64 v[204:205], 0
v_mov_b64 v[206:207], 0
v_mov_b64 v[208:209], 0
v_mov_b64 v[210:211], 0
v_mov_b64 v[212:213], 0
v_mov_b64 v[214:215], 0
v_mov_b64 v[216:217], 0
v_mov_b64 v[218:219], 0
v_mov_b64 v[220:221], 0
v_mov_b64 v[222:223], 0
v_mov_b64 v[224:225], 0
v_mov_b64 v[226:227], 0
v_mov_b64 v[228:229], 0
v_mov_b64 v[230:231], 0
v_mov_b64 v[232:233], 0
v_mov_b64 v[234:235], 0
v_mov_b64 v[236:237], 0
v_mov_b64 v[238:239], 0
v_mov_b64 v[240:241], 0
v_mov_b64 v[242:243], 0
v_mov_b64 v[244:245], 0
v_mov_b64 v[246:247], 0
v_mov_b64 v[248:249], 0
v_mov_b64 v[250:251], 0
v_mov_b64 v[252:253], 0
v_mov_b64 v[254:255], 0
s_waitcnt vmcnt(0)
s_barrier
ds_read_b128 v[16:19], v12 offset:0
ds_read_b128 v[20:23], v12 offset:1024
ds_read_b128 v[24:27], v12 offset:2048
ds_read_b128 v[28:31], v12 offset:3072
ds_read_b128 v[32:35], v12 offset:4096
ds_read_b64_tr_b16 v[56:57], v8 offset:0
ds_read_b64_tr_b16 v[58:59], v8 offset:512
ds_read_b64_tr_b16 v[60:61], v9 offset:0
ds_read_b64_tr_b16 v[62:63], v9 offset:512
s_mov_b32 s60, 5
.p2align 6
L_loopA:
s_waitcnt lgkmcnt(2)
v_mfma_f32_16x16x32_bf16 v[96:99], v[56:59], v[16:19], v[96:99]
ds_read_b64_tr_b16 v[64:65], v8 offset:2048
v_mfma_f32_16x16x32_bf16 v[100:103], v[56:59], v[20:23], v[100:103]
ds_read_b64_tr_b16 v[66:67], v8 offset:2560
v_mfma_f32_16x16x32_bf16 v[104:107], v[56:59], v[24:27], v[104:107]
v_mfma_f32_16x16x32_bf16 v[108:111], v[56:59], v[28:31], v[108:111]
v_mfma_f32_16x16x32_bf16 v[112:115], v[56:59], v[32:35], v[112:115]
s_waitcnt lgkmcnt(2)
v_mfma_f32_16x16x32_bf16 v[132:135], v[60:63], v[32:35], v[132:135]
ds_read_b64_tr_b16 v[68:69], v9 offset:2048
v_mfma_f32_16x16x32_bf16 v[128:131], v[60:63], v[28:31], v[128:131]
ds_read_b64_tr_b16 v[70:71], v9 offset:2560
v_mfma_f32_16x16x32_bf16 v[124:127], v[60:63], v[24:27], v[124:127]
v_mfma_f32_16x16x32_bf16 v[120:123], v[60:63], v[20:23], v[120:123]
v_mfma_f32_16x16x32_bf16 v[116:119], v[60:63], v[16:19], v[116:119]
s_waitcnt lgkmcnt(2)
v_mfma_f32_16x16x32_bf16 v[136:139], v[64:67], v[16:19], v[136:139]
ds_read_b64_tr_b16 v[56:57], v10 offset:0
v_mfma_f32_16x16x32_bf16 v[140:143], v[64:67], v[20:23], v[140:143]
ds_read_b64_tr_b16 v[58:59], v10 offset:512
v_mfma_f32_16x16x32_bf16 v[144:147], v[64:67], v[24:27], v[144:147]
v_mfma_f32_16x16x32_bf16 v[148:151], v[64:67], v[28:31], v[148:151]
v_mfma_f32_16x16x32_bf16 v[152:155], v[64:67], v[32:35], v[152:155]
s_waitcnt lgkmcnt(2)
v_mfma_f32_16x16x32_bf16 v[172:175], v[68:71], v[32:35], v[172:175]
s_barrier
v_mfma_f32_16x16x32_bf16 v[168:171], v[68:71], v[28:31], v[168:171]
ds_read_b64_tr_b16 v[60:61], v8 offset:4096
v_mfma_f32_16x16x32_bf16 v[164:167], v[68:71], v[24:27], v[164:167]
ds_read_b64_tr_b16 v[62:63], v8 offset:4608
v_mfma_f32_16x16x32_bf16 v[160:163], v[68:71], v[20:23], v[160:163]
v_mfma_f32_16x16x32_bf16 v[156:159], v[68:71], v[16:19], v[156:159]
s_waitcnt lgkmcnt(2)
v_mfma_f32_16x16x32_bf16 v[176:179], v[56:59], v[16:19], v[176:179]
ds_read_b64_tr_b16 v[64:65], v9 offset:4096
v_mfma_f32_16x16x32_bf16 v[180:183], v[56:59], v[20:23], v[180:183]
ds_read_b64_tr_b16 v[66:67], v9 offset:4608
v_mfma_f32_16x16x32_bf16 v[184:187], v[56:59], v[24:27], v[184:187]
ds_read_b128 v[36:39], v13 offset:0
v_mfma_f32_16x16x32_bf16 v[188:191], v[56:59], v[28:31], v[188:191]
v_mfma_f32_16x16x32_bf16 v[192:195], v[56:59], v[32:35], v[192:195]
s_waitcnt lgkmcnt(3)
v_mfma_f32_16x16x32_bf16 v[212:215], v[32:35], v[60:63], v[212:215]
ds_read_b64_tr_b16 v[68:69], v11 offset:4096
v_mfma_f32_16x16x32_bf16 v[208:211], v[28:31], v[60:63], v[208:211]
ds_read_b64_tr_b16 v[70:71], v11 offset:4608
v_mfma_f32_16x16x32_bf16 v[204:207], v[24:27], v[60:63], v[204:207]
ds_read_b128 v[40:43], v13 offset:1024
v_mfma_f32_16x16x32_bf16 v[200:203], v[20:23], v[60:63], v[200:203]
v_mfma_f32_16x16x32_bf16 v[196:199], v[16:19], v[60:63], v[196:199]
s_waitcnt lgkmcnt(4)
v_mfma_f32_16x16x32_bf16 v[216:219], v[16:19], v[64:67], v[216:219]
ds_read_b64_tr_b16 v[56:57], v8 offset:6144
v_mfma_f32_16x16x32_bf16 v[220:223], v[20:23], v[64:67], v[220:223]
ds_read_b64_tr_b16 v[58:59], v8 offset:6656
v_mfma_f32_16x16x32_bf16 v[224:227], v[24:27], v[64:67], v[224:227]
ds_read_b128 v[44:47], v13 offset:2048
v_mfma_f32_16x16x32_bf16 v[228:231], v[28:31], v[64:67], v[228:231]
ds_read_b128 v[48:51], v13 offset:3072
v_mfma_f32_16x16x32_bf16 v[232:235], v[32:35], v[64:67], v[232:235]
ds_read_b128 v[52:55], v13 offset:4096
s_waitcnt lgkmcnt(6)
v_mfma_f32_16x16x32_bf16 v[252:255], v[32:35], v[68:71], v[252:255]
ds_read_b64_tr_b16 v[60:61], v9 offset:6144
v_mfma_f32_16x16x32_bf16 v[248:251], v[28:31], v[68:71], v[248:251]
ds_read_b64_tr_b16 v[62:63], v9 offset:6656
v_mfma_f32_16x16x32_bf16 v[244:247], v[24:27], v[68:71], v[244:247]
v_mfma_f32_16x16x32_bf16 v[240:243], v[20:23], v[68:71], v[240:243]
v_mfma_f32_16x16x32_bf16 v[236:239], v[16:19], v[68:71], v[236:239]
s_waitcnt lgkmcnt(2)
v_mfma_f32_16x16x32_bf16 v[96:99], v[56:59], v[36:39], v[96:99]
ds_read_b64_tr_b16 v[64:65], v8 offset:8192
v_mfma_f32_16x16x32_bf16 v[100:103], v[56:59], v[40:43], v[100:103]
ds_read_b64_tr_b16 v[66:67], v8 offset:8704
v_mfma_f32_16x16x32_bf16 v[104:107], v[56:59], v[44:47], v[104:107]
v_mfma_f32_16x16x32_bf16 v[108:111], v[56:59], v[48:51], v[108:111]
v_mfma_f32_16x16x32_bf16 v[112:115], v[56:59], v[52:55], v[112:115]
s_waitcnt lgkmcnt(2)
v_mfma_f32_16x16x32_bf16 v[132:135], v[60:63], v[52:55], v[132:135]
ds_read_b64_tr_b16 v[68:69], v9 offset:8192
v_mfma_f32_16x16x32_bf16 v[128:131], v[60:63], v[48:51], v[128:131]
ds_read_b64_tr_b16 v[70:71], v9 offset:8704
v_mfma_f32_16x16x32_bf16 v[124:127], v[60:63], v[44:47], v[124:127]
v_mfma_f32_16x16x32_bf16 v[120:123], v[60:63], v[40:43], v[120:123]
v_mfma_f32_16x16x32_bf16 v[116:119], v[60:63], v[36:39], v[116:119]
s_waitcnt lgkmcnt(2)
v_mfma_f32_16x16x32_bf16 v[136:139], v[64:67], v[36:39], v[136:139]
ds_read_b64_tr_b16 v[56:57], v10 offset:6144
v_mfma_f32_16x16x32_bf16 v[140:143], v[64:67], v[40:43], v[140:143]
ds_read_b64_tr_b16 v[58:59], v10 offset:6656
v_mfma_f32_16x16x32_bf16 v[144:147], v[64:67], v[44:47], v[144:147]
v_mfma_f32_16x16x32_bf16 v[148:151], v[64:67], v[48:51], v[148:151]
v_mfma_f32_16x16x32_bf16 v[152:155], v[64:67], v[52:55], v[152:155]
s_waitcnt lgkmcnt(2)
v_mfma_f32_16x16x32_bf16 v[172:175], v[68:71], v[52:55], v[172:175]
s_barrier
v_mfma_f32_16x16x32_bf16 v[168:171], v[68:71], v[48:51], v[168:171]
ds_read_b64_tr_b16 v[60:61], v8 offset:10240
v_mfma_f32_16x16x32_bf16 v[164:167], v[68:71], v[44:47], v[164:167]
ds_read_b64_tr_b16 v[62:63], v8 offset:10752
v_mfma_f32_16x16x32_bf16 v[160:163], v[68:71], v[40:43], v[160:163]
v_mfma_f32_16x16x32_bf16 v[156:159], v[68:71], v[36:39], v[156:159]
s_waitcnt lgkmcnt(2)
v_mfma_f32_16x16x32_bf16 v[176:179], v[56:59], v[36:39], v[176:179]
ds_read_b64_tr_b16 v[64:65], v9 offset:10240
v_mfma_f32_16x16x32_bf16 v[180:183], v[56:59], v[40:43], v[180:183]
ds_read_b64_tr_b16 v[66:67], v9 offset:10752
v_mfma_f32_16x16x32_bf16 v[184:187], v[56:59], v[44:47], v[184:187]
ds_read_b128 v[16:19], v12 offset:20480
v_mfma_f32_16x16x32_bf16 v[188:191], v[56:59], v[48:51], v[188:191]
v_mfma_f32_16x16x32_bf16 v[192:195], v[56:59], v[52:55], v[192:195]
s_waitcnt lgkmcnt(3)
v_mfma_f32_16x16x32_bf16 v[212:215], v[52:55], v[60:63], v[212:215]
ds_read_b64_tr_b16 v[68:69], v11 offset:10240
v_mfma_f32_16x16x32_bf16 v[208:211], v[48:51], v[60:63], v[208:211]
ds_read_b64_tr_b16 v[70:71], v11 offset:10752
v_mfma_f32_16x16x32_bf16 v[204:207], v[44:47], v[60:63], v[204:207]
ds_read_b128 v[20:23], v12 offset:21504
v_mfma_f32_16x16x32_bf16 v[200:203], v[40:43], v[60:63], v[200:203]
v_mfma_f32_16x16x32_bf16 v[196:199], v[36:39], v[60:63], v[196:199]
s_waitcnt lgkmcnt(4)
v_mfma_f32_16x16x32_bf16 v[216:219], v[36:39], v[64:67], v[216:219]
ds_read_b64_tr_b16 v[56:57], v8 offset:12288
v_mfma_f32_16x16x32_bf16 v[220:223], v[40:43], v[64:67], v[220:223]
ds_read_b64_tr_b16 v[58:59], v8 offset:12800
v_mfma_f32_16x16x32_bf16 v[224:227], v[44:47], v[64:67], v[224:227]
ds_read_b128 v[24:27], v12 offset:22528
v_mfma_f32_16x16x32_bf16 v[228:231], v[48:51], v[64:67], v[228:231]
ds_read_b128 v[28:31], v12 offset:23552
v_mfma_f32_16x16x32_bf16 v[232:235], v[52:55], v[64:67], v[232:235]
ds_read_b128 v[32:35], v12 offset:24576
s_waitcnt lgkmcnt(6)
v_mfma_f32_16x16x32_bf16 v[252:255], v[52:55], v[68:71], v[252:255]
ds_read_b64_tr_b16 v[60:61], v9 offset:12288
v_mfma_f32_16x16x32_bf16 v[248:251], v[48:51], v[68:71], v[248:251]
ds_read_b64_tr_b16 v[62:63], v9 offset:12800
v_mfma_f32_16x16x32_bf16 v[244:247], v[44:47], v[68:71], v[244:247]
v_mfma_f32_16x16x32_bf16 v[240:243], v[40:43], v[68:71], v[240:243]
v_mfma_f32_16x16x32_bf16 v[236:239], v[36:39], v[68:71], v[236:239]
s_waitcnt lgkmcnt(2)
v_mfma_f32_16x16x32_bf16 v[96:99], v[56:59], v[16:19], v[96:99]
ds_read_b64_tr_b16 v[64:65], v8 offset:14336
v_mfma_f32_16x16x32_bf16 v[100:103], v[56:59], v[20:23], v[100:103]
ds_read_b64_tr_b16 v[66:67], v8 offset:14848
v_mfma_f32_16x16x32_bf16 v[104:107], v[56:59], v[24:27], v[104:107]
v_mfma_f32_16x16x32_bf16 v[108:111], v[56:59], v[28:31], v[108:111]
v_mfma_f32_16x16x32_bf16 v[112:115], v[56:59], v[32:35], v[112:115]
s_waitcnt lgkmcnt(2)
v_mfma_f32_16x16x32_bf16 v[132:135], v[60:63], v[32:35], v[132:135]
ds_read_b64_tr_b16 v[68:69], v9 offset:14336
v_mfma_f32_16x16x32_bf16 v[128:131], v[60:63], v[28:31], v[128:131]
ds_read_b64_tr_b16 v[70:71], v9 offset:14848
v_mfma_f32_16x16x32_bf16 v[124:127], v[60:63], v[24:27], v[124:127]
v_mfma_f32_16x16x32_bf16 v[120:123], v[60:63], v[20:23], v[120:123]
v_mfma_f32_16x16x32_bf16 v[116:119], v[60:63], v[16:19], v[116:119]
s_waitcnt lgkmcnt(2)
v_mfma_f32_16x16x32_bf16 v[136:139], v[64:67], v[16:19], v[136:139]
ds_read_b64_tr_b16 v[56:57], v10 offset:12288
v_mfma_f32_16x16x32_bf16 v[140:143], v[64:67], v[20:23], v[140:143]
ds_read_b64_tr_b16 v[58:59], v10 offset:12800
v_mfma_f32_16x16x32_bf16 v[144:147], v[64:67], v[24:27], v[144:147]
v_mfma_f32_16x16x32_bf16 v[148:151], v[64:67], v[28:31], v[148:151]
v_mfma_f32_16x16x32_bf16 v[152:155], v[64:67], v[32:35], v[152:155]
s_waitcnt lgkmcnt(2)
v_mfma_f32_16x16x32_bf16 v[172:175], v[68:71], v[32:35], v[172:175]
s_barrier
v_mfma_f32_16x16x32_bf16 v[168:171], v[68:71], v[28:31], v[168:171]
ds_read_b64_tr_b16 v[60:61], v8 offset:16384
v_mfma_f32_16x16x32_bf16 v[164:167], v[68:71], v[24:27], v[164:167]
ds_read_b64_tr_b16 v[62:63], v8 offset:16896
v_mfma_f32_16x16x32_bf16 v[160:163], v[68:71], v[20:23], v[160:163]
v_mfma_f32_16x16x32_bf16 v[156:159], v[68:71], v[16:19], v[156:159]
s_waitcnt lgkmcnt(2)
v_mfma_f32_16x16x32_bf16 v[176:179], v[56:59], v[16:19], v[176:179]
ds_read_b64_tr_b16 v[64:65], v9 offset:16384
v_mfma_f32_16x16x32_bf16 v[180:183], v[56:59], v[20:23], v[180:183]
ds_read_b64_tr_b16 v[66:67], v9 offset:16896
v_mfma_f32_16x16x32_bf16 v[184:187], v[56:59], v[24:27], v[184:187]
ds_read_b128 v[36:39], v13 offset:20480
v_mfma_f32_16x16x32_bf16 v[188:191], v[56:59], v[28:31], v[188:191]
v_mfma_f32_16x16x32_bf16 v[192:195], v[56:59], v[32:35], v[192:195]
s_waitcnt lgkmcnt(3)
v_mfma_f32_16x16x32_bf16 v[212:215], v[32:35], v[60:63], v[212:215]
ds_read_b64_tr_b16 v[68:69], v11 offset:16384
v_mfma_f32_16x16x32_bf16 v[208:211], v[28:31], v[60:63], v[208:211]
ds_read_b64_tr_b16 v[70:71], v11 offset:16896
v_mfma_f32_16x16x32_bf16 v[204:207], v[24:27], v[60:63], v[204:207]
ds_read_b128 v[40:43], v13 offset:21504
v_mfma_f32_16x16x32_bf16 v[200:203], v[20:23], v[60:63], v[200:203]
v_mfma_f32_16x16x32_bf16 v[196:199], v[16:19], v[60:63], v[196:199]
s_waitcnt lgkmcnt(4)
v_mfma_f32_16x16x32_bf16 v[216:219], v[16:19], v[64:67], v[216:219]
ds_read_b64_tr_b16 v[56:57], v8 offset:18432
v_mfma_f32_16x16x32_bf16 v[220:223], v[20:23], v[64:67], v[220:223]
ds_read_b64_tr_b16 v[58:59], v8 offset:18944
v_mfma_f32_16x16x32_bf16 v[224:227], v[24:27], v[64:67], v[224:227]
ds_read_b128 v[44:47], v13 offset:22528
v_mfma_f32_16x16x32_bf16 v[228:231], v[28:31], v[64:67], v[228:231]
ds_read_b128 v[48:51], v13 offset:23552
v_mfma_f32_16x16x32_bf16 v[232:235], v[32:35], v[64:67], v[232:235]
ds_read_b128 v[52:55], v13 offset:24576
s_waitcnt lgkmcnt(6)
v_mfma_f32_16x16x32_bf16 v[252:255], v[32:35], v[68:71], v[252:255]
ds_read_b64_tr_b16 v[60:61], v9 offset:18432
v_mfma_f32_16x16x32_bf16 v[248:251], v[28:31], v[68:71], v[248:251]
ds_read_b64_tr_b16 v[62:63], v9 offset:18944
v_mfma_f32_16x16x32_bf16 v[244:247], v[24:27], v[68:71], v[244:247]
v_mfma_f32_16x16x32_bf16 v[240:243], v[20:23], v[68:71], v[240:243]
v_mfma_f32_16x16x32_bf16 v[236:239], v[16:19], v[68:71], v[236:239]
s_waitcnt lgkmcnt(2)
v_mfma_f32_16x16x32_bf16 v[96:99], v[56:59], v[36:39], v[96:99]
ds_read_b64_tr_b16 v[64:65], v8 offset:20480
v_mfma_f32_16x16x32_bf16 v[100:103], v[56:59], v[40:43], v[100:103]
ds_read_b64_tr_b16 v[66:67], v8 offset:20992
v_mfma_f32_16x16x32_bf16 v[104:107], v[56:59], v[44:47], v[104:107]
v_mfma_f32_16x16x32_bf16 v[108:111], v[56:59], v[48:51], v[108:111]
v_mfma_f32_16x16x32_bf16 v[112:115], v[56:59], v[52:55], v[112:115]
s_waitcnt lgkmcnt(2)
v_mfma_f32_16x16x32_bf16 v[132:135], v[60:63], v[52:55], v[132:135]
ds_read_b64_tr_b16 v[68:69], v9 offset:20480
v_mfma_f32_16x16x32_bf16 v[128:131], v[60:63], v[48:51], v[128:131]
ds_read_b64_tr_b16 v[70:71], v9 offset:20992
v_mfma_f32_16x16x32_bf16 v[124:127], v[60:63], v[44:47], v[124:127]
v_mfma_f32_16x16x32_bf16 v[120:123], v[60:63], v[40:43], v[120:123]
v_mfma_f32_16x16x32_bf16 v[116:119], v[60:63], v[36:39], v[116:119]
s_waitcnt lgkmcnt(2)
v_mfma_f32_16x16x32_bf16 v[136:139], v[64:67], v[36:39], v[136:139]
ds_read_b64_tr_b16 v[56:57], v10 offset:18432
v_mfma_f32_16x16x32_bf16 v[140:143], v[64:67], v[40:43], v[140:143]
ds_read_b64_tr_b16 v[58:59], v10 offset:18944
v_mfma_f32_16x16x32_bf16 v[144:147], v[64:67], v[44:47], v[144:147]
v_mfma_f32_16x16x32_bf16 v[148:151], v[64:67], v[48:51], v[148:151]
v_mfma_f32_16x16x32_bf16 v[152:155], v[64:67], v[52:55], v[152:155]
s_waitcnt lgkmcnt(2)
v_mfma_f32_16x16x32_bf16 v[172:175], v[68:71], v[52:55], v[172:175]
s_barrier
v_mfma_f32_16x16x32_bf16 v[168:171], v[68:71], v[48:51], v[168:171]
ds_read_b64_tr_b16 v[60:61], v8 offset:22528
v_mfma_f32_16x16x32_bf16 v[164:167], v[68:71], v[44:47], v[164:167]
ds_read_b64_tr_b16 v[62:63], v8 offset:23040
v_mfma_f32_16x16x32_bf16 v[160:163], v[68:71], v[40:43], v[160:163]
v_mfma_f32_16x16x32_bf16 v[156:159], v[68:71], v[36:39], v[156:159]
s_waitcnt lgkmcnt(2)
v_mfma_f32_16x16x32_bf16 v[176:179], v[56:59], v[36:39], v[176:179]
ds_read_b64_tr_b16 v[64:65], v9 offset:22528
v_mfma_f32_16x16x32_bf16 v[180:183], v[56:59], v[40:43], v[180:183]
ds_read_b64_tr_b16 v[66:67], v9 offset:23040
v_mfma_f32_16x16x32_bf16 v[184:187], v[56:59], v[44:47], v[184:187]
ds_read_b128 v[16:19], v12 offset:0
v_mfma_f32_16x16x32_bf16 v[188:191], v[56:59], v[48:51], v[188:191]
v_mfma_f32_16x16x32_bf16 v[192:195], v[56:59], v[52:55], v[192:195]
s_waitcnt lgkmcnt(3)
v_mfma_f32_16x16x32_bf16 v[212:215], v[52:55], v[60:63], v[212:215]
ds_read_b64_tr_b16 v[68:69], v11 offset:22528
v_mfma_f32_16x16x32_bf16 v[208:211], v[48:51], v[60:63], v[208:211]
ds_read_b64_tr_b16 v[70:71], v11 offset:23040
v_mfma_f32_16x16x32_bf16 v[204:207], v[44:47], v[60:63], v[204:207]
ds_read_b128 v[20:23], v12 offset:1024
v_mfma_f32_16x16x32_bf16 v[200:203], v[40:43], v[60:63], v[200:203]
v_mfma_f32_16x16x32_bf16 v[196:199], v[36:39], v[60:63], v[196:199]
s_waitcnt lgkmcnt(4)
v_mfma_f32_16x16x32_bf16 v[216:219], v[36:39], v[64:67], v[216:219]
ds_read_b64_tr_b16 v[56:57], v8 offset:0
v_mfma_f32_16x16x32_bf16 v[220:223], v[40:43], v[64:67], v[220:223]
ds_read_b64_tr_b16 v[58:59], v8 offset:512
v_mfma_f32_16x16x32_bf16 v[224:227], v[44:47], v[64:67], v[224:227]
ds_read_b128 v[24:27], v12 offset:2048
v_mfma_f32_16x16x32_bf16 v[228:231], v[48:51], v[64:67], v[228:231]
ds_read_b128 v[28:31], v12 offset:3072
v_mfma_f32_16x16x32_bf16 v[232:235], v[52:55], v[64:67], v[232:235]
ds_read_b128 v[32:35], v12 offset:4096
s_waitcnt lgkmcnt(6)
v_mfma_f32_16x16x32_bf16 v[252:255], v[52:55], v[68:71], v[252:255]
ds_read_b64_tr_b16 v[60:61], v9 offset:0
v_mfma_f32_16x16x32_bf16 v[248:251], v[48:51], v[68:71], v[248:251]
ds_read_b64_tr_b16 v[62:63], v9 offset:512
v_mfma_f32_16x16x32_bf16 v[244:247], v[44:47], v[68:71], v[244:247]
v_mfma_f32_16x16x32_bf16 v[240:243], v[40:43], v[68:71], v[240:243]
v_mfma_f32_16x16x32_bf16 v[236:239], v[36:39], v[68:71], v[236:239]
s_sub_u32 s60, s60, 1
s_cmp_lg_u32 s60, 0
s_cbranch_scc1 L_loopA
s_waitcnt lgkmcnt(0)
s_setprio 3
s_barrier
ds_read_b64 v[16:17], v75
ds_read_b128 v[28:31], v72 offset:0
ds_read_b128 v[32:35], v73 offset:0
ds_read_b128 v[36:39], v72 offset:512
ds_read_b128 v[40:43], v73 offset:512
ds_read_b128 v[44:47], v74 offset:0
ds_read_b64 v[18:19], v75 offset:256
ds_read_b64 v[20:21], v75 offset:512
ds_read_b64 v[22:23], v75 offset:768
ds_read_b64 v[24:25], v75 offset:1024
ds_read_b32 v48, v76
ds_read_b32 v49, v77
ds_read_b32 v50, v79
ds_read_b128 v[52:55], v78 offset:0
ds_read_b128 v[56:59], v78 offset:640
ds_read_b128 v[60:63], v78 offset:128
ds_read_b128 v[64:67], v78 offset:768
v_mov_b32 v72, 0x3f803f80
v_mov_b32 v73, 0x3f803f80
v_mov_b32 v74, 0x3f803f80
v_mov_b32 v75, 0x3f803f80
s_waitcnt lgkmcnt(15)
v_bfi_b32 v12, v94, 1.0, v17
v_pk_fma_f32 v[96:97], v[16:17], v[28:29], v[96:97] op_sel_hi:[0,1,1]
s_waitcnt lgkmcnt(14)
v_pk_fma_f32 v[116:117], v[16:17], v[32:33], v[116:117] op_sel_hi:[0,1,1]
s_waitcnt lgkmcnt(13)
v_pk_fma_f32 v[136:137], v[16:17], v[36:37], v[136:137] op_sel_hi:[0,1,1]
v_pk_fma_f32 v[138:139], v[16:17], v[38:39], v[138:139] op_sel_hi:[0,1,1]
v_pk_mul_f32 v[136:137], v[16:17], v[136:137] op_sel:[1,0]
s_waitcnt lgkmcnt(11)
v_pk_fma_f32 v[176:177], v[16:17], v[44:45], v[176:177] op_sel_hi:[0,1,1]
v_pk_mul_f32 v[138:139], v[16:17], v[138:139] op_sel:[1,0]
v_cvt_pk_bf16_f32 v136, v136, v137
v_pk_mul_f32 v[176:177], v[12:13], v[176:177] op_sel_hi:[0,1]
v_cvt_pk_bf16_f32 v137, v138, v139
v_pk_fma_f32 v[178:179], v[16:17], v[46:47], v[178:179] op_sel_hi:[0,1,1]
v_cvt_pk_bf16_f32 v138, v176, v177
v_pk_mul_f32 v[178:179], v[12:13], v[178:179] op_sel_hi:[0,1]
v_cvt_pk_bf16_f32 v176, v176, v177
v_cvt_pk_bf16_f32 v139, v178, v179
v_cvt_pk_bf16_f32 v177, v178, v179
v_pk_fma_f32 v[156:157], v[16:17], v[40:41], v[156:157] op_sel_hi:[0,1,1]
v_pk_fma_f32 v[158:159], v[16:17], v[42:43], v[158:159] op_sel_hi:[0,1,1]
v_pk_mul_f32 v[156:157], v[16:17], v[156:157] op_sel:[1,0]
s_waitcnt lgkmcnt(10)
v_pk_fma_f32 v[140:141], v[18:19], v[36:37], v[140:141] op_sel_hi:[0,1,1]
v_pk_fma_f32 v[98:99], v[16:17], v[30:31], v[98:99] op_sel_hi:[0,1,1]
v_pk_fma_f32 v[118:119], v[16:17], v[34:35], v[118:119] op_sel_hi:[0,1,1]
v_pk_mul_f32 v[158:159], v[16:17], v[158:159] op_sel:[1,0]
v_cvt_pk_bf16_f32 v96, v96, v97
v_cvt_pk_bf16_f32 v116, v116, v117
v_cvt_pk_bf16_f32 v156, v156, v157
v_permlane32_swap_b32 v176, v138
v_permlane32_swap_b32 v177, v139
v_pk_fma_f32 v[142:143], v[18:19], v[38:39], v[142:143] op_sel_hi:[0,1,1]
v_pk_mul_f32 v[140:141], v[18:19], v[140:141] op_sel:[1,0]
v_cvt_pk_bf16_f32 v97, v98, v99
v_cvt_pk_bf16_f32 v117, v118, v119
v_cvt_pk_bf16_f32 v157, v158, v159
v_bfi_b32 v13, v94, 1.0, v19
v_pk_fma_f32 v[180:181], v[18:19], v[44:45], v[180:181] op_sel_hi:[0,1,1]
v_pk_mul_f32 v[142:143], v[18:19], v[142:143] op_sel:[1,0]
v_cvt_pk_bf16_f32 v140, v140, v141
v_and_b32 v98, v92, v176
v_and_b32 v118, v93, v176
v_and_b32 v99, v92, v177
v_and_b32 v119, v93, v177
v_mov_b64 v[158:159], v[138:139]
v_pk_mul_f32 v[180:181], v[12:13], v[180:181] op_sel:[1,0]
v_cvt_pk_bf16_f32 v141, v142, v143
v_pk_fma_f32 v[182:183], v[18:19], v[46:47], v[182:183] op_sel_hi:[0,1,1]
v_cvt_pk_bf16_f32 v142, v180, v181
v_pk_mul_f32 v[182:183], v[12:13], v[182:183] op_sel:[1,0]
v_cvt_pk_bf16_f32 v180, v180, v181
v_cvt_pk_bf16_f32 v143, v182, v183
v_cvt_pk_bf16_f32 v181, v182, v183
v_mfma_f32_16x16x32_bf16 v[96:99], v[136:139], v[96:99], v[80:83]
v_permlane32_swap_b32 v180, v142
v_mfma_f32_16x16x32_bf16 v[116:119], v[156:159], v[116:119], v[80:83]
v_permlane32_swap_b32 v181, v143
s_waitcnt lgkmcnt(9)
v_bfi_b32 v12, v94, 1.0, v21
v_mul_f32 v16, 0x3ea52b5c, v17
v_pk_fma_f32 v[100:101], v[18:19], v[28:29], v[100:101] op_sel_hi:[0,1,1]
v_pk_fma_f32 v[120:121], v[18:19], v[32:33], v[120:121] op_sel_hi:[0,1,1]
v_pk_fma_f32 v[102:103], v[18:19], v[30:31], v[102:103] op_sel_hi:[0,1,1]
v_pk_fma_f32 v[122:123], v[18:19], v[34:35], v[122:123] op_sel_hi:[0,1,1]
v_pk_fma_f32 v[160:161], v[18:19], v[40:41], v[160:161] op_sel_hi:[0,1,1]
v_cvt_pk_bf16_f32 v100, v100, v101
v_cvt_pk_bf16_f32 v120, v120, v121
v_pk_fma_f32 v[162:163], v[18:19], v[42:43], v[162:163] op_sel_hi:[0,1,1]
v_pk_mul_f32 v[160:161], v[18:19], v[160:161] op_sel:[1,0]
v_cvt_pk_bf16_f32 v101, v102, v103
v_cvt_pk_bf16_f32 v121, v122, v123
v_pk_mul_f32 v[162:163], v[18:19], v[162:163] op_sel:[1,0]
v_cvt_pk_bf16_f32 v160, v160, v161
v_and_b32 v102, v92, v180
v_and_b32 v122, v93, v180
v_and_b32 v103, v92, v181
v_and_b32 v123, v93, v181
v_cvt_pk_bf16_f32 v161, v162, v163
v_pk_fma_f32 v[144:145], v[20:21], v[36:37], v[144:145] op_sel_hi:[0,1,1]
v_mov_b64 v[162:163], v[142:143]
v_pk_fma_f32 v[146:147], v[20:21], v[38:39], v[146:147] op_sel_hi:[0,1,1]
v_pk_mul_f32 v[144:145], v[20:21], v[144:145] op_sel:[1,0]
v_pk_fma_f32 v[184:185], v[20:21], v[44:45], v[184:185] op_sel_hi:[0,1,1]
v_pk_mul_f32 v[146:147], v[20:21], v[146:147] op_sel:[1,0]
v_cvt_pk_bf16_f32 v144, v144, v145
v_mfma_f32_16x16x32_bf16 v[136:139], v[136:139], v[100:103], v[84:87]
v_cvt_pk_bf16_f32 v145, v146, v147
v_max3_f32 v176, v96, v97, v98
v_mfma_f32_16x16x32_bf16 v[156:159], v[156:159], v[120:123], v[84:87]
v_max3_f32 v177, v116, v117, v118
v_max_f32 v176, v176, v99
v_mfma_f32_16x16x32_bf16 v[100:103], v[140:143], v[100:103], v[80:83]
v_max_f32 v177, v177, v119
v_mul_f32 v18, 0x3ea52b5c, v19
v_mfma_f32_16x16x32_bf16 v[120:123], v[160:163], v[120:123], v[80:83]
v_permlane32_swap_b32 v176, v177
v_max_f32 v178, v176, v177
v_max_f32 v179, v176, v177
v_pk_mul_f32 v[184:185], v[12:13], v[184:185] op_sel_hi:[0,1]
v_pk_fma_f32 v[186:187], v[20:21], v[46:47], v[186:187] op_sel_hi:[0,1,1]
v_cvt_pk_bf16_f32 v146, v184, v185
v_pk_mul_f32 v[186:187], v[12:13], v[186:187] op_sel_hi:[0,1]
v_cvt_pk_bf16_f32 v184, v184, v185
v_cvt_pk_bf16_f32 v147, v186, v187
v_cvt_pk_bf16_f32 v185, v186, v187
v_pk_fma_f32 v[104:105], v[20:21], v[28:29], v[104:105] op_sel_hi:[0,1,1]
v_pk_fma_f32 v[124:125], v[20:21], v[32:33], v[124:125] op_sel_hi:[0,1,1]
v_pk_fma_f32 v[106:107], v[20:21], v[30:31], v[106:107] op_sel_hi:[0,1,1]
v_pk_fma_f32 v[126:127], v[20:21], v[34:35], v[126:127] op_sel_hi:[0,1,1]
v_pk_fma_f32 v[164:165], v[20:21], v[40:41], v[164:165] op_sel_hi:[0,1,1]
v_cvt_pk_bf16_f32 v104, v104, v105
v_cvt_pk_bf16_f32 v124, v124, v125
v_permlane32_swap_b32 v184, v146
v_permlane32_swap_b32 v185, v147
v_pk_fma_f32 v[166:167], v[20:21], v[42:43], v[166:167] op_sel_hi:[0,1,1]
v_pk_mul_f32 v[164:165], v[20:21], v[164:165] op_sel:[1,0]
v_cvt_pk_bf16_f32 v105, v106, v107
v_cvt_pk_bf16_f32 v125, v126, v127
s_waitcnt lgkmcnt(3)
v_pk_fma_f32 v[196:197], v[48:49], v[52:53], v[196:197] op_sel_hi:[0,1,1]
v_pk_fma_f32 v[198:199], v[48:49], v[54:55], v[198:199] op_sel_hi:[0,1,1]
v_pk_fma_f32 v[216:217], v[48:49], v[52:53], v[216:217] op_sel:[1,0,0]
v_pk_fma_f32 v[218:219], v[48:49], v[54:55], v[218:219] op_sel:[1,0,0]
v_pk_fma_f32 v[236:237], v[50:51], v[52:53], v[236:237] op_sel_hi:[0,1,1]
v_pk_fma_f32 v[238:239], v[50:51], v[54:55], v[238:239] op_sel_hi:[0,1,1]
v_pk_mul_f32 v[166:167], v[20:21], v[166:167] op_sel:[1,0]
v_cvt_pk_bf16_f32 v164, v164, v165
v_and_b32 v106, v92, v184
v_and_b32 v126, v93, v184
v_and_b32 v107, v92, v185
v_and_b32 v127, v93, v185
s_waitcnt lgkmcnt(2)
v_pk_mul_f32 v[196:197], v[196:197], v[56:57]
v_pk_mul_f32 v[198:199], v[198:199], v[58:59]
v_pk_mul_f32 v[216:217], v[216:217], v[56:57]
v_pk_mul_f32 v[218:219], v[218:219], v[58:59]
v_pk_mul_f32 v[236:237], v[236:237], v[56:57]
v_pk_mul_f32 v[238:239], v[238:239], v[58:59]
ds_read_b128 v[52:55], v78 offset:256
v_cvt_pk_bf16_f32 v165, v166, v167
v_pk_fma_f32 v[148:149], v[22:23], v[36:37], v[148:149] op_sel_hi:[0,1,1]
ds_read_b128 v[56:59], v78 offset:896
v_mov_b64 v[166:167], v[146:147]
v_pk_fma_f32 v[150:151], v[22:23], v[38:39], v[150:151] op_sel_hi:[0,1,1]
v_pk_mul_f32 v[148:149], v[22:23], v[148:149] op_sel:[1,0]
v_bfi_b32 v13, v94, 1.0, v23
v_pk_fma_f32 v[188:189], v[22:23], v[44:45], v[188:189] op_sel_hi:[0,1,1]
v_pk_mul_f32 v[150:151], v[22:23], v[150:151] op_sel:[1,0]
v_cvt_pk_bf16_f32 v148, v148, v149
v_mfma_f32_16x16x32_bf16 v[140:143], v[140:143], v[104:107], v[84:87]
v_permlane16_swap_b32 v178, v179
v_mfma_f32_16x16x32_bf16 v[160:163], v[160:163], v[124:127], v[84:87]
v_cvt_pk_bf16_f32 v149, v150, v151
v_max_f32 v100, v100, v136
v_max_f32 v101, v101, v137
v_max_f32 v102, v102, v138
v_pk_mul_f32 v[188:189], v[12:13], v[188:189] op_sel:[1,0]
v_max_f32 v120, v120, v156
v_max_f32 v121, v121, v157
v_max_f32 v122, v122, v158
v_pk_fma_f32 v[190:191], v[22:23], v[46:47], v[190:191] op_sel_hi:[0,1,1]
v_cvt_pk_bf16_f32 v150, v188, v189
v_mfma_f32_16x16x32_bf16 v[104:107], v[144:147], v[104:107], v[80:83]
v_max_f32 v178, v178, v179
v_max_f32 v103, v103, v139
v_mfma_f32_16x16x32_bf16 v[124:127], v[164:167], v[124:127], v[80:83]
v_max_f32 v123, v123, v159
v_max3_f32 v180, v100, v101, v102
v_max3_f32 v181, v120, v121, v122
v_cvt_pk_bf16_f32 v188, v188, v189
v_pk_mul_f32 v[190:191], v[12:13], v[190:191] op_sel:[1,0]
v_mul_f32_e64 v176, -v178, v16
v_mul_f32_e64 v177, -v178, v16
v_max_f32 v180, v180, v103
v_max_f32 v181, v181, v123
v_cvt_pk_bf16_f32 v151, v190, v191
v_cvt_pk_bf16_f32 v189, v190, v191
v_pk_fma_f32 v[108:109], v[22:23], v[28:29], v[108:109] op_sel_hi:[0,1,1]
v_pk_fma_f32 v[128:129], v[22:23], v[32:33], v[128:129] op_sel_hi:[0,1,1]
v_permlane32_swap_b32 v176, v177
v_permlane32_swap_b32 v180, v181
v_pk_fma_f32 v[110:111], v[22:23], v[30:31], v[110:111] op_sel_hi:[0,1,1]
v_pk_fma_f32 v[130:131], v[22:23], v[34:35], v[130:131] op_sel_hi:[0,1,1]
v_pk_fma_f32 v[168:169], v[22:23], v[40:41], v[168:169] op_sel_hi:[0,1,1]
v_cvt_pk_bf16_f32 v108, v108, v109
v_cvt_pk_bf16_f32 v128, v128, v129
v_permlane32_swap_b32 v188, v150
v_permlane32_swap_b32 v189, v151
v_pk_fma_f32 v[170:171], v[22:23], v[42:43], v[170:171] op_sel_hi:[0,1,1]
v_pk_mul_f32 v[168:169], v[22:23], v[168:169] op_sel:[1,0]
v_cvt_pk_bf16_f32 v109, v110, v111
v_cvt_pk_bf16_f32 v129, v130, v131
v_pk_fma_f32 v[96:97], v[16:17], v[96:97], v[176:177] op_sel_hi:[0,1,0]
v_max_f32 v182, v180, v181
v_max_f32 v183, v180, v181
v_pk_mul_f32 v[170:171], v[22:23], v[170:171] op_sel:[1,0]
v_cvt_pk_bf16_f32 v168, v168, v169
v_and_b32 v110, v92, v188
v_and_b32 v130, v93, v188
v_and_b32 v111, v92, v189
v_and_b32 v131, v93, v189
v_pk_fma_f32 v[98:99], v[16:17], v[98:99], v[176:177] op_sel_hi:[0,1,0]
v_exp_f32 v96, v96
v_exp_f32 v97, v97
v_cvt_pk_bf16_f32 v169, v170, v171
v_pk_fma_f32 v[152:153], v[24:25], v[36:37], v[152:153] op_sel_hi:[0,1,1]
v_pk_fma_f32 v[116:117], v[16:17], v[116:117], v[176:177] op_sel:[0,0,1] op_sel_hi:[0,1,1]
v_exp_f32 v98, v98
v_exp_f32 v99, v99
v_mov_b64 v[170:171], v[150:151]
v_pk_fma_f32 v[154:155], v[24:25], v[38:39], v[154:155] op_sel_hi:[0,1,1]
v_pk_mul_f32 v[152:153], v[24:25], v[152:153] op_sel:[1,0]
v_pk_fma_f32 v[118:119], v[16:17], v[118:119], v[176:177] op_sel:[0,0,1] op_sel_hi:[0,1,1]
v_exp_f32 v116, v116
v_exp_f32 v117, v117
v_permlane16_swap_b32 v182, v183
v_bfi_b32 v12, v94, 1.0, v25
v_pk_fma_f32 v[192:193], v[24:25], v[44:45], v[192:193] op_sel_hi:[0,1,1]
v_pk_mul_f32 v[154:155], v[24:25], v[154:155] op_sel:[1,0]
v_cvt_pk_bf16_f32 v152, v152, v153
v_mfma_f32_16x16x32_bf16 v[144:147], v[144:147], v[108:111], v[84:87]
v_exp_f32 v118, v118
v_mfma_f32_16x16x32_bf16 v[164:167], v[164:167], v[128:131], v[84:87]
v_exp_f32 v119, v119
v_cvt_pk_bf16_f32 v96, v96, v97
v_cvt_pk_bf16_f32 v153, v154, v155
v_pk_mul_f32 v[192:193], v[12:13], v[192:193] op_sel_hi:[0,1]
v_cvt_pk_bf16_f32 v97, v98, v99
v_max_f32 v182, v182, v183
v_max_f32 v104, v104, v140
v_max_f32 v105, v105, v141
v_max_f32 v106, v106, v142
v_max_f32 v124, v124, v160
v_max_f32 v125, v125, v161
v_max_f32 v126, v126, v162
v_pk_fma_f32 v[194:195], v[24:25], v[46:47], v[194:195] op_sel_hi:[0,1,1]
v_cvt_pk_bf16_f32 v154, v192, v193
v_mfma_f32_16x16x32_bf16 v[108:111], v[148:151], v[108:111], v[80:83]
v_cvt_pk_bf16_f32 v116, v116, v117
v_and_b32 v8, v88, v96
v_mfma_f32_16x16x32_bf16 v[128:131], v[168:171], v[128:131], v[80:83]
v_and_b32 v9, v89, v97
v_and_b32 v10, v90, v96
v_and_b32 v11, v91, v97
v_mul_f32_e64 v180, -v182, v18
v_mul_f32_e64 v181, -v182, v18
v_max_f32 v107, v107, v143
v_max_f32 v127, v127, v163
v_max3_f32 v184, v104, v105, v106
v_max3_f32 v185, v124, v125, v126
v_pk_mul_f32 v[194:195], v[12:13], v[194:195] op_sel_hi:[0,1]
v_cvt_pk_bf16_f32 v192, v192, v193
v_cvt_pk_bf16_f32 v199, v198, v199
v_cvt_pk_bf16_f32 v117, v118, v119
v_max_f32 v184, v184, v107
v_max_f32 v185, v185, v127
v_cvt_pk_bf16_f32 v155, v194, v195
v_cvt_pk_bf16_f32 v193, v194, v195
v_cvt_pk_bf16_f32 v198, v196, v197
v_and_b32 v68, v88, v116
v_and_b32 v69, v89, v117
v_and_b32 v70, v90, v116
v_and_b32 v71, v91, v117
v_mov_b64 v[196:197], 0
v_cvt_pk_bf16_f32 v219, v218, v219
s_waitcnt lgkmcnt(3)
v_pk_fma_f32 v[200:201], v[48:49], v[60:61], v[200:201] op_sel_hi:[0,1,1]
v_pk_fma_f32 v[202:203], v[48:49], v[62:63], v[202:203] op_sel_hi:[0,1,1]
v_pk_fma_f32 v[220:221], v[48:49], v[60:61], v[220:221] op_sel:[1,0,0]
v_pk_fma_f32 v[222:223], v[48:49], v[62:63], v[222:223] op_sel:[1,0,0]
v_pk_fma_f32 v[240:241], v[50:51], v[60:61], v[240:241] op_sel_hi:[0,1,1]
v_pk_fma_f32 v[242:243], v[50:51], v[62:63], v[242:243] op_sel_hi:[0,1,1]
v_mfma_f32_16x16x32_bf16 v[176:179], v[72:75], v[8:11], 0
v_permlane32_swap_b32 v180, v181
v_cvt_pk_bf16_f32 v218, v216, v217
ds_read_b128 v[60:63], v78 offset:384
v_pk_fma_f32 v[112:113], v[24:25], v[28:29], v[112:113] op_sel_hi:[0,1,1]
v_pk_fma_f32 v[114:115], v[24:25], v[30:31], v[114:115] op_sel_hi:[0,1,1]
v_pk_fma_f32 v[132:133], v[24:25], v[32:33], v[132:133] op_sel_hi:[0,1,1]
s_waitcnt lgkmcnt(3)
v_pk_mul_f32 v[200:201], v[200:201], v[64:65]
v_pk_mul_f32 v[202:203], v[202:203], v[66:67]
v_pk_mul_f32 v[220:221], v[220:221], v[64:65]
v_pk_mul_f32 v[222:223], v[222:223], v[66:67]
v_pk_mul_f32 v[240:241], v[240:241], v[64:65]
v_pk_mul_f32 v[242:243], v[242:243], v[66:67]
v_permlane32_swap_b32 v184, v185
v_pk_fma_f32 v[134:135], v[24:25], v[34:35], v[134:135] op_sel_hi:[0,1,1]
v_pk_fma_f32 v[172:173], v[24:25], v[40:41], v[172:173] op_sel_hi:[0,1,1]
v_cvt_pk_bf16_f32 v112, v112, v113
v_cvt_pk_bf16_f32 v132, v132, v133
v_permlane32_swap_b32 v192, v154
v_permlane32_swap_b32 v193, v155
v_mov_b64 v[216:217], 0
ds_read_b128 v[64:67], v78 offset:1024
v_mfma_f32_16x16x32_bf16 v[28:31], v[72:75], v[68:71], 0
v_cvt_pk_bf16_f32 v113, v114, v115
v_cvt_pk_bf16_f32 v133, v134, v135
v_mfma_f32_16x16x32_bf16 v[96:99], v[196:199], v[8:11], 0
v_max_f32 v186, v184, v185
v_max_f32 v187, v184, v185
v_and_b32 v114, v92, v192
v_and_b32 v134, v93, v192
v_pk_fma_f32 v[100:101], v[18:19], v[100:101], v[180:181] op_sel_hi:[0,1,0]
v_pk_fma_f32 v[174:175], v[24:25], v[42:43], v[174:175] op_sel_hi:[0,1,1]
v_pk_mul_f32 v[172:173], v[24:25], v[172:173] op_sel:[1,0]
v_pk_fma_f32 v[102:103], v[18:19], v[102:103], v[180:181] op_sel_hi:[0,1,0]
v_exp_f32 v100, v100
v_exp_f32 v101, v101
v_pk_mul_f32 v[174:175], v[24:25], v[174:175] op_sel:[1,0]
v_cvt_pk_bf16_f32 v172, v172, v173
v_and_b32 v115, v92, v193
v_and_b32 v135, v93, v193
v_pk_fma_f32 v[120:121], v[18:19], v[120:121], v[180:181] op_sel:[0,0,1] op_sel_hi:[0,1,1]
v_exp_f32 v102, v102
v_exp_f32 v103, v103
v_cvt_pk_bf16_f32 v173, v174, v175
v_cvt_pk_bf16_f32 v239, v238, v239
v_mfma_f32_16x16x32_bf16 v[116:119], v[216:219], v[68:71], 0
v_exp_f32 v120, v120
v_exp_f32 v121, v121
v_pk_fma_f32 v[122:123], v[18:19], v[122:123], v[180:181] op_sel:[0,0,1] op_sel_hi:[0,1,1]
v_mov_b64 v[174:175], v[154:155]
v_cvt_pk_bf16_f32 v238, v236, v237
v_exp_f32 v122, v122
v_exp_f32 v123, v123
v_cvt_pk_bf16_f32 v100, v100, v101
v_permlane16_swap_b32 v186, v187
v_mov_b64 v[236:237], 0
v_mfma_f32_16x16x32_bf16 v[148:151], v[148:151], v[112:115], v[84:87]
v_cvt_pk_bf16_f32 v101, v102, v103
v_mul_f32 v20, 0x3ea52b5c, v21
v_mfma_f32_16x16x32_bf16 v[168:171], v[168:171], v[132:135], v[84:87]
v_cvt_pk_bf16_f32 v120, v120, v121
v_and_b32 v136, v88, v100
v_and_b32 v137, v89, v101
v_and_b32 v138, v90, v100
v_and_b32 v139, v91, v101
v_max_f32 v186, v186, v187
v_max_f32 v108, v108, v144
v_max_f32 v109, v109, v145
v_max_f32 v110, v110, v146
v_max_f32 v128, v128, v164
v_max_f32 v129, v129, v165
v_max_f32 v130, v130, v166
v_mfma_f32_16x16x32_bf16 v[112:115], v[152:155], v[112:115], v[80:83]
v_cvt_pk_bf16_f32 v121, v122, v123
v_mul_f32_e64 v184, -v186, v20
v_mfma_f32_16x16x32_bf16 v[132:135], v[172:175], v[132:135], v[80:83]
v_mul_f32_e64 v185, -v186, v20
v_max_f32 v111, v111, v147
v_max_f32 v131, v131, v167
v_max3_f32 v188, v108, v109, v110
v_max3_f32 v189, v128, v129, v130
v_cvt_pk_bf16_f32 v200, v200, v201
v_mfma_f32_16x16x32_bf16 v[8:11], v[236:239], v[8:11], 0
v_and_b32 v156, v88, v120
v_and_b32 v157, v89, v121
v_mfma_f32_16x16x32_bf16 v[68:71], v[236:239], v[68:71], 0
v_and_b32 v158, v90, v120
v_and_b32 v159, v91, v121
v_max_f32 v188, v188, v111
v_max_f32 v189, v189, v131
v_cvt_pk_bf16_f32 v201, v202, v203
v_rcp_f32 v176, v176
v_mfma_f32_16x16x32_bf16 v[180:183], v[72:75], v[136:139], 0
v_cvt_pk_bf16_f32 v220, v220, v221
v_permlane32_swap_b32 v184, v185
v_cvt_pk_bf16_f32 v221, v222, v223
s_waitcnt lgkmcnt(3)
v_pk_fma_f32 v[204:205], v[48:49], v[52:53], v[204:205] op_sel_hi:[0,1,1]
v_pk_fma_f32 v[206:207], v[48:49], v[54:55], v[206:207] op_sel_hi:[0,1,1]
v_pk_fma_f32 v[224:225], v[48:49], v[52:53], v[224:225] op_sel:[1,0,0]
v_pk_fma_f32 v[226:227], v[48:49], v[54:55], v[226:227] op_sel:[1,0,0]
v_pk_fma_f32 v[244:245], v[50:51], v[52:53], v[244:245] op_sel_hi:[0,1,1]
v_pk_fma_f32 v[246:247], v[50:51], v[54:55], v[246:247] op_sel_hi:[0,1,1]
s_waitcnt lgkmcnt(2)
v_pk_mul_f32 v[204:205], v[204:205], v[56:57]
v_pk_mul_f32 v[206:207], v[206:207], v[58:59]
v_pk_mul_f32 v[224:225], v[224:225], v[56:57]
v_pk_mul_f32 v[226:227], v[226:227], v[58:59]
v_pk_mul_f32 v[244:245], v[244:245], v[56:57]
v_pk_mul_f32 v[246:247], v[246:247], v[58:59]
ds_read_b128 v[52:55], v78 offset:512
v_rcp_f32 v28, v28
v_mfma_f32_16x16x32_bf16 v[32:35], v[72:75], v[156:159], 0
v_permlane32_swap_b32 v188, v189
ds_read_b128 v[56:59], v78 offset:1152
v_mfma_f32_16x16x32_bf16 v[100:103], v[198:201], v[136:139], 0
v_max_f32 v190, v188, v189
v_max_f32 v191, v188, v189
v_mfma_f32_16x16x32_bf16 v[120:123], v[218:221], v[156:159], 0
v_cvt_pk_bf16_f32 v240, v240, v241
v_cvt_pk_bf16_f32 v241, v242, v243
v_permlane16_swap_b32 v190, v191
v_pk_mul_f32 v[96:97], v[176:177], v[96:97] op_sel_hi:[0,1]
v_pk_fma_f32 v[104:105], v[20:21], v[104:105], v[184:185] op_sel_hi:[0,1,0]
v_pk_mul_f32 v[98:99], v[176:177], v[98:99] op_sel_hi:[0,1]
v_cvt_pk_bf16_f32 v96, v96, v97
v_pk_fma_f32 v[106:107], v[20:21], v[106:107], v[184:185] op_sel_hi:[0,1,0]
v_exp_f32 v104, v104
v_exp_f32 v105, v105
v_pk_mul_f32 v[116:117], v[28:29], v[116:117] op_sel_hi:[0,1]
v_pk_mul_f32 v[118:119], v[28:29], v[118:119] op_sel_hi:[0,1]
v_cvt_pk_bf16_f32 v97, v98, v99
v_pk_fma_f32 v[124:125], v[20:21], v[124:125], v[184:185] op_sel:[0,0,1] op_sel_hi:[0,1,1]
v_exp_f32 v106, v106
v_exp_f32 v107, v107
v_cvt_pk_bf16_f32 v98, v116, v117
v_cvt_pk_bf16_f32 v99, v118, v119
v_pk_fma_f32 v[126:127], v[20:21], v[126:127], v[184:185] op_sel:[0,0,1] op_sel_hi:[0,1,1]
v_exp_f32 v124, v124
v_exp_f32 v125, v125
buffer_store_dwordx4 v[96:99], v15, s[20:23], s68 offen sc1
v_exp_f32 v126, v126
v_exp_f32 v127, v127
v_cvt_pk_bf16_f32 v104, v104, v105
v_cvt_pk_bf16_f32 v105, v106, v107
v_mul_f32 v22, 0x3ea52b5c, v23
v_cvt_pk_bf16_f32 v124, v124, v125
v_and_b32 v140, v88, v104
v_and_b32 v141, v89, v105
v_and_b32 v142, v90, v104
v_and_b32 v143, v91, v105
v_max_f32 v190, v190, v191
v_max_f32 v112, v112, v148
v_max_f32 v113, v113, v149
v_max_f32 v114, v114, v150
v_max_f32 v132, v132, v168
v_max_f32 v133, v133, v169
v_max_f32 v134, v134, v170
v_bfi_b32 v8, v92, v8, v68
v_bfi_b32 v9, v92, v9, v69
v_bfi_b32 v10, v92, v10, v70
v_bfi_b32 v11, v92, v11, v71
v_bfi_b32 v178, v92, v176, v28
v_mfma_f32_16x16x32_bf16 v[136:139], v[238:241], v[136:139], 0
v_cvt_pk_bf16_f32 v125, v126, v127
v_mul_f32_e64 v188, -v190, v22
v_mfma_f32_16x16x32_bf16 v[156:159], v[238:241], v[156:159], 0
v_mul_f32_e64 v189, -v190, v22
v_max_f32 v115, v115, v151
v_max_f32 v135, v135, v171
v_max3_f32 v192, v112, v113, v114
v_max3_f32 v193, v132, v133, v134
v_pk_mul_f32 v[8:9], v[178:179], v[8:9] op_sel_hi:[0,1]
v_pk_mul_f32 v[10:11], v[178:179], v[10:11] op_sel_hi:[0,1]
v_rcp_f32 v180, v180
v_and_b32 v160, v88, v124
v_and_b32 v161, v89, v125
v_and_b32 v162, v90, v124
v_and_b32 v163, v91, v125
v_max_f32 v192, v192, v115
v_max_f32 v193, v193, v135
v_cvt_pk_bf16_f32 v202, v204, v205
v_cvt_pk_bf16_f32 v203, v206, v207
v_cvt_pk_bf16_f32 v116, v8, v9
v_cvt_pk_bf16_f32 v117, v10, v11
v_mfma_f32_16x16x32_bf16 v[184:187], v[72:75], v[140:143], 0
buffer_store_dwordx2 v[116:117], v95, s[20:23], s68 offen sc1
v_rcp_f32 v32, v32
v_permlane32_swap_b32 v188, v189
v_cvt_pk_bf16_f32 v222, v224, v225
v_cvt_pk_bf16_f32 v223, v226, v227
v_pk_mul_f32 v[100:101], v[180:181], v[100:101] op_sel_hi:[0,1]
v_mfma_f32_16x16x32_bf16 v[36:39], v[72:75], v[160:163], 0
v_permlane32_swap_b32 v192, v193
v_cvt_pk_bf16_f32 v100, v100, v101
v_mfma_f32_16x16x32_bf16 v[104:107], v[200:203], v[140:143], 0
v_max_f32 v194, v192, v193
v_max_f32 v195, v192, v193
v_mfma_f32_16x16x32_bf16 v[124:127], v[220:223], v[160:163], 0
v_bfi_b32 v96, v7, v100, v96
v_cvt_pk_bf16_f32 v242, v244, v245
v_cvt_pk_bf16_f32 v243, v246, v247
v_permlane16_swap_b32 v194, v195
v_pk_mul_f32 v[102:103], v[180:181], v[102:103] op_sel_hi:[0,1]
v_pk_fma_f32 v[108:109], v[22:23], v[108:109], v[188:189] op_sel_hi:[0,1,0]
v_pk_mul_f32 v[120:121], v[32:33], v[120:121] op_sel_hi:[0,1]
v_pk_mul_f32 v[122:123], v[32:33], v[122:123] op_sel_hi:[0,1]
v_cvt_pk_bf16_f32 v101, v102, v103
v_pk_fma_f32 v[110:111], v[22:23], v[110:111], v[188:189] op_sel_hi:[0,1,0]
v_exp_f32 v108, v108
v_exp_f32 v109, v109
v_cvt_pk_bf16_f32 v102, v120, v121
v_cvt_pk_bf16_f32 v103, v122, v123
v_pk_fma_f32 v[128:129], v[22:23], v[128:129], v[188:189] op_sel:[0,0,1] op_sel_hi:[0,1,1]
v_exp_f32 v110, v110
v_exp_f32 v111, v111
v_bfi_b32 v97, v7, v101, v97
v_bfi_b32 v98, v7, v102, v98
v_bfi_b32 v99, v7, v103, v99
v_pk_fma_f32 v[130:131], v[22:23], v[130:131], v[188:189] op_sel:[0,0,1] op_sel_hi:[0,1,1]
v_exp_f32 v128, v128
v_exp_f32 v129, v129
buffer_store_dwordx4 v[96:99], v15, s[20:23], s69 offen sc1
v_exp_f32 v130, v130
v_exp_f32 v131, v131
v_cvt_pk_bf16_f32 v108, v108, v109
v_cvt_pk_bf16_f32 v109, v110, v111
v_mul_f32 v24, 0x3ea52b5c, v25
v_bfi_b32 v136, v92, v136, v156
v_bfi_b32 v137, v92, v137, v157
v_bfi_b32 v138, v92, v138, v158
v_bfi_b32 v139, v92, v139, v159
v_bfi_b32 v182, v92, v180, v32
v_cvt_pk_bf16_f32 v128, v128, v129
v_and_b32 v144, v88, v108
v_and_b32 v145, v89, v109
v_and_b32 v146, v90, v108
v_and_b32 v147, v91, v109
v_max_f32 v194, v194, v195
s_waitcnt lgkmcnt(3)
v_pk_fma_f32 v[208:209], v[48:49], v[60:61], v[208:209] op_sel_hi:[0,1,1]
v_pk_fma_f32 v[210:211], v[48:49], v[62:63], v[210:211] op_sel_hi:[0,1,1]
v_pk_mul_f32 v[136:137], v[182:183], v[136:137] op_sel_hi:[0,1]
v_pk_mul_f32 v[138:139], v[182:183], v[138:139] op_sel_hi:[0,1]
v_mfma_f32_16x16x32_bf16 v[140:143], v[240:243], v[140:143], 0
v_cvt_pk_bf16_f32 v129, v130, v131
v_mul_f32_e64 v192, -v194, v24
v_mfma_f32_16x16x32_bf16 v[160:163], v[240:243], v[160:163], 0
v_mul_f32_e64 v193, -v194, v24
v_cvt_pk_bf16_f32 v120, v136, v137
v_cvt_pk_bf16_f32 v121, v138, v139
v_rcp_f32 v184, v184
s_waitcnt lgkmcnt(2)
v_pk_mul_f32 v[208:209], v[208:209], v[64:65]
v_pk_mul_f32 v[210:211], v[210:211], v[66:67]
v_and_b32 v164, v88, v128
v_and_b32 v165, v89, v129
v_and_b32 v166, v90, v128
v_and_b32 v167, v91, v129
v_pk_fma_f32 v[228:229], v[48:49], v[60:61], v[228:229] op_sel:[1,0,0]
v_pk_fma_f32 v[230:231], v[48:49], v[62:63], v[230:231] op_sel:[1,0,0]
v_cvt_pk_bf16_f32 v204, v208, v209
v_cvt_pk_bf16_f32 v205, v210, v211
v_bfi_b32 v116, v7, v120, v116
v_bfi_b32 v117, v7, v121, v117
v_mfma_f32_16x16x32_bf16 v[188:191], v[72:75], v[144:147], 0
buffer_store_dwordx2 v[116:117], v95, s[20:23], s69 offen sc1
v_pk_mul_f32 v[228:229], v[228:229], v[64:65]
v_pk_mul_f32 v[230:231], v[230:231], v[66:67]
v_rcp_f32 v36, v36
v_permlane32_swap_b32 v192, v193
v_cvt_pk_bf16_f32 v224, v228, v229
v_cvt_pk_bf16_f32 v225, v230, v231
v_pk_mul_f32 v[104:105], v[184:185], v[104:105] op_sel_hi:[0,1]
v_mfma_f32_16x16x32_bf16 v[40:43], v[72:75], v[164:167], 0
v_cvt_pk_bf16_f32 v104, v104, v105
v_bfi_b32 v100, v7, v104, v100
v_mfma_f32_16x16x32_bf16 v[108:111], v[202:205], v[144:147], 0
v_bfi_b32 v140, v92, v140, v160
v_bfi_b32 v141, v92, v141, v161
v_mfma_f32_16x16x32_bf16 v[128:131], v[222:225], v[164:167], 0
v_bfi_b32 v142, v92, v142, v162
v_bfi_b32 v143, v92, v143, v163
v_bfi_b32 v186, v92, v184, v36
v_rcp_f32 v188, v188
v_pk_mul_f32 v[106:107], v[184:185], v[106:107] op_sel_hi:[0,1]
v_pk_fma_f32 v[112:113], v[24:25], v[112:113], v[192:193] op_sel_hi:[0,1,0]
v_pk_mul_f32 v[124:125], v[36:37], v[124:125] op_sel_hi:[0,1]
v_pk_mul_f32 v[126:127], v[36:37], v[126:127] op_sel_hi:[0,1]
v_cvt_pk_bf16_f32 v105, v106, v107
v_pk_fma_f32 v[114:115], v[24:25], v[114:115], v[192:193] op_sel_hi:[0,1,0]
v_exp_f32 v112, v112
v_exp_f32 v113, v113
v_pk_fma_f32 v[248:249], v[50:51], v[60:61], v[248:249] op_sel_hi:[0,1,1]
v_pk_fma_f32 v[250:251], v[50:51], v[62:63], v[250:251] op_sel_hi:[0,1,1]
v_cvt_pk_bf16_f32 v106, v124, v125
v_cvt_pk_bf16_f32 v107, v126, v127
v_pk_fma_f32 v[132:133], v[24:25], v[132:133], v[192:193] op_sel:[0,0,1] op_sel_hi:[0,1,1]
v_exp_f32 v114, v114
v_exp_f32 v115, v115
v_pk_mul_f32 v[248:249], v[248:249], v[64:65]
v_pk_mul_f32 v[250:251], v[250:251], v[66:67]
v_bfi_b32 v101, v7, v105, v101
v_bfi_b32 v102, v7, v106, v102
v_bfi_b32 v103, v7, v107, v103
v_pk_fma_f32 v[134:135], v[24:25], v[134:135], v[192:193] op_sel:[0,0,1] op_sel_hi:[0,1,1]
v_exp_f32 v132, v132
v_exp_f32 v133, v133
v_cvt_pk_bf16_f32 v244, v248, v249
v_cvt_pk_bf16_f32 v245, v250, v251
buffer_store_dwordx4 v[100:103], v15, s[20:23], s70 offen sc1
v_exp_f32 v134, v134
v_exp_f32 v135, v135
v_cvt_pk_bf16_f32 v112, v112, v113
v_cvt_pk_bf16_f32 v113, v114, v115
v_cvt_pk_bf16_f32 v132, v132, v133
v_and_b32 v148, v88, v112
v_and_b32 v149, v89, v113
v_and_b32 v150, v90, v112
v_and_b32 v151, v91, v113
s_waitcnt lgkmcnt(1)
v_pk_fma_f32 v[212:213], v[48:49], v[52:53], v[212:213] op_sel_hi:[0,1,1]
v_pk_fma_f32 v[214:215], v[48:49], v[54:55], v[214:215] op_sel_hi:[0,1,1]
v_pk_mul_f32 v[140:141], v[186:187], v[140:141] op_sel_hi:[0,1]
v_pk_mul_f32 v[142:143], v[186:187], v[142:143] op_sel_hi:[0,1]
v_mfma_f32_16x16x32_bf16 v[144:147], v[242:245], v[144:147], 0
v_cvt_pk_bf16_f32 v133, v134, v135
v_cvt_pk_bf16_f32 v124, v140, v141
v_mfma_f32_16x16x32_bf16 v[164:167], v[242:245], v[164:167], 0
v_cvt_pk_bf16_f32 v125, v142, v143
v_and_b32 v168, v88, v132
v_and_b32 v169, v89, v133
v_and_b32 v170, v90, v132
s_waitcnt lgkmcnt(0)
v_pk_mul_f32 v[212:213], v[212:213], v[56:57]
v_pk_mul_f32 v[214:215], v[214:215], v[58:59]
v_and_b32 v171, v91, v133
v_pk_fma_f32 v[232:233], v[48:49], v[52:53], v[232:233] op_sel:[1,0,0]
v_pk_fma_f32 v[234:235], v[48:49], v[54:55], v[234:235] op_sel:[1,0,0]
v_cvt_pk_bf16_f32 v206, v212, v213
v_cvt_pk_bf16_f32 v207, v214, v215
v_bfi_b32 v120, v7, v124, v120
v_bfi_b32 v121, v7, v125, v121
v_mfma_f32_16x16x32_bf16 v[192:195], v[72:75], v[148:151], 0
buffer_store_dwordx2 v[120:121], v95, s[20:23], s70 offen sc1
v_pk_mul_f32 v[232:233], v[232:233], v[56:57]
v_pk_mul_f32 v[234:235], v[234:235], v[58:59]
v_rcp_f32 v40, v40
v_cvt_pk_bf16_f32 v226, v232, v233
v_cvt_pk_bf16_f32 v227, v234, v235
v_pk_mul_f32 v[108:109], v[188:189], v[108:109] op_sel_hi:[0,1]
v_mfma_f32_16x16x32_bf16 v[44:47], v[72:75], v[168:171], 0
v_cvt_pk_bf16_f32 v108, v108, v109
v_bfi_b32 v104, v7, v108, v104
v_mfma_f32_16x16x32_bf16 v[112:115], v[204:207], v[148:151], 0
v_bfi_b32 v144, v92, v144, v164
v_bfi_b32 v145, v92, v145, v165
v_mfma_f32_16x16x32_bf16 v[132:135], v[224:227], v[168:171], 0
v_bfi_b32 v146, v92, v146, v166
v_bfi_b32 v147, v92, v147, v167
v_bfi_b32 v190, v92, v188, v40
v_rcp_f32 v192, v192
v_pk_mul_f32 v[110:111], v[188:189], v[110:111] op_sel_hi:[0,1]
v_pk_mul_f32 v[128:129], v[40:41], v[128:129] op_sel_hi:[0,1]
v_pk_mul_f32 v[130:131], v[40:41], v[130:131] op_sel_hi:[0,1]
v_cvt_pk_bf16_f32 v109, v110, v111
v_pk_fma_f32 v[252:253], v[50:51], v[52:53], v[252:253] op_sel_hi:[0,1,1]
v_pk_fma_f32 v[254:255], v[50:51], v[54:55], v[254:255] op_sel_hi:[0,1,1]
v_cvt_pk_bf16_f32 v110, v128, v129
v_cvt_pk_bf16_f32 v111, v130, v131
v_pk_mul_f32 v[252:253], v[252:253], v[56:57]
v_pk_mul_f32 v[254:255], v[254:255], v[58:59]
v_bfi_b32 v105, v7, v109, v105
v_bfi_b32 v106, v7, v110, v106
v_bfi_b32 v107, v7, v111, v107
v_cvt_pk_bf16_f32 v246, v252, v253
v_cvt_pk_bf16_f32 v247, v254, v255
buffer_store_dwordx4 v[104:107], v15, s[20:23], s71 offen sc1
v_pk_mul_f32 v[144:145], v[190:191], v[144:145] op_sel_hi:[0,1]
v_pk_mul_f32 v[146:147], v[190:191], v[146:147] op_sel_hi:[0,1]
v_mfma_f32_16x16x32_bf16 v[148:151], v[244:247], v[148:151], 0
v_cvt_pk_bf16_f32 v128, v144, v145
v_cvt_pk_bf16_f32 v129, v146, v147
v_mfma_f32_16x16x32_bf16 v[168:171], v[244:247], v[168:171], 0
v_bfi_b32 v124, v7, v128, v124
v_bfi_b32 v125, v7, v129, v125
buffer_store_dwordx2 v[124:125], v95, s[20:23], s71 offen sc1
v_rcp_f32 v44, v44
v_pk_mul_f32 v[112:113], v[192:193], v[112:113] op_sel_hi:[0,1]
v_pk_mul_f32 v[114:115], v[192:193], v[114:115] op_sel_hi:[0,1]
v_cvt_pk_bf16_f32 v112, v112, v113
v_pk_mul_f32 v[132:133], v[44:45], v[132:133] op_sel_hi:[0,1]
v_pk_mul_f32 v[134:135], v[44:45], v[134:135] op_sel_hi:[0,1]
v_cvt_pk_bf16_f32 v113, v114, v115
v_cvt_pk_bf16_f32 v114, v132, v133
v_cvt_pk_bf16_f32 v115, v134, v135
v_bfi_b32 v108, v7, v112, v108
v_bfi_b32 v109, v7, v113, v109
v_bfi_b32 v110, v7, v114, v110
v_bfi_b32 v111, v7, v115, v111
buffer_store_dwordx4 v[108:111], v15, s[20:23], s72 offen sc1
v_bfi_b32 v148, v92, v148, v168
v_bfi_b32 v149, v92, v149, v169
v_bfi_b32 v150, v92, v150, v170
v_bfi_b32 v151, v92, v151, v171
v_bfi_b32 v194, v92, v192, v44
v_pk_mul_f32 v[148:149], v[194:195], v[148:149] op_sel_hi:[0,1]
v_pk_mul_f32 v[150:151], v[194:195], v[150:151] op_sel_hi:[0,1]
v_cvt_pk_bf16_f32 v132, v148, v149
v_cvt_pk_bf16_f32 v133, v150, v151
v_bfi_b32 v128, v7, v132, v128
v_bfi_b32 v129, v7, v133, v129
buffer_store_dwordx2 v[128:129], v95, s[20:23], s72 offen sc1
buffer_store_dwordx4 v[112:115], v15, s[20:23], s73 offen sc1
buffer_store_dwordx2 v[132:133], v95, s[20:23], s73 offen sc1
L_P2A:
v_mov_b32 v1, 1
s_load_dword s74, s[54:55], s89 glc
v_lshrrev_b32 v5, 4, v0
v_and_b32 v2, 15, v0
v_and_b32 v3, 7, v0
v_xor_b32 v3, v3, v5
v_lshlrev_b32 v4, 8, v2
v_lshl_add_u32 v4, v3, 4, v4
s_mul_i32 s61, s81, 24576
s_mov_b32 s60, s61
s_add_u32 s61, s61, 16384
v_add_u32 v13, s60, v4
v_xor_b32 v7, 64, v13
v_add_u32 v12, s60, v14
v_bfe_u32 v3, v0, 1, 2
v_xor_b32 v3, v3, v5
v_lshlrev_b32 v4, 6, v2
v_lshl_add_u32 v4, v3, 4, v4
v_add_u32 v6, s61, v4
v_and_b32 v2, 1, v0
v_lshlrev_b32 v2, 2, v2
v_add_u32 v2, 146688, v2
ds_read_b32 v3, v2
s_waitcnt lgkmcnt(0)
v_cmp_eq_u32 vcc, 0, v3
s_mov_b32 s42, 0
s_cbranch_vccnz L_nf66
s_mov_b32 s42, 1
ds_read_b128 v[136:139], v12 offset:0
ds_read_b128 v[140:143], v12 offset:1024
ds_read_b128 v[144:147], v12 offset:2048
ds_read_b128 v[148:151], v12 offset:3072
ds_read_b128 v[152:155], v12 offset:4096
ds_read_b128 v[156:159], v12 offset:5120
ds_read_b128 v[160:163], v12 offset:6144
ds_read_b128 v[164:167], v12 offset:7168
ds_read_b128 v[168:171], v12 offset:8192
ds_read_b128 v[172:175], v12 offset:9216
L_nf66:
v_mov_b32 v2, 146700
s_waitcnt vmcnt(0)
s_mov_b64 exec, 1
ds_add_rtn_u32 v3, v2, v1
s_mov_b64 exec, -1
s_waitcnt lgkmcnt(0)
v_readfirstlane_b32 s60, v3
s_nop 0
s_cmp_lg_u32 s60, 3
s_cbranch_scc1 L_sk67
s_atomic_add s5, s[54:55], s79
s_add_u32 s68, s79, 128
s_cmp_gt_u32 s68, s76
s_cbranch_scc1 L_sk67
s_atomic_add s5, s[54:55], s68
s_add_u32 s69, s79, 256
s_cmp_gt_u32 s69, s76
s_cbranch_scc1 L_sk67
s_atomic_add s5, s[54:55], s69
s_add_u32 s70, s79, 384
s_cmp_gt_u32 s70, s76
s_cbranch_scc1 L_sk67
s_atomic_add s5, s[54:55], s70
L_sk67:
s_mov_b32 s76, 0
s_cmp_eq_u32 s42, 1
s_cbranch_scc1 L_sk69
v_and_b32 v2, 1, v0
v_lshlrev_b32 v2, 2, v2
v_add_u32 v2, 146688, v2
ds_read_b32 v3, v2
s_waitcnt lgkmcnt(0)
v_cmp_eq_u32 vcc, 0, v3
s_nop 0
s_cbranch_vccz L_ok71
s_mov_b32 s78, 400000
s_branch L_lc73
L_lp72:
s_sleep 1
L_lc73:
ds_read_b32 v3, v2
s_waitcnt lgkmcnt(0)
v_cmp_eq_u32 vcc, 0, v3
s_sub_u32 s78, s78, 1
s_cbranch_vccz L_lo74
s_cmp_lg_u32 s78, 0
s_cbranch_scc1 L_lp72
L_lo74:
L_ok71:
ds_read_b128 v[136:139], v12 offset:0
ds_read_b128 v[140:143], v12 offset:1024
ds_read_b128 v[144:147], v12 offset:2048
ds_read_b128 v[148:151], v12 offset:3072
ds_read_b128 v[152:155], v12 offset:4096
ds_read_b128 v[156:159], v12 offset:5120
ds_read_b128 v[160:163], v12 offset:6144
ds_read_b128 v[164:167], v12 offset:7168
ds_read_b128 v[168:171], v12 offset:8192
ds_read_b128 v[172:175], v12 offset:9216
L_sk69:
s_bfe_u32 s85, s74, 0x80000
s_cmp_eq_u32 s85, 2
s_cbranch_scc1 L_ok70
s_mov_b32 s78, 40000
s_branch L_sl78
L_sp75:
s_sleep 3
L_sl78:
s_load_dword s74, s[54:55], s89 glc
L_sc76:
s_waitcnt lgkmcnt(0)
s_bfe_u32 s85, s74, 0x80000
s_cmp_eq_u32 s85, 2
s_cbranch_scc1 L_so77
s_sub_u32 s78, s78, 1
s_cmp_lg_u32 s78, 0
s_cbranch_scc1 L_sp75
L_so77:
L_ok70:
s_add_u32 s87, s90, 0
buffer_load_dwordx4 v[80:83], v14, s[20:23], s87 offen offset:0 sc1
buffer_load_dwordx4 v[84:87], v14, s[20:23], s87 offen offset:1024 sc1
buffer_load_dwordx4 v[88:91], v14, s[20:23], s87 offen offset:2048 sc1
buffer_load_dwordx4 v[92:95], v14, s[20:23], s87 offen offset:3072 sc1
s_add_u32 s87, s90, 4096
buffer_load_dwordx4 v[96:99], v14, s[20:23], s87 offen offset:0 sc1
buffer_load_dwordx4 v[100:103], v14, s[20:23], s87 offen offset:1024 sc1
buffer_load_dwordx4 v[104:107], v14, s[20:23], s87 offen offset:2048 sc1
buffer_load_dwordx4 v[108:111], v14, s[20:23], s87 offen offset:3072 sc1
s_branch L_P2G
.fill 256, 4, 0xbf800000
L_codeend:
.section .rodata,"a"
.p2align 6
.amdhsa_kernel recurrent_scan__sliding_local_dilated__glu_gated_geglu__prompt_kernel
  .amdhsa_next_free_vgpr 256
  .amdhsa_next_free_sgpr 102
  .amdhsa_accum_offset 256
  .amdhsa_group_segment_fixed_size 0
  .amdhsa_kernarg_size 80
  .amdhsa_user_sgpr_count 2
  .amdhsa_user_sgpr_kernarg_segment_ptr 1
  .amdhsa_system_sgpr_workgroup_id_x 1
.end_amdhsa_kernel
```
